```python
import torch

def _softmax(x, axis=-1):
    return torch.softmax(x, dim=axis)

def _gelu(x):
    return torch.nn.functional.gelu(x, approximate='tanh')

def _silu(x):
    return torch.nn.functional.silu(x)

def _sigmoid(x):
    return torch.sigmoid(x)

def _layernorm(x, axis=-1, eps=1e-05):
    m = x.mean(dim=axis, keepdim=True)
    v = x.var(dim=axis, keepdim=True, unbiased=False)
    return (x - m) / torch.sqrt(v + eps)

def _scatter_add(tgt, idx, src, axis=0):
    return tgt.clone().index_add_(axis, idx, src)

def _segment_sum(src, seg, n):
    out = torch.zeros((n,) + src.shape[1:], dtype=src.dtype)
    return out.index_add_(0, seg, src)

def _pad(x, pw):
    flat = tuple((v for pair in reversed(pw) for v in pair))
    return torch.nn.functional.pad(x, flat)
kernel_name = 'gated_mix__sliding_local_dilated__mixer_gmlp__prompt'

def setup_inputs():

    _w = lambda a: (lambda t: t.to(torch.bfloat16) if t.is_floating_point() else t)(torch.as_tensor(a))

    def _A_setup():
        B, S, D = (1, 2048, 512)
        return {'x': _w((lambda *s: torch.randn(*s, dtype=torch.bfloat16) * 0.05)(B, S, D)), 'wqkv': _w((lambda *s: torch.randn(*s, dtype=torch.bfloat16) * 0.8)(D, 3 * D)), 'wo': _w((lambda *s: torch.randn(*s, dtype=torch.bfloat16) * 0.05)(D, D))}
    _A_in = _A_setup()

    def _B_setup():
        B, S, D, F = (1, 2048, 512, 1792)
        Fh = F // 2
        return {'x': _w((lambda *s: torch.randn(*s, dtype=torch.bfloat16) * 0.05)(B, S, D)), 'w_in': _w((lambda *s: torch.randn(*s, dtype=torch.bfloat16) * 0.4)(D, 2 * Fh)), 'w_sp': _w(0.01 * (lambda *s: torch.randn(*s, dtype=torch.bfloat16) * 0.4)(S, S)), 'b_sp': _w(1.0 + 0.01 * (lambda *s: torch.randn(*s, dtype=torch.bfloat16) * 0.1)(S)), 'w_out': _w((lambda *s: torch.randn(*s, dtype=torch.bfloat16) * 0.1)(Fh, D))}
    _B_in = _B_setup()
    return {'A_x': _A_in['x'], 'A_wqkv': _A_in['wqkv'], 'A_wo': _A_in['wo'], 'B_x': _B_in['x'], 'B_w_in': _B_in['w_in'], 'B_w_sp': _B_in['w_sp'], 'B_b_sp': _B_in['b_sp'], 'B_w_out': _B_in['w_out'], 'gate_w': _w((lambda *s: torch.randn(*s, dtype=torch.bfloat16) * 0.05)(512) * 16.0)}

def reference(A_x, A_wqkv, A_wo, B_x, B_w_in, B_w_sp, B_b_sp, B_w_out, gate_w):

    def _A_ref(x, wqkv, wo):
        B, S, D = x.shape
        H = 32
        Dh = D // H
        W, dil = (8, 2)
        qkv = (lambda x, *d: x.permute(*d))((x @ wqkv).reshape(B, S, 3, H, Dh), 2, 0, 3, 1, 4)
        q, k, v = (qkv[0], qkv[1], qkv[2])
        scale = Dh ** (-0.5)
        pos = torch.arange(S)
        off = torch.arange(W) * dil
        idx = pos[:, None] - off[None, :]
        mask = idx >= 0
        idx_c = torch.where(mask, idx, 0).reshape(-1)
        kg = k[:, :, idx_c, :].reshape(B, H, S, W, Dh)
        vg = v[:, :, idx_c, :].reshape(B, H, S, W, Dh)
        logits = torch.einsum('bhsd,bhswd->bhsw', q, kg) * scale
        logits = torch.where(mask[None, None, :, :], logits, -1000000000.0)
        attn = _softmax(logits, axis=-1)
        o = torch.einsum('bhsw,bhswd->bhsd', attn, vg)
        return (lambda x, *d: x.permute(*d))(o, 0, 2, 1, 3).reshape(B, S, D) @ wo

    def _B_ref(x, w_in, w_sp, b_sp, w_out):
        B, S, D = x.shape
        F = w_in.shape[-1]
        Fh = F // 2
        z = _gelu(torch.einsum('bsd,df->bsf', x, w_in))
        z1 = z[..., :Fh].clone()
        z2 = _layernorm(z[..., Fh:], axis=-1)
        g = torch.einsum('ts,bsf->btf', w_sp, z2) + b_sp[None, :, None]
        return torch.einsum('bsf,fd->bsd', z1 * g, w_out)
    x = A_x
    g = _sigmoid((x * gate_w).sum(-1, keepdims=True))
    a = _A_ref(x, A_wqkv, A_wo)
    b = _B_ref(x, B_w_in, B_w_sp, B_b_sp, B_w_out)
    return g * a + (1 - g) * b
```

```asm
; @launch grid=(256,1,1) block=(256,1,1) lds=163840
.amdgcn_target "amdgcn-amd-amdhsa--gfx950"
.text
.globl gated_mix__sliding_local_dilated__mixer_gmlp__prompt_kernel
.p2align 12
.p2align 8
.type gated_mix__sliding_local_dilated__mixer_gmlp__prompt_kernel,@function
gated_mix__sliding_local_dilated__mixer_gmlp__prompt_kernel:
    s_cmp_ge_u32 s2, 256
    s_cbranch_scc1 L_end
    s_load_dwordx2 s[4:5], s[0:1], 0
    s_load_dwordx2 s[8:9], s[0:1], 32
    s_load_dwordx2 s[20:21], s[0:1], 88
    s_getpc_b64 s[60:61]
L_pcref:
    s_lshr_b32 s48, s2, 3
    s_lshl_b32 s48, s48, 7
    v_lshl_add_u32 v8, v0, 12, s48
    v_cmp_gt_u32 vcc, L_codeend-L_pcref, v8
    s_nop 1
    s_and_saveexec_b64 s[98:99], vcc
    s_cbranch_execz L_nocodepf
    global_load_dword v11, v8, s[60:61]
L_nocodepf:
    s_mov_b64 exec, -1
    s_load_dwordx2 s[12:13], s[0:1], 8
    s_load_dwordx2 s[16:17], s[0:1], 64
    s_load_dwordx2 s[24:25], s[0:1], 40
    s_load_dwordx2 s[28:29], s[0:1], 16
    s_load_dwordx2 s[32:33], s[0:1], 56
    s_load_dwordx2 s[36:37], s[0:1], 48
    s_load_dwordx2 s[40:41], s[0:1], 72
    v_lshrrev_b32 v8, 6, v0
    v_and_b32 v1, 63, v0
    v_readfirstlane_b32 s3, v8
    s_mov_b32 s6, 2097152
    s_mov_b32 s7, 0x20000
    s_mov_b32 s10, 1835008
    s_mov_b32 s11, 0x20000
    s_mov_b32 s14, 1572864
    s_mov_b32 s15, 0x20000
    s_mov_b32 s18, 1024
    s_mov_b32 s19, 0x20000
    s_mov_b32 s22, 13631488
    s_mov_b32 s23, 0x20000
    s_mov_b32 s26, 8388608
    s_mov_b32 s27, 0x20000
    s_mov_b32 s30, 524288
    s_mov_b32 s31, 0x20000
    s_mov_b32 s34, 917504
    s_mov_b32 s35, 0x20000
    s_mov_b32 s38, 4096
    s_mov_b32 s39, 0x20000
    s_mov_b32 s42, 2097152
    s_mov_b32 s43, 0x20000
    s_lshr_b32 s48, s2, 3
    s_and_b32 s53, s48, 7
    s_lshr_b32 s54, s48, 3
    s_and_b32 s49, s2, 6
    s_lshl_b32 s49, s49, 2
    s_add_u32 s44, s49, s53
    s_and_b32 s50, s2, 1
    s_lshl_b32 s49, s50, 2
    s_add_u32 s45, s49, s54
    s_lshr_b32 s48, s53, 2
    s_xor_b32 s55, s48, s50
    s_cmp_eq_u32 s54, 3
    s_cselect_b32 s55, s55, 0
    s_cselect_b32 s46, 3, s45
    s_lshl_b32 s49, s54, 1
    s_add_u32 s47, s53, s49
    s_and_b32 s47, s47, 7
    v_lshrrev_b32 v3, 4, v1
    v_lshrrev_b32 v6, 3, v1
    v_and_b32 v7, 7, v1
    v_and_b32 v2, 15, v1
    s_and_b32 s48, s3, 1
    s_lshl_b32 s48, s48, 5
    s_lshr_b32 s49, s3, 1
    s_add_u32 s48, s48, s49
    s_lshl_b32 s49, s44, 6
    s_add_u32 s59, s48, s49
    v_lshl_add_u32 v14, v6, 1, s59
    v_xor_b32 v15, v7, v3
    v_lshlrev_b32 v15, 4, v15
    v_lshl_add_u32 v12, v14, 10, v15
    v_xor_b32 v13, 64, v12
    v_add_u32 v13, 15360, v13
    s_mul_i32 s48, s3, 57344
    s_lshl_b32 s49, s46, 8
    s_add_u32 s48, s48, s49
    v_lshlrev_b32 v8, 2, v3
    v_xor_b32 v8, v8, v2
    v_mul_u32_u24 v9, 3584, v3
    v_lshl_add_u32 v8, v8, 4, v9
    v_add_u32 v16, s48, v8
    v_add_u32 v17, 13312, v16
    v_xor_b32 v18, 32, v16
    v_add_u32 v18, 26624, v18
    v_add_u32 v19, 13312, v18
    s_lshl_b32 s62, s3, 11
    s_lshl_b32 s63, s3, 12
    s_mul_i32 s64, s3, 6144
    s_lshl_b32 s65, s3, 10
    s_waitcnt lgkmcnt(0)
    s_load_dwordx2 s[56:57], s[20:21], 0
    s_cmp_lg_u32 s55, 0
    s_cselect_b32 s10, 0, s10
    s_add_u32 s51, s47, 0
    s_and_b32 s51, s51, 7
    s_add_u32 m0, s63, 77824
    s_mul_i32 s52, s51, 229376
    s_add_u32 s52, s52, 1792
    buffer_load_dwordx4 v16, s[8:11], s52 offen offset:0 lds
    buffer_load_dwordx4 v17, s[8:11], s52 offen offset:1024 lds
    buffer_load_dwordx4 v18, s[8:11], s52 offen offset:2048 lds
    buffer_load_dwordx4 v19, s[8:11], s52 offen offset:3072 lds
    s_add_u32 m0, s62, 0
    s_lshl_b32 s51, s51, 7
    buffer_load_dwordx4 v12, s[4:7], s51 offen offset:0 lds
    buffer_load_dwordx4 v13, s[4:7], s51 offen offset:1024 lds
    s_lshl_b32 s48, s47, 3
    v_add_u32 v8, s48, v1
    v_and_b32 v8, 63, v8
    v_lshlrev_b32 v8, 4, v8
    s_mov_b32 m0, 151552
    s_nop 0
    buffer_load_dwordx4 v8, s[16:19], 0 offen lds
    s_add_u32 s51, s47, 1
    s_and_b32 s51, s51, 7
    s_add_u32 m0, s63, 94208
    s_mul_i32 s52, s51, 229376
    s_add_u32 s52, s52, 1792
    buffer_load_dwordx4 v16, s[8:11], s52 offen offset:0 lds
    buffer_load_dwordx4 v17, s[8:11], s52 offen offset:1024 lds
    buffer_load_dwordx4 v18, s[8:11], s52 offen offset:2048 lds
    buffer_load_dwordx4 v19, s[8:11], s52 offen offset:3072 lds
    s_add_u32 m0, s62, 8192
    s_lshl_b32 s51, s51, 7
    buffer_load_dwordx4 v12, s[4:7], s51 offen offset:0 lds
    buffer_load_dwordx4 v13, s[4:7], s51 offen offset:1024 lds
    v_bfe_u32 v4, v1, 2, 2
    v_and_b32 v5, 3, v1
    s_mul_i32 s48, s3, 49152
    s_lshl_b32 s49, s45, 7
    s_add_u32 s48, s48, s49
    v_and_b32 v8, 1, v3
    v_lshlrev_b32 v8, 2, v8
    v_xor_b32 v8, v8, v7
    v_mul_u32_u24 v9, 3072, v6
    v_lshl_add_u32 v8, v8, 4, v9
    v_add_u32 v20, s48, v8
    v_xor_b32 v21, 32, v20
    v_add_u32 v21, 24576, v21
    s_lshl_b32 s48, s44, 6
    s_sub_u32 s48, s48, 16
    s_max_i32 s48, s48, 0
    s_and_b32 s49, s3, 1
    s_add_u32 s48, s48, s49
    v_lshl_add_u32 v8, v6, 1, s48
    s_lshl_b32 s49, s49, 6
    v_xor_b32 v9, s49, v15
    v_lshl_add_u32 v22, v8, 10, v9
    s_lshr_b32 s48, s3, 1
    s_add_u32 s66, s47, s48
    v_lshl_add_u32 v23, v14, 12, v15
    v_xor_b32 v24, 64, v23
    v_add_u32 v24, 64512, v24
    v_lshrrev_b32 v9, 1, v2
    v_xor_b32 v9, v9, v3
    v_lshlrev_b32 v9, 4, v9
    v_lshl_add_u32 v14, v2, 7, v9
    v_xor_b32 v15, 64, v14
    v_add_u32 v25, s62, v14
    v_add_u32 v27, 90112, v14
    v_add_u32 v26, s62, v15
    v_add_u32 v28, 90112, v15
    v_lshrrev_b32 v9, 1, v5
    v_and_b32 v10, 1, v3
    v_lshl_or_b32 v34, v10, 1, v9
    v_and_b32 v35, 1, v5
    v_lshlrev_b32 v35, 3, v35
    v_lshl_add_u32 v8, v3, 3, v4
    v_lshl_add_u32 v8, v8, 8, v35
    v_xor_b32 v9, s3, v4
    v_lshl_or_b32 v9, v9, 2, v34
    v_lshl_add_u32 v8, v9, 4, v8
    v_add_u32 v29, 77824, v8
    v_xor_b32 v30, 32, v29
    v_mul_u32_u24 v8, 3072, v3
    v_lshl_add_u32 v8, v4, 7, v8
    v_add_u32 v8, v8, v35
    s_lshl_b32 s48, s3, 1
    v_xor_b32 v9, s48, v34
    v_lshlrev_b32 v10, 1, v4
    v_and_b32 v10, 4, v10
    v_xor_b32 v9, v9, v10
    v_lshl_add_u32 v8, v9, 4, v8
    v_add_u32 v31, 65536, v8
    v_add_u32 v32, 57344, v31
    v_lshlrev_b32 v33, 4, v3
    v_add_u32 v33, 151552, v33
    v_lshlrev_b32 v8, 1, v3
    v_xor_b32 v8, v8, v7
    v_lshlrev_b32 v8, 4, v8
    v_lshl_add_u32 v8, v6, 10, v8
    s_lshl_b32 s48, s45, 7
    s_lshl_b32 s49, s3, 13
    s_add_u32 s48, s48, s49
    v_add_u32 v36, s48, v8
    v_lshl_add_u32 v8, v3, 2, v4
    v_lshl_add_u32 v8, v8, 7, v35
    v_and_b32 v9, 1, v3
    v_lshlrev_b32 v9, 2, v9
    v_and_b32 v10, 2, v4
    v_or_b32 v9, v9, v10
    v_lshrrev_b32 v10, 1, v5
    v_or_b32 v9, v9, v10
    v_lshl_add_u32 v37, v9, 4, v8
    v_lshlrev_b32 v34, 4, v1
    s_mov_b32 s68, 0xbdd2d3e8
    s_mov_b32 s69, 0xc0135761
    s_lshl_b32 s67, s44, 2
    s_add_u32 s67, s67, s3
    s_lshl_b32 s67, s67, 14
    s_add_u32 s67, s67, 9437184
    s_mul_i32 s70, s44, 114688
    s_add_u32 s70, s70, 5242880
    v_mov_b32 v184, 0xbdd2d3e8
    s_lshr_b32 s75, s53, 0
    s_mul_i32 s75, s75, 0
    s_add_u32 s75, s75, s46
    s_and_b32 s76, s3, 1
    s_lshl_b32 s48, s76, 10
    v_add_u32 v204, s48, v34
    s_xor_b32 s77, s67, 16384
    s_lshl_b32 s48, s76, 12
    v_add_u32 v37, s48, v37
    s_lshl_b32 s49, s46, 3
    s_lshl_b32 s50, s3, 1
    s_add_u32 s49, s49, s50
    s_lshl_b32 s49, s49, 16
    s_add_u32 s49, s49, 1048576
    v_add_u32 v186, s49, v34
    v_add_u32 v187, 0x10000, v186
    s_mov_b64 exec, 0
    s_cmp_eq_u32 s3, 0
    s_cbranch_scc1 L_h1
    s_cmp_eq_u32 s3, 1
    s_cbranch_scc1 L_h2
    s_cmp_eq_u32 s3, 2
    s_cbranch_scc1 L_h3
    s_branch L_h4
L_hret:
    s_mov_b64 exec, -1
    s_cmp_lg_u32 s55, 0
    s_cbranch_scc1 L_ghost
    s_add_u32 s51, s47, 2
    s_and_b32 s51, s51, 7
    s_add_u32 m0, s63, 122880
    s_mul_i32 s52, s51, 229376
    s_add_u32 s52, s52, 1792
    buffer_load_dwordx4 v16, s[8:11], s52 offen offset:0 lds
    buffer_load_dwordx4 v17, s[8:11], s52 offen offset:1024 lds
    buffer_load_dwordx4 v18, s[8:11], s52 offen offset:2048 lds
    buffer_load_dwordx4 v19, s[8:11], s52 offen offset:3072 lds
    s_add_u32 m0, s62, 16384
    s_lshl_b32 s51, s51, 7
    buffer_load_dwordx4 v12, s[4:7], s51 offen offset:0 lds
    buffer_load_dwordx4 v13, s[4:7], s51 offen offset:1024 lds
    s_lshl_b32 s74, s46, 2
    s_add_u32 s74, s74, s3
    s_lshl_b32 s74, s74, 10
    s_add_u32 s74, s74, s70
    v_mov_b32 v188, -1
    v_mov_b32 v189, -1
    v_mov_b32 v190, -1
    v_mov_b32 v191, -1
    s_waitcnt vmcnt(12)
    s_barrier
    ds_read_b64_tr_b16 a[16:17], v29 offset:0
    ds_read_b64_tr_b16 a[18:19], v29 offset:1024
    ds_read_b64_tr_b16 a[20:21], v30 offset:0
    ds_read_b64_tr_b16 a[22:23], v30 offset:1024
    ds_read_b128 a[0:3], v14 offset:0
    ds_read_b128 a[4:7], v14 offset:2048
    ds_read_b128 a[8:11], v14 offset:4096
    ds_read_b128 a[12:15], v14 offset:6144
    ds_read_b128 a[24:27], v25 offset:0
    ds_read_b128 a[28:31], v33 offset:0
    ds_read_b64_tr_b16 a[48:49], v29 offset:8192
    ds_read_b64_tr_b16 a[50:51], v29 offset:9216
    ds_read_b64_tr_b16 a[52:53], v30 offset:8192
    ds_read_b64_tr_b16 a[54:55], v30 offset:9216
    ds_read_b128 a[32:35], v15 offset:0
    ds_read_b128 a[36:39], v15 offset:2048
    ds_read_b128 a[40:43], v15 offset:4096
    ds_read_b128 a[44:47], v15 offset:6144
    ds_read_b128 a[56:59], v26 offset:0
    ds_read_b128 a[60:63], v33 offset:64
    s_waitcnt lgkmcnt(0)
    s_waitcnt vmcnt(6)
    s_barrier
    v_mfma_f32_16x16x32_bf16 v[40:43], a[16:19], a[0:3], 0
    s_add_u32 s51, s47, 3
    s_and_b32 s51, s51, 7
    s_add_u32 m0, s63, 77824
    s_mul_i32 s52, s51, 229376
    s_add_u32 s52, s52, 1792
    buffer_load_dwordx4 v16, s[8:11], s52 offen offset:0 lds
    ds_read_b64_tr_b16 a[80:81], v29 offset:16384
    v_mfma_f32_16x16x32_bf16 v[44:47], a[16:19], a[4:7], 0
    ds_read_b64_tr_b16 a[82:83], v29 offset:17408
    ds_read_b64_tr_b16 a[84:85], v30 offset:16384
    v_mfma_f32_16x16x32_bf16 v[48:51], a[16:19], a[8:11], 0
    ds_read_b64_tr_b16 a[86:87], v30 offset:17408
    ds_read_b128 a[64:67], v14 offset:8192
    v_mfma_f32_16x16x32_bf16 v[52:55], a[16:19], a[12:15], 0
    buffer_load_dwordx4 v17, s[8:11], s52 offen offset:1024 lds
    ds_read_b128 a[68:71], v14 offset:10240
    v_mfma_f32_16x16x32_bf16 v[56:59], a[20:23], a[0:3], 0
    ds_read_b128 a[72:75], v14 offset:12288
    ds_read_b128 a[76:79], v14 offset:14336
    v_mfma_f32_16x16x32_bf16 v[60:63], a[20:23], a[4:7], 0
    ds_read_b128 a[88:91], v25 offset:8192
    ds_read_b128 a[92:95], v33 offset:128
    v_mfma_f32_16x16x32_bf16 v[64:67], a[20:23], a[8:11], 0
    buffer_load_dwordx4 v18, s[8:11], s52 offen offset:2048 lds
    ds_read_b64_tr_b16 a[112:113], v29 offset:24576
    v_mfma_f32_16x16x32_bf16 v[68:71], a[20:23], a[12:15], 0
    ds_read_b64_tr_b16 a[114:115], v29 offset:25600
    ds_read_b64_tr_b16 a[116:117], v30 offset:24576
    v_mfma_f32_16x16x32_bf16 v[104:107], a[28:31], a[24:27], 0
    ds_read_b64_tr_b16 a[118:119], v30 offset:25600
    ds_read_b128 a[96:99], v15 offset:8192
    v_mfma_f32_16x16x32_bf16 v[40:43], a[48:51], a[32:35], v[40:43]
    buffer_load_dwordx4 v19, s[8:11], s52 offen offset:3072 lds
    ds_read_b128 a[100:103], v15 offset:10240
    v_mfma_f32_16x16x32_bf16 v[44:47], a[48:51], a[36:39], v[44:47]
    ds_read_b128 a[104:107], v15 offset:12288
    ds_read_b128 a[108:111], v15 offset:14336
    v_mfma_f32_16x16x32_bf16 v[48:51], a[48:51], a[40:43], v[48:51]
    ds_read_b128 a[120:123], v26 offset:8192
    ds_read_b128 a[124:127], v33 offset:192
    v_mfma_f32_16x16x32_bf16 v[52:55], a[48:51], a[44:47], v[52:55]
    s_add_u32 m0, s62, 24576
    s_lshl_b32 s51, s51, 7
    buffer_load_dwordx4 v12, s[4:7], s51 offen offset:0 lds
    v_mfma_f32_16x16x32_bf16 v[56:59], a[52:55], a[32:35], v[56:59]
    v_mfma_f32_16x16x32_bf16 v[60:63], a[52:55], a[36:39], v[60:63]
    v_mfma_f32_16x16x32_bf16 v[64:67], a[52:55], a[40:43], v[64:67]
    buffer_load_dwordx4 v13, s[4:7], s51 offen offset:1024 lds
    v_mfma_f32_16x16x32_bf16 v[68:71], a[52:55], a[44:47], v[68:71]
    v_mfma_f32_16x16x32_bf16 v[104:107], a[60:63], a[56:59], v[104:107]
    s_waitcnt lgkmcnt(0)
    s_waitcnt vmcnt(6)
    s_barrier
    v_mfma_f32_16x16x32_bf16 v[40:43], a[80:83], a[64:67], v[40:43]
    s_add_u32 s51, s47, 4
    s_and_b32 s51, s51, 7
    s_add_u32 m0, s63, 94208
    s_mul_i32 s52, s51, 229376
    s_add_u32 s52, s52, 1792
    buffer_load_dwordx4 v16, s[8:11], s52 offen offset:0 lds
    ds_read_b64_tr_b16 a[16:17], v29 offset:45056
    v_mfma_f32_16x16x32_bf16 v[44:47], a[80:83], a[68:71], v[44:47]
    ds_read_b64_tr_b16 a[18:19], v29 offset:46080
    ds_read_b64_tr_b16 a[20:21], v30 offset:45056
    v_mfma_f32_16x16x32_bf16 v[48:51], a[80:83], a[72:75], v[48:51]
    ds_read_b64_tr_b16 a[22:23], v30 offset:46080
    ds_read_b128 a[0:3], v14 offset:16384
    v_mfma_f32_16x16x32_bf16 v[52:55], a[80:83], a[76:79], v[52:55]
    buffer_load_dwordx4 v17, s[8:11], s52 offen offset:1024 lds
    ds_read_b128 a[4:7], v14 offset:18432
    v_mfma_f32_16x16x32_bf16 v[56:59], a[84:87], a[64:67], v[56:59]
    ds_read_b128 a[8:11], v14 offset:20480
    ds_read_b128 a[12:15], v14 offset:22528
    v_mfma_f32_16x16x32_bf16 v[60:63], a[84:87], a[68:71], v[60:63]
    ds_read_b128 a[24:27], v25 offset:16384
    ds_read_b128 a[28:31], v33 offset:256
    v_mfma_f32_16x16x32_bf16 v[64:67], a[84:87], a[72:75], v[64:67]
    buffer_load_dwordx4 v18, s[8:11], s52 offen offset:2048 lds
    ds_read_b64_tr_b16 a[48:49], v29 offset:53248
    v_mfma_f32_16x16x32_bf16 v[68:71], a[84:87], a[76:79], v[68:71]
    ds_read_b64_tr_b16 a[50:51], v29 offset:54272
    ds_read_b64_tr_b16 a[52:53], v30 offset:53248
    v_mfma_f32_16x16x32_bf16 v[104:107], a[92:95], a[88:91], v[104:107]
    ds_read_b64_tr_b16 a[54:55], v30 offset:54272
    ds_read_b128 a[32:35], v15 offset:16384
    v_mfma_f32_16x16x32_bf16 v[40:43], a[112:115], a[96:99], v[40:43]
    buffer_load_dwordx4 v19, s[8:11], s52 offen offset:3072 lds
    ds_read_b128 a[36:39], v15 offset:18432
    v_mfma_f32_16x16x32_bf16 v[44:47], a[112:115], a[100:103], v[44:47]
    ds_read_b128 a[40:43], v15 offset:20480
    ds_read_b128 a[44:47], v15 offset:22528
    v_mfma_f32_16x16x32_bf16 v[48:51], a[112:115], a[104:107], v[48:51]
    ds_read_b128 a[56:59], v26 offset:16384
    ds_read_b128 a[60:63], v33 offset:320
    v_mfma_f32_16x16x32_bf16 v[52:55], a[112:115], a[108:111], v[52:55]
    s_add_u32 m0, s62, 32768
    s_lshl_b32 s51, s51, 7
    buffer_load_dwordx4 v12, s[4:7], s51 offen offset:0 lds
    v_mfma_f32_16x16x32_bf16 v[56:59], a[116:119], a[96:99], v[56:59]
    v_mfma_f32_16x16x32_bf16 v[60:63], a[116:119], a[100:103], v[60:63]
    v_mfma_f32_16x16x32_bf16 v[64:67], a[116:119], a[104:107], v[64:67]
    buffer_load_dwordx4 v13, s[4:7], s51 offen offset:1024 lds
    v_mfma_f32_16x16x32_bf16 v[68:71], a[116:119], a[108:111], v[68:71]
    v_mfma_f32_16x16x32_bf16 v[104:107], a[124:127], a[120:123], v[104:107]
    s_waitcnt lgkmcnt(0)
    s_waitcnt vmcnt(6)
    s_barrier
    v_mfma_f32_16x16x32_bf16 v[40:43], a[16:19], a[0:3], v[40:43]
    s_add_u32 s51, s47, 5
    s_and_b32 s51, s51, 7
    s_add_u32 m0, s63, 122880
    s_mul_i32 s52, s51, 229376
    s_add_u32 s52, s52, 1792
    buffer_load_dwordx4 v16, s[8:11], s52 offen offset:0 lds
    ds_read_b64_tr_b16 a[80:81], v29 offset:0
    v_mfma_f32_16x16x32_bf16 v[44:47], a[16:19], a[4:7], v[44:47]
    ds_read_b64_tr_b16 a[82:83], v29 offset:1024
    ds_read_b64_tr_b16 a[84:85], v30 offset:0
    v_mfma_f32_16x16x32_bf16 v[48:51], a[16:19], a[8:11], v[48:51]
    ds_read_b64_tr_b16 a[86:87], v30 offset:1024
    ds_read_b128 a[64:67], v14 offset:24576
    v_mfma_f32_16x16x32_bf16 v[52:55], a[16:19], a[12:15], v[52:55]
    buffer_load_dwordx4 v17, s[8:11], s52 offen offset:1024 lds
    ds_read_b128 a[68:71], v14 offset:26624
    v_mfma_f32_16x16x32_bf16 v[56:59], a[20:23], a[0:3], v[56:59]
    ds_read_b128 a[72:75], v14 offset:28672
    ds_read_b128 a[76:79], v14 offset:30720
    v_mfma_f32_16x16x32_bf16 v[60:63], a[20:23], a[4:7], v[60:63]
    ds_read_b128 a[88:91], v25 offset:24576
    ds_read_b128 a[92:95], v33 offset:384
    v_mfma_f32_16x16x32_bf16 v[64:67], a[20:23], a[8:11], v[64:67]
    buffer_load_dwordx4 v18, s[8:11], s52 offen offset:2048 lds
    ds_read_b64_tr_b16 a[112:113], v29 offset:8192
    v_mfma_f32_16x16x32_bf16 v[68:71], a[20:23], a[12:15], v[68:71]
    ds_read_b64_tr_b16 a[114:115], v29 offset:9216
    ds_read_b64_tr_b16 a[116:117], v30 offset:8192
    v_mfma_f32_16x16x32_bf16 v[104:107], a[28:31], a[24:27], v[104:107]
    ds_read_b64_tr_b16 a[118:119], v30 offset:9216
    ds_read_b128 a[96:99], v15 offset:24576
    v_mfma_f32_16x16x32_bf16 v[40:43], a[48:51], a[32:35], v[40:43]
    buffer_load_dwordx4 v19, s[8:11], s52 offen offset:3072 lds
    ds_read_b128 a[100:103], v15 offset:26624
    v_mfma_f32_16x16x32_bf16 v[44:47], a[48:51], a[36:39], v[44:47]
    ds_read_b128 a[104:107], v15 offset:28672
    ds_read_b128 a[108:111], v15 offset:30720
    v_mfma_f32_16x16x32_bf16 v[48:51], a[48:51], a[40:43], v[48:51]
    ds_read_b128 a[120:123], v26 offset:24576
    ds_read_b128 a[124:127], v33 offset:448
    v_mfma_f32_16x16x32_bf16 v[52:55], a[48:51], a[44:47], v[52:55]
    s_add_u32 m0, s62, 40960
    s_lshl_b32 s51, s51, 7
    buffer_load_dwordx4 v12, s[4:7], s51 offen offset:0 lds
    v_mfma_f32_16x16x32_bf16 v[56:59], a[52:55], a[32:35], v[56:59]
    v_mfma_f32_16x16x32_bf16 v[60:63], a[52:55], a[36:39], v[60:63]
    v_mfma_f32_16x16x32_bf16 v[64:67], a[52:55], a[40:43], v[64:67]
    buffer_load_dwordx4 v13, s[4:7], s51 offen offset:1024 lds
    v_mfma_f32_16x16x32_bf16 v[68:71], a[52:55], a[44:47], v[68:71]
    v_mfma_f32_16x16x32_bf16 v[104:107], a[60:63], a[56:59], v[104:107]
    s_waitcnt lgkmcnt(0)
    s_waitcnt vmcnt(6)
    s_barrier
    v_mfma_f32_16x16x32_bf16 v[40:43], a[80:83], a[64:67], v[40:43]
    s_add_u32 s51, s47, 6
    s_and_b32 s51, s51, 7
    s_add_u32 m0, s63, 77824
    s_mul_i32 s52, s51, 229376
    s_add_u32 s52, s52, 1792
    buffer_load_dwordx4 v16, s[8:11], s52 offen offset:0 lds
    ds_read_b64_tr_b16 a[16:17], v29 offset:16384
    v_mfma_f32_16x16x32_bf16 v[44:47], a[80:83], a[68:71], v[44:47]
    ds_read_b64_tr_b16 a[18:19], v29 offset:17408
    ds_read_b64_tr_b16 a[20:21], v30 offset:16384
    v_mfma_f32_16x16x32_bf16 v[48:51], a[80:83], a[72:75], v[48:51]
    ds_read_b64_tr_b16 a[22:23], v30 offset:17408
    ds_read_b128 a[0:3], v14 offset:32768
    v_mfma_f32_16x16x32_bf16 v[52:55], a[80:83], a[76:79], v[52:55]
    buffer_load_dwordx4 v17, s[8:11], s52 offen offset:1024 lds
    ds_read_b128 a[4:7], v14 offset:34816
    v_mfma_f32_16x16x32_bf16 v[56:59], a[84:87], a[64:67], v[56:59]
    ds_read_b128 a[8:11], v14 offset:36864
    ds_read_b128 a[12:15], v14 offset:38912
    v_mfma_f32_16x16x32_bf16 v[60:63], a[84:87], a[68:71], v[60:63]
    ds_read_b128 a[24:27], v25 offset:32768
    ds_read_b128 a[28:31], v33 offset:512
    v_mfma_f32_16x16x32_bf16 v[64:67], a[84:87], a[72:75], v[64:67]
    buffer_load_dwordx4 v18, s[8:11], s52 offen offset:2048 lds
    ds_read_b64_tr_b16 a[48:49], v29 offset:24576
    v_mfma_f32_16x16x32_bf16 v[68:71], a[84:87], a[76:79], v[68:71]
    ds_read_b64_tr_b16 a[50:51], v29 offset:25600
    ds_read_b64_tr_b16 a[52:53], v30 offset:24576
    v_mfma_f32_16x16x32_bf16 v[104:107], a[92:95], a[88:91], v[104:107]
    ds_read_b64_tr_b16 a[54:55], v30 offset:25600
    ds_read_b128 a[32:35], v15 offset:32768
    v_mfma_f32_16x16x32_bf16 v[40:43], a[112:115], a[96:99], v[40:43]
    buffer_load_dwordx4 v19, s[8:11], s52 offen offset:3072 lds
    ds_read_b128 a[36:39], v15 offset:34816
    v_mfma_f32_16x16x32_bf16 v[44:47], a[112:115], a[100:103], v[44:47]
    ds_read_b128 a[40:43], v15 offset:36864
    ds_read_b128 a[44:47], v15 offset:38912
    v_mfma_f32_16x16x32_bf16 v[48:51], a[112:115], a[104:107], v[48:51]
    ds_read_b128 a[56:59], v26 offset:32768
    ds_read_b128 a[60:63], v33 offset:576
    v_mfma_f32_16x16x32_bf16 v[52:55], a[112:115], a[108:111], v[52:55]
    s_add_u32 m0, s62, 49152
    s_lshl_b32 s51, s51, 7
    buffer_load_dwordx4 v12, s[4:7], s51 offen offset:0 lds
    v_mfma_f32_16x16x32_bf16 v[56:59], a[116:119], a[96:99], v[56:59]
    v_mfma_f32_16x16x32_bf16 v[60:63], a[116:119], a[100:103], v[60:63]
    v_mfma_f32_16x16x32_bf16 v[64:67], a[116:119], a[104:107], v[64:67]
    buffer_load_dwordx4 v13, s[4:7], s51 offen offset:1024 lds
    v_mfma_f32_16x16x32_bf16 v[68:71], a[116:119], a[108:111], v[68:71]
    v_mfma_f32_16x16x32_bf16 v[104:107], a[124:127], a[120:123], v[104:107]
    s_waitcnt lgkmcnt(0)
    s_waitcnt vmcnt(6)
    s_barrier
    v_mfma_f32_16x16x32_bf16 v[40:43], a[16:19], a[0:3], v[40:43]
    s_add_u32 s51, s47, 7
    s_and_b32 s51, s51, 7
    s_add_u32 m0, s63, 94208
    s_mul_i32 s52, s51, 229376
    s_add_u32 s52, s52, 1792
    buffer_load_dwordx4 v16, s[8:11], s52 offen offset:0 lds
    ds_read_b64_tr_b16 a[80:81], v29 offset:45056
    v_mfma_f32_16x16x32_bf16 v[44:47], a[16:19], a[4:7], v[44:47]
    ds_read_b64_tr_b16 a[82:83], v29 offset:46080
    ds_read_b64_tr_b16 a[84:85], v30 offset:45056
    v_mfma_f32_16x16x32_bf16 v[48:51], a[16:19], a[8:11], v[48:51]
    ds_read_b64_tr_b16 a[86:87], v30 offset:46080
    ds_read_b128 a[64:67], v14 offset:40960
    v_mfma_f32_16x16x32_bf16 v[52:55], a[16:19], a[12:15], v[52:55]
    buffer_load_dwordx4 v17, s[8:11], s52 offen offset:1024 lds
    ds_read_b128 a[68:71], v14 offset:43008
    v_mfma_f32_16x16x32_bf16 v[56:59], a[20:23], a[0:3], v[56:59]
    ds_read_b128 a[72:75], v14 offset:45056
    ds_read_b128 a[76:79], v14 offset:47104
    v_mfma_f32_16x16x32_bf16 v[60:63], a[20:23], a[4:7], v[60:63]
    ds_read_b128 a[88:91], v25 offset:40960
    ds_read_b128 a[92:95], v33 offset:640
    v_mfma_f32_16x16x32_bf16 v[64:67], a[20:23], a[8:11], v[64:67]
    buffer_load_dwordx4 v18, s[8:11], s52 offen offset:2048 lds
    ds_read_b64_tr_b16 a[112:113], v29 offset:53248
    v_mfma_f32_16x16x32_bf16 v[68:71], a[20:23], a[12:15], v[68:71]
    ds_read_b64_tr_b16 a[114:115], v29 offset:54272
    ds_read_b64_tr_b16 a[116:117], v30 offset:53248
    v_mfma_f32_16x16x32_bf16 v[104:107], a[28:31], a[24:27], v[104:107]
    ds_read_b64_tr_b16 a[118:119], v30 offset:54272
    ds_read_b128 a[96:99], v15 offset:40960
    v_mfma_f32_16x16x32_bf16 v[40:43], a[48:51], a[32:35], v[40:43]
    buffer_load_dwordx4 v19, s[8:11], s52 offen offset:3072 lds
    ds_read_b128 a[100:103], v15 offset:43008
    v_mfma_f32_16x16x32_bf16 v[44:47], a[48:51], a[36:39], v[44:47]
    ds_read_b128 a[104:107], v15 offset:45056
    ds_read_b128 a[108:111], v15 offset:47104
    v_mfma_f32_16x16x32_bf16 v[48:51], a[48:51], a[40:43], v[48:51]
    ds_read_b128 a[120:123], v26 offset:40960
    ds_read_b128 a[124:127], v33 offset:704
    v_mfma_f32_16x16x32_bf16 v[52:55], a[48:51], a[44:47], v[52:55]
    s_add_u32 m0, s62, 57344
    s_lshl_b32 s51, s51, 7
    buffer_load_dwordx4 v12, s[4:7], s51 offen offset:0 lds
    v_mfma_f32_16x16x32_bf16 v[56:59], a[52:55], a[32:35], v[56:59]
    v_mfma_f32_16x16x32_bf16 v[60:63], a[52:55], a[36:39], v[60:63]
    v_mfma_f32_16x16x32_bf16 v[64:67], a[52:55], a[40:43], v[64:67]
    buffer_load_dwordx4 v13, s[4:7], s51 offen offset:1024 lds
    v_mfma_f32_16x16x32_bf16 v[68:71], a[52:55], a[44:47], v[68:71]
    v_mfma_f32_16x16x32_bf16 v[104:107], a[60:63], a[56:59], v[104:107]
    s_waitcnt lgkmcnt(0)
    s_waitcnt vmcnt(6)
    s_barrier
    v_mfma_f32_16x16x32_bf16 v[40:43], a[80:83], a[64:67], v[40:43]
    s_add_u32 s51, s47, 0
    s_and_b32 s51, s51, 7
    s_add_u32 m0, s63, 122880
    s_mul_i32 s52, s51, 229376
    buffer_load_dwordx4 v16, s[8:11], s52 offen offset:0 lds
    ds_read_b64_tr_b16 a[16:17], v29 offset:0
    v_mfma_f32_16x16x32_bf16 v[44:47], a[80:83], a[68:71], v[44:47]
    ds_read_b64_tr_b16 a[18:19], v29 offset:1024
    ds_read_b64_tr_b16 a[20:21], v30 offset:0
    v_mfma_f32_16x16x32_bf16 v[48:51], a[80:83], a[72:75], v[48:51]
    ds_read_b64_tr_b16 a[22:23], v30 offset:1024
    ds_read_b128 a[0:3], v14 offset:49152
    v_mfma_f32_16x16x32_bf16 v[52:55], a[80:83], a[76:79], v[52:55]
    ds_read_b128 a[4:7], v14 offset:51200
    v_mfma_f32_16x16x32_bf16 v[56:59], a[84:87], a[64:67], v[56:59]
    buffer_load_dwordx4 v17, s[8:11], s52 offen offset:1024 lds
    ds_read_b128 a[8:11], v14 offset:53248
    ds_read_b128 a[12:15], v14 offset:55296
    v_mfma_f32_16x16x32_bf16 v[60:63], a[84:87], a[68:71], v[60:63]
    ds_read_b128 a[24:27], v25 offset:49152
    ds_read_b128 a[28:31], v33 offset:768
    v_mfma_f32_16x16x32_bf16 v[64:67], a[84:87], a[72:75], v[64:67]
    ds_read_b64_tr_b16 a[48:49], v29 offset:8192
    v_mfma_f32_16x16x32_bf16 v[68:71], a[84:87], a[76:79], v[68:71]
    ds_read_b64_tr_b16 a[50:51], v29 offset:9216
    ds_read_b64_tr_b16 a[52:53], v30 offset:8192
    v_mfma_f32_16x16x32_bf16 v[104:107], a[92:95], a[88:91], v[104:107]
    ds_read_b64_tr_b16 a[54:55], v30 offset:9216
    ds_read_b128 a[32:35], v15 offset:49152
    v_mfma_f32_16x16x32_bf16 v[40:43], a[112:115], a[96:99], v[40:43]
    buffer_load_dwordx4 v18, s[8:11], s52 offen offset:2048 lds
    ds_read_b128 a[36:39], v15 offset:51200
    v_mfma_f32_16x16x32_bf16 v[44:47], a[112:115], a[100:103], v[44:47]
    ds_read_b128 a[40:43], v15 offset:53248
    ds_read_b128 a[44:47], v15 offset:55296
    v_mfma_f32_16x16x32_bf16 v[48:51], a[112:115], a[104:107], v[48:51]
    ds_read_b128 a[56:59], v26 offset:49152
    ds_read_b128 a[60:63], v33 offset:832
    v_mfma_f32_16x16x32_bf16 v[52:55], a[112:115], a[108:111], v[52:55]
    v_mfma_f32_16x16x32_bf16 v[56:59], a[116:119], a[96:99], v[56:59]
    buffer_load_dwordx4 v19, s[8:11], s52 offen offset:3072 lds
    v_mfma_f32_16x16x32_bf16 v[60:63], a[116:119], a[100:103], v[60:63]
    v_mfma_f32_16x16x32_bf16 v[64:67], a[116:119], a[104:107], v[64:67]
    v_mfma_f32_16x16x32_bf16 v[68:71], a[116:119], a[108:111], v[68:71]
    v_mfma_f32_16x16x32_bf16 v[104:107], a[124:127], a[120:123], v[104:107]
L_h1:
    s_cbranch_execz L_h5
    s_waitcnt lgkmcnt(0)
    s_waitcnt vmcnt(4)
    s_barrier
    v_mfma_f32_16x16x32_bf16 v[40:43], a[16:19], a[0:3], v[40:43]
    s_add_u32 s51, s47, 1
    s_and_b32 s51, s51, 7
    s_add_u32 m0, s63, 77824
    s_mul_i32 s52, s51, 229376
    buffer_load_dwordx4 v16, s[8:11], s52 offen offset:0 lds
    ds_read_b64_tr_b16 a[80:81], v29 offset:16384
    v_mfma_f32_16x16x32_bf16 v[44:47], a[16:19], a[4:7], v[44:47]
    ds_read_b64_tr_b16 a[82:83], v29 offset:17408
    ds_read_b64_tr_b16 a[84:85], v30 offset:16384
    v_mfma_f32_16x16x32_bf16 v[48:51], a[16:19], a[8:11], v[48:51]
    ds_read_b64_tr_b16 a[86:87], v30 offset:17408
    ds_read_b128 a[64:67], v14 offset:57344
    v_mfma_f32_16x16x32_bf16 v[52:55], a[16:19], a[12:15], v[52:55]
    ds_read_b128 a[68:71], v14 offset:59392
    v_mfma_f32_16x16x32_bf16 v[56:59], a[20:23], a[0:3], v[56:59]
    buffer_load_dwordx4 v17, s[8:11], s52 offen offset:1024 lds
    ds_read_b128 a[72:75], v14 offset:61440
    ds_read_b128 a[76:79], v14 offset:63488
    v_mfma_f32_16x16x32_bf16 v[60:63], a[20:23], a[4:7], v[60:63]
    ds_read_b128 a[88:91], v25 offset:57344
    ds_read_b128 a[92:95], v33 offset:896
    v_mfma_f32_16x16x32_bf16 v[64:67], a[20:23], a[8:11], v[64:67]
    ds_read_b64_tr_b16 a[112:113], v29 offset:24576
    v_mfma_f32_16x16x32_bf16 v[68:71], a[20:23], a[12:15], v[68:71]
    ds_read_b64_tr_b16 a[114:115], v29 offset:25600
    ds_read_b64_tr_b16 a[116:117], v30 offset:24576
    v_mfma_f32_16x16x32_bf16 v[104:107], a[28:31], a[24:27], v[104:107]
    ds_read_b64_tr_b16 a[118:119], v30 offset:25600
    ds_read_b128 a[96:99], v15 offset:57344
    v_mfma_f32_16x16x32_bf16 v[40:43], a[48:51], a[32:35], v[40:43]
    buffer_load_dwordx4 v18, s[8:11], s52 offen offset:2048 lds
    ds_read_b128 a[100:103], v15 offset:59392
    v_mfma_f32_16x16x32_bf16 v[44:47], a[48:51], a[36:39], v[44:47]
    ds_read_b128 a[104:107], v15 offset:61440
    ds_read_b128 a[108:111], v15 offset:63488
    v_mfma_f32_16x16x32_bf16 v[48:51], a[48:51], a[40:43], v[48:51]
    ds_read_b128 a[120:123], v26 offset:57344
    ds_read_b128 a[124:127], v33 offset:960
    v_mfma_f32_16x16x32_bf16 v[52:55], a[48:51], a[44:47], v[52:55]
    v_mfma_f32_16x16x32_bf16 v[56:59], a[52:55], a[32:35], v[56:59]
    buffer_load_dwordx4 v19, s[8:11], s52 offen offset:3072 lds
    v_mfma_f32_16x16x32_bf16 v[60:63], a[52:55], a[36:39], v[60:63]
    v_mfma_f32_16x16x32_bf16 v[64:67], a[52:55], a[40:43], v[64:67]
    v_mfma_f32_16x16x32_bf16 v[68:71], a[52:55], a[44:47], v[68:71]
    v_mfma_f32_16x16x32_bf16 v[104:107], a[60:63], a[56:59], v[104:107]
    s_waitcnt lgkmcnt(0)
    s_waitcnt vmcnt(4)
    s_barrier
    v_mfma_f32_16x16x32_bf16 v[40:43], a[80:83], a[64:67], v[40:43]
    s_add_u32 s51, s47, 2
    s_and_b32 s51, s51, 7
    s_add_u32 m0, s63, 94208
    s_mul_i32 s52, s51, 229376
    buffer_load_dwordx4 v16, s[8:11], s52 offen offset:0 lds
    ds_read_b64_tr_b16 a[16:17], v29 offset:45056
    v_mfma_f32_16x16x32_bf16 v[44:47], a[80:83], a[68:71], v[44:47]
    ds_read_b64_tr_b16 a[18:19], v29 offset:46080
    v_mfma_f32_16x16x32_bf16 v[48:51], a[80:83], a[72:75], v[48:51]
    ds_read_b64_tr_b16 a[20:21], v30 offset:45056
    ds_read_b64_tr_b16 a[22:23], v30 offset:46080
    v_mfma_f32_16x16x32_bf16 v[52:55], a[80:83], a[76:79], v[52:55]
    ds_read_b128 a[0:3], v14 offset:0
    v_mfma_f32_16x16x32_bf16 v[56:59], a[84:87], a[64:67], v[56:59]
    buffer_load_dwordx4 v17, s[8:11], s52 offen offset:1024 lds
    ds_read_b128 a[4:7], v14 offset:2048
    v_mfma_f32_16x16x32_bf16 v[60:63], a[84:87], a[68:71], v[60:63]
    ds_read_b128 a[8:11], v14 offset:4096
    ds_read_b128 a[12:15], v14 offset:6144
    v_mfma_f32_16x16x32_bf16 v[64:67], a[84:87], a[72:75], v[64:67]
    ds_read_b64_tr_b16 a[48:49], v29 offset:53248
    v_mfma_f32_16x16x32_bf16 v[68:71], a[84:87], a[76:79], v[68:71]
    ds_read_b64_tr_b16 a[50:51], v29 offset:54272
    v_mfma_f32_16x16x32_bf16 v[104:107], a[92:95], a[88:91], v[104:107]
    ds_read_b64_tr_b16 a[52:53], v30 offset:53248
    ds_read_b64_tr_b16 a[54:55], v30 offset:54272
    v_mfma_f32_16x16x32_bf16 v[40:43], a[112:115], a[96:99], v[40:43]
    buffer_load_dwordx4 v18, s[8:11], s52 offen offset:2048 lds
    ds_read_b128 a[32:35], v15 offset:0
    v_mfma_f32_16x16x32_bf16 v[44:47], a[112:115], a[100:103], v[44:47]
    ds_read_b128 a[36:39], v15 offset:2048
    v_mfma_f32_16x16x32_bf16 v[48:51], a[112:115], a[104:107], v[48:51]
    ds_read_b128 a[40:43], v15 offset:4096
    ds_read_b128 a[44:47], v15 offset:6144
    v_mfma_f32_16x16x32_bf16 v[52:55], a[112:115], a[108:111], v[52:55]
    v_mfma_f32_16x16x32_bf16 v[56:59], a[116:119], a[96:99], v[56:59]
    buffer_load_dwordx4 v19, s[8:11], s52 offen offset:3072 lds
    v_mfma_f32_16x16x32_bf16 v[60:63], a[116:119], a[100:103], v[60:63]
    v_mfma_f32_16x16x32_bf16 v[64:67], a[116:119], a[104:107], v[64:67]
    v_mfma_f32_16x16x32_bf16 v[68:71], a[116:119], a[108:111], v[68:71]
    v_mfma_f32_16x16x32_bf16 v[104:107], a[124:127], a[120:123], v[104:107]
    s_add_u32 s56, s56, 0x7f4a7c15
    s_addc_u32 s57, s57, 0x9e3779b9
    v_mov_b32 v172, s56
    v_mov_b32 v173, s57
    v_pk_mul_f32 v[206:207], v[40:41], v[40:41]
    v_pk_mul_f32 v[208:209], v[42:43], v[42:43]
    v_pk_mul_f32 v[210:211], v[44:45], v[44:45]
    v_pk_mul_f32 v[212:213], v[46:47], v[46:47]
    s_add_u32 s71, s75, 0
    s_and_b32 s71, s71, 7
    s_lshl_b32 s71, s71, 7
    s_add_u32 s71, s71, 3072
    buffer_load_dwordx4 a[192:195], v23, s[24:27], s71 offen offset:0
    v_pk_mul_f32 v[214:215], v[48:49], v[48:49]
    v_pk_mul_f32 v[216:217], v[50:51], v[50:51]
    v_pk_mul_f32 v[218:219], v[52:53], v[52:53]
    v_pk_mul_f32 v[220:221], v[54:55], v[54:55]
    buffer_load_dwordx4 a[196:199], v24, s[24:27], s71 offen offset:1024
    v_pk_mul_f32 v[222:223], v[56:57], v[56:57]
    v_pk_mul_f32 v[224:225], v[58:59], v[58:59]
    v_pk_mul_f32 v[226:227], v[60:61], v[60:61]
    v_pk_mul_f32 v[228:229], v[62:63], v[62:63]
    s_add_u32 s71, s75, 1
    s_and_b32 s71, s71, 7
    s_lshl_b32 s71, s71, 7
    s_add_u32 s71, s71, 3072
    buffer_load_dwordx4 a[200:203], v23, s[24:27], s71 offen offset:0
    v_pk_mul_f32 v[230:231], v[64:65], v[64:65]
    v_pk_mul_f32 v[232:233], v[66:67], v[66:67]
    v_pk_mul_f32 v[234:235], v[68:69], v[68:69]
    v_pk_mul_f32 v[236:237], v[70:71], v[70:71]
    buffer_load_dwordx4 a[204:207], v24, s[24:27], s71 offen offset:1024
    v_pk_fma_f32 v[206:207], v[206:207], s[68:69], s[68:69] op_sel:[0,0,1] op_sel_hi:[1,0,1]
    v_pk_fma_f32 v[208:209], v[208:209], s[68:69], s[68:69] op_sel:[0,0,1] op_sel_hi:[1,0,1]
    v_pk_fma_f32 v[210:211], v[210:211], s[68:69], s[68:69] op_sel:[0,0,1] op_sel_hi:[1,0,1]
    v_pk_fma_f32 v[212:213], v[212:213], s[68:69], s[68:69] op_sel:[0,0,1] op_sel_hi:[1,0,1]
    v_pk_fma_f32 v[214:215], v[214:215], s[68:69], s[68:69] op_sel:[0,0,1] op_sel_hi:[1,0,1]
    v_pk_fma_f32 v[216:217], v[216:217], s[68:69], s[68:69] op_sel:[0,0,1] op_sel_hi:[1,0,1]
    v_pk_fma_f32 v[218:219], v[218:219], s[68:69], s[68:69] op_sel:[0,0,1] op_sel_hi:[1,0,1]
    v_pk_fma_f32 v[220:221], v[220:221], s[68:69], s[68:69] op_sel:[0,0,1] op_sel_hi:[1,0,1]
    v_pk_fma_f32 v[222:223], v[222:223], s[68:69], s[68:69] op_sel:[0,0,1] op_sel_hi:[1,0,1]
    v_pk_fma_f32 v[224:225], v[224:225], s[68:69], s[68:69] op_sel:[0,0,1] op_sel_hi:[1,0,1]
    v_pk_fma_f32 v[226:227], v[226:227], s[68:69], s[68:69] op_sel:[0,0,1] op_sel_hi:[1,0,1]
    v_pk_fma_f32 v[228:229], v[228:229], s[68:69], s[68:69] op_sel:[0,0,1] op_sel_hi:[1,0,1]
    v_pk_fma_f32 v[230:231], v[230:231], s[68:69], s[68:69] op_sel:[0,0,1] op_sel_hi:[1,0,1]
    v_pk_fma_f32 v[232:233], v[232:233], s[68:69], s[68:69] op_sel:[0,0,1] op_sel_hi:[1,0,1]
    v_pk_fma_f32 v[234:235], v[234:235], s[68:69], s[68:69] op_sel:[0,0,1] op_sel_hi:[1,0,1]
    v_pk_fma_f32 v[236:237], v[236:237], s[68:69], s[68:69] op_sel:[0,0,1] op_sel_hi:[1,0,1]
    v_pk_mul_f32 v[206:207], v[206:207], v[40:41]
    v_pk_mul_f32 v[208:209], v[208:209], v[42:43]
    v_pk_mul_f32 v[210:211], v[210:211], v[44:45]
    v_pk_mul_f32 v[212:213], v[212:213], v[46:47]
    v_pk_mul_f32 v[214:215], v[214:215], v[48:49]
    v_pk_mul_f32 v[216:217], v[216:217], v[50:51]
    v_pk_mul_f32 v[218:219], v[218:219], v[52:53]
    v_pk_mul_f32 v[220:221], v[220:221], v[54:55]
    v_pk_mul_f32 v[222:223], v[222:223], v[56:57]
    v_pk_mul_f32 v[224:225], v[224:225], v[58:59]
    v_pk_mul_f32 v[226:227], v[226:227], v[60:61]
    v_pk_mul_f32 v[228:229], v[228:229], v[62:63]
    v_pk_mul_f32 v[230:231], v[230:231], v[64:65]
    v_pk_mul_f32 v[232:233], v[232:233], v[66:67]
    v_pk_mul_f32 v[234:235], v[234:235], v[68:69]
    v_pk_mul_f32 v[236:237], v[236:237], v[70:71]
    v_exp_f32 v206, v206
    v_exp_f32 v207, v207
    v_exp_f32 v208, v208
    v_exp_f32 v209, v209
    v_exp_f32 v210, v210
    v_exp_f32 v211, v211
    v_exp_f32 v212, v212
    v_exp_f32 v213, v213
    v_exp_f32 v214, v214
    v_exp_f32 v215, v215
    v_exp_f32 v216, v216
    v_exp_f32 v217, v217
    v_exp_f32 v218, v218
    v_exp_f32 v219, v219
    v_exp_f32 v220, v220
    v_exp_f32 v221, v221
    v_exp_f32 v222, v222
    v_exp_f32 v223, v223
    v_exp_f32 v224, v224
    v_exp_f32 v225, v225
    v_exp_f32 v226, v226
    v_exp_f32 v227, v227
    v_exp_f32 v228, v228
    v_exp_f32 v229, v229
    v_exp_f32 v230, v230
    v_exp_f32 v231, v231
    v_exp_f32 v232, v232
    v_exp_f32 v233, v233
    v_exp_f32 v234, v234
    v_exp_f32 v235, v235
    v_exp_f32 v236, v236
    v_exp_f32 v237, v237
    v_pk_add_f32 v[206:207], v[206:207], 1.0 op_sel_hi:[1,0]
    v_pk_add_f32 v[208:209], v[208:209], 1.0 op_sel_hi:[1,0]
    v_pk_add_f32 v[210:211], v[210:211], 1.0 op_sel_hi:[1,0]
    v_pk_add_f32 v[212:213], v[212:213], 1.0 op_sel_hi:[1,0]
    v_pk_add_f32 v[214:215], v[214:215], 1.0 op_sel_hi:[1,0]
    v_pk_add_f32 v[216:217], v[216:217], 1.0 op_sel_hi:[1,0]
    v_pk_add_f32 v[218:219], v[218:219], 1.0 op_sel_hi:[1,0]
    v_pk_add_f32 v[220:221], v[220:221], 1.0 op_sel_hi:[1,0]
    v_pk_add_f32 v[222:223], v[222:223], 1.0 op_sel_hi:[1,0]
    v_pk_add_f32 v[224:225], v[224:225], 1.0 op_sel_hi:[1,0]
    v_pk_add_f32 v[226:227], v[226:227], 1.0 op_sel_hi:[1,0]
    v_pk_add_f32 v[228:229], v[228:229], 1.0 op_sel_hi:[1,0]
    v_pk_add_f32 v[230:231], v[230:231], 1.0 op_sel_hi:[1,0]
    v_pk_add_f32 v[232:233], v[232:233], 1.0 op_sel_hi:[1,0]
    v_pk_add_f32 v[234:235], v[234:235], 1.0 op_sel_hi:[1,0]
    v_pk_add_f32 v[236:237], v[236:237], 1.0 op_sel_hi:[1,0]
    v_rcp_f32 v206, v206
    v_rcp_f32 v207, v207
    v_rcp_f32 v208, v208
    v_rcp_f32 v209, v209
    v_rcp_f32 v210, v210
    v_rcp_f32 v211, v211
    v_rcp_f32 v212, v212
    v_rcp_f32 v213, v213
    v_rcp_f32 v214, v214
    v_rcp_f32 v215, v215
    v_rcp_f32 v216, v216
    v_rcp_f32 v217, v217
    v_rcp_f32 v218, v218
    v_rcp_f32 v219, v219
    v_rcp_f32 v220, v220
    v_rcp_f32 v221, v221
    v_rcp_f32 v222, v222
    v_rcp_f32 v223, v223
    v_rcp_f32 v224, v224
    v_rcp_f32 v225, v225
    v_rcp_f32 v226, v226
    v_rcp_f32 v227, v227
    v_rcp_f32 v228, v228
    v_rcp_f32 v229, v229
    v_rcp_f32 v230, v230
    v_rcp_f32 v231, v231
    v_rcp_f32 v232, v232
    v_rcp_f32 v233, v233
    v_rcp_f32 v234, v234
    v_rcp_f32 v235, v235
    v_rcp_f32 v236, v236
    v_rcp_f32 v237, v237
    v_pk_mul_f32 v[40:41], v[40:41], v[206:207]
    v_pk_mul_f32 v[42:43], v[42:43], v[208:209]
    v_pk_mul_f32 v[44:45], v[44:45], v[210:211]
    v_pk_mul_f32 v[46:47], v[46:47], v[212:213]
    v_pk_mul_f32 v[48:49], v[48:49], v[214:215]
    v_pk_mul_f32 v[50:51], v[50:51], v[216:217]
    v_pk_mul_f32 v[52:53], v[52:53], v[218:219]
    v_pk_mul_f32 v[54:55], v[54:55], v[220:221]
    v_pk_mul_f32 v[56:57], v[56:57], v[222:223]
    v_pk_mul_f32 v[58:59], v[58:59], v[224:225]
    v_pk_mul_f32 v[60:61], v[60:61], v[226:227]
    v_pk_mul_f32 v[62:63], v[62:63], v[228:229]
    v_pk_mul_f32 v[64:65], v[64:65], v[230:231]
    v_pk_mul_f32 v[66:67], v[66:67], v[232:233]
    v_pk_mul_f32 v[68:69], v[68:69], v[234:235]
    v_pk_mul_f32 v[70:71], v[70:71], v[236:237]
    v_pk_add_f32 v[206:207], v[40:41], v[42:43]
    v_pk_add_f32 v[214:215], v[56:57], v[58:59]
    v_pk_mul_f32 v[222:223], v[40:41], v[40:41]
    v_pk_add_f32 v[208:209], v[44:45], v[46:47]
    v_pk_add_f32 v[216:217], v[60:61], v[62:63]
    v_pk_mul_f32 v[224:225], v[44:45], v[44:45]
    v_pk_add_f32 v[210:211], v[48:49], v[50:51]
    v_pk_add_f32 v[218:219], v[64:65], v[66:67]
    v_pk_mul_f32 v[226:227], v[48:49], v[48:49]
    v_pk_add_f32 v[212:213], v[52:53], v[54:55]
    v_pk_add_f32 v[220:221], v[68:69], v[70:71]
    v_pk_mul_f32 v[228:229], v[52:53], v[52:53]
    v_pk_fma_f32 v[222:223], v[42:43], v[42:43], v[222:223]
    v_pk_fma_f32 v[224:225], v[46:47], v[46:47], v[224:225]
    v_pk_fma_f32 v[226:227], v[50:51], v[50:51], v[226:227]
    v_pk_fma_f32 v[228:229], v[54:55], v[54:55], v[228:229]
    v_pk_fma_f32 v[222:223], v[56:57], v[56:57], v[222:223]
    v_pk_fma_f32 v[224:225], v[60:61], v[60:61], v[224:225]
    v_pk_fma_f32 v[226:227], v[64:65], v[64:65], v[226:227]
    v_pk_fma_f32 v[228:229], v[68:69], v[68:69], v[228:229]
    v_pk_fma_f32 v[222:223], v[58:59], v[58:59], v[222:223]
    v_pk_fma_f32 v[224:225], v[62:63], v[62:63], v[224:225]
    v_pk_fma_f32 v[226:227], v[66:67], v[66:67], v[226:227]
    v_pk_fma_f32 v[228:229], v[70:71], v[70:71], v[228:229]
    v_pk_add_f32 v[206:207], v[206:207], v[214:215]
    v_pk_add_f32 v[208:209], v[208:209], v[216:217]
    v_pk_add_f32 v[210:211], v[210:211], v[218:219]
    v_pk_add_f32 v[212:213], v[212:213], v[220:221]
    v_add_f32 v222, v222, v223
    v_add_f32 v224, v224, v225
    v_add_f32 v226, v226, v227
    v_add_f32 v228, v228, v229
    v_add_f32 v206, v206, v207
    v_add_f32 v208, v208, v209
    v_add_f32 v210, v210, v211
    v_add_f32 v212, v212, v213
    s_lshl_b32 s48, s3, 9
    s_add_u32 s48, s48, 160768
    v_lshl_add_u32 v35, v1, 3, s48
    v_permlane32_swap_b32 v222, v226
    v_permlane32_swap_b32 v224, v228
    v_permlane32_swap_b32 v206, v210
    v_permlane32_swap_b32 v208, v212
    v_add_f32 v222, v222, v226
    v_add_f32 v224, v224, v228
    v_add_f32 v206, v206, v210
    v_add_f32 v208, v208, v212
    v_permlane16_swap_b32 v222, v224
    s_nop 0
    v_permlane16_swap_b32 v206, v208
    v_add_f32 v165, v222, v224
    v_add_f32 v164, v206, v208
    ds_write_b64 v35, v[164:165]
    s_lshl_b32 s48, s3, 7
    s_add_u32 s48, s48, 160768
    v_lshlrev_b32 v35, 9, v3
    v_lshl_add_u32 v35, v2, 3, v35
    v_add_u32 v35, s48, v35
    s_lshl_b32 s48, s3, 8
    v_lshl_add_u32 v38, v2, 4, s48
    s_waitcnt lgkmcnt(0)
    s_waitcnt vmcnt(8)
    s_barrier
    v_mfma_f32_16x16x32_bf16 v[72:75], a[16:19], a[0:3], 0
    s_add_u32 s51, s47, 3
    s_and_b32 s51, s51, 7
    s_add_u32 m0, s63, 122880
    s_mul_i32 s52, s51, 229376
    buffer_load_dwordx4 v16, s[8:11], s52 offen offset:0 lds
    ds_read_b64_tr_b16 a[80:81], v29 offset:0
    ds_read_b64 v[164:165], v35
    v_mov_b32 v166, s56
    v_mov_b32 v167, s57
    v_mfma_f32_16x16x32_bf16 v[76:79], a[16:19], a[4:7], 0
    ds_read_b64_tr_b16 a[82:83], v29 offset:1024
    ds_read_b64_tr_b16 a[84:85], v30 offset:0
    s_lshl_b32 s48, s44, 3
    s_add_u32 s48, s48, s46
    v_mfma_f32_16x16x32_bf16 v[80:83], a[16:19], a[8:11], 0
    buffer_load_dwordx4 v17, s[8:11], s52 offen offset:1024 lds
    ds_read_b64_tr_b16 a[86:87], v30 offset:1024
    s_lshl_b32 s48, s48, 10
    s_add_u32 s48, s48, 65536
    v_mfma_f32_16x16x32_bf16 v[84:87], a[16:19], a[12:15], 0
    ds_read_b128 a[64:67], v14 offset:8192
    ds_read_b128 a[68:71], v14 offset:10240
    s_waitcnt lgkmcnt(5)
    v_mov_b32 v168, v164
    v_mfma_f32_16x16x32_bf16 v[88:91], a[20:23], a[0:3], 0
    ds_read_b128 a[72:75], v14 offset:12288
    v_mov_b32 v169, v165
    v_permlane32_swap_b32 v164, v168
    v_mfma_f32_16x16x32_bf16 v[92:95], a[20:23], a[4:7], 0
    buffer_load_dwordx4 v18, s[8:11], s52 offen offset:2048 lds
    ds_read_b128 a[76:79], v14 offset:14336
    ds_read_b64_tr_b16 a[112:113], v29 offset:8192
    v_permlane32_swap_b32 v165, v169
    v_add_f32 v164, v164, v168
    v_add_f32 v165, v165, v169
    v_mfma_f32_16x16x32_bf16 v[96:99], a[20:23], a[8:11], 0
    ds_read_b64_tr_b16 a[114:115], v29 offset:9216
    v_mov_b32 v168, v164
    v_mov_b32 v169, v165
    v_mfma_f32_16x16x32_bf16 v[100:103], a[20:23], a[12:15], 0
    ds_read_b64_tr_b16 a[116:117], v30 offset:8192
    ds_read_b64_tr_b16 a[118:119], v30 offset:9216
    v_permlane16_swap_b32 v164, v168
    v_permlane16_swap_b32 v165, v169
    v_mfma_f32_16x16x32_bf16 v[72:75], a[48:51], a[32:35], v[72:75]
    buffer_load_dwordx4 v19, s[8:11], s52 offen offset:3072 lds
    ds_read_b128 a[96:99], v15 offset:8192
    v_add_f32 v164, v164, v168
    v_add_f32 v165, v165, v169
    v_mfma_f32_16x16x32_bf16 v[76:79], a[48:51], a[36:39], v[76:79]
    ds_read_b128 a[100:103], v15 offset:10240
    ds_read_b128 a[104:107], v15 offset:12288
    s_mov_b64 exec, 0xffff
    buffer_store_dwordx4 v[164:167], v38, s[20:23], s48 offen sc1
    s_mov_b64 exec, -1
    v_mfma_f32_16x16x32_bf16 v[80:83], a[48:51], a[40:43], v[80:83]
    s_add_u32 s71, s75, 2
    s_and_b32 s71, s71, 7
    s_lshl_b32 s71, s71, 7
    s_add_u32 s71, s71, 3072
    buffer_load_dwordx4 a[208:211], v23, s[24:27], s71 offen offset:0
    ds_read_b128 a[108:111], v15 offset:14336
    v_mfma_f32_16x16x32_bf16 v[84:87], a[48:51], a[44:47], v[84:87]
    v_lshl_add_u32 v38, v3, 11, v38
    v_cmp_gt_u32 vcc, 3, v3
    v_mfma_f32_16x16x32_bf16 v[88:91], a[52:55], a[32:35], v[88:91]
    v_mov_b32 v8, 1024
    v_cndmask_b32 v8, 0, v8, vcc
    v_mfma_f32_16x16x32_bf16 v[92:95], a[52:55], a[36:39], v[92:95]
    buffer_load_dwordx4 a[212:215], v24, s[24:27], s71 offen offset:1024
    v_add_u32 v39, v38, v8
    v_mfma_f32_16x16x32_bf16 v[96:99], a[52:55], a[40:43], v[96:99]
    v_mfma_f32_16x16x32_bf16 v[100:103], a[52:55], a[44:47], v[100:103]
    s_waitcnt lgkmcnt(0)
    s_waitcnt vmcnt(11)
    s_barrier
    v_mfma_f32_16x16x32_bf16 v[72:75], a[80:83], a[64:67], v[72:75]
    s_add_u32 s51, s47, 4
    s_and_b32 s51, s51, 7
    s_add_u32 m0, s63, 77824
    s_mul_i32 s52, s51, 229376
    buffer_load_dwordx4 v16, s[8:11], s52 offen offset:0 lds
    ds_read_b64_tr_b16 a[16:17], v29 offset:16384
    v_mfma_f32_16x16x32_bf16 v[76:79], a[80:83], a[68:71], v[76:79]
    ds_read_b64_tr_b16 a[18:19], v29 offset:17408
    ds_read_b64_tr_b16 a[20:21], v30 offset:16384
    v_mfma_f32_16x16x32_bf16 v[80:83], a[80:83], a[72:75], v[80:83]
    buffer_load_dwordx4 v17, s[8:11], s52 offen offset:1024 lds
    ds_read_b64_tr_b16 a[22:23], v30 offset:17408
    v_mfma_f32_16x16x32_bf16 v[84:87], a[80:83], a[76:79], v[84:87]
    ds_read_b128 a[0:3], v14 offset:16384
    ds_read_b128 a[4:7], v14 offset:18432
    v_mfma_f32_16x16x32_bf16 v[88:91], a[84:87], a[64:67], v[88:91]
    ds_read_b128 a[8:11], v14 offset:20480
    v_mfma_f32_16x16x32_bf16 v[92:95], a[84:87], a[68:71], v[92:95]
    buffer_load_dwordx4 v18, s[8:11], s52 offen offset:2048 lds
    ds_read_b128 a[12:15], v14 offset:22528
    ds_read_b64_tr_b16 a[48:49], v29 offset:24576
    v_mfma_f32_16x16x32_bf16 v[96:99], a[84:87], a[72:75], v[96:99]
    ds_read_b64_tr_b16 a[50:51], v29 offset:25600
    v_mfma_f32_16x16x32_bf16 v[100:103], a[84:87], a[76:79], v[100:103]
    ds_read_b64_tr_b16 a[52:53], v30 offset:24576
    ds_read_b64_tr_b16 a[54:55], v30 offset:25600
    v_mfma_f32_16x16x32_bf16 v[72:75], a[112:115], a[96:99], v[72:75]
    buffer_load_dwordx4 v19, s[8:11], s52 offen offset:3072 lds
    ds_read_b128 a[32:35], v15 offset:16384
    v_mfma_f32_16x16x32_bf16 v[76:79], a[112:115], a[100:103], v[76:79]
    ds_read_b128 a[36:39], v15 offset:18432
    ds_read_b128 a[40:43], v15 offset:20480
    v_mfma_f32_16x16x32_bf16 v[80:83], a[112:115], a[104:107], v[80:83]
    s_add_u32 s71, s75, 3
    s_and_b32 s71, s71, 7
    s_lshl_b32 s71, s71, 7
    s_add_u32 s71, s71, 3072
    buffer_load_dwordx4 a[216:219], v23, s[24:27], s71 offen offset:0
    ds_read_b128 a[44:47], v15 offset:22528
    v_mfma_f32_16x16x32_bf16 v[84:87], a[112:115], a[108:111], v[84:87]
    v_mfma_f32_16x16x32_bf16 v[88:91], a[116:119], a[96:99], v[88:91]
    v_mfma_f32_16x16x32_bf16 v[92:95], a[116:119], a[100:103], v[92:95]
    buffer_load_dwordx4 a[220:223], v24, s[24:27], s71 offen offset:1024
    v_mfma_f32_16x16x32_bf16 v[96:99], a[116:119], a[104:107], v[96:99]
    v_mfma_f32_16x16x32_bf16 v[100:103], a[116:119], a[108:111], v[100:103]
    s_waitcnt lgkmcnt(0)
    s_waitcnt vmcnt(9)
    s_barrier
    v_mfma_f32_16x16x32_bf16 v[72:75], a[16:19], a[0:3], v[72:75]
    s_add_u32 s51, s47, 5
    s_and_b32 s51, s51, 7
    s_add_u32 m0, s63, 94208
    s_mul_i32 s52, s51, 229376
    buffer_load_dwordx4 v16, s[8:11], s52 offen offset:0 lds
    ds_read_b64_tr_b16 a[80:81], v29 offset:45056
    v_mfma_f32_16x16x32_bf16 v[76:79], a[16:19], a[4:7], v[76:79]
    ds_read_b64_tr_b16 a[82:83], v29 offset:46080
    ds_read_b64_tr_b16 a[84:85], v30 offset:45056
    v_mfma_f32_16x16x32_bf16 v[80:83], a[16:19], a[8:11], v[80:83]
    buffer_load_dwordx4 v17, s[8:11], s52 offen offset:1024 lds
    ds_read_b64_tr_b16 a[86:87], v30 offset:46080
    v_mfma_f32_16x16x32_bf16 v[84:87], a[16:19], a[12:15], v[84:87]
    ds_read_b128 a[64:67], v14 offset:24576
    ds_read_b128 a[68:71], v14 offset:26624
    v_mfma_f32_16x16x32_bf16 v[88:91], a[20:23], a[0:3], v[88:91]
    buffer_load_dwordx4 v18, s[8:11], s52 offen offset:2048 lds
    ds_read_b128 a[72:75], v14 offset:28672
    v_mfma_f32_16x16x32_bf16 v[92:95], a[20:23], a[4:7], v[92:95]
    ds_read_b128 a[76:79], v14 offset:30720
    ds_read_b64_tr_b16 a[112:113], v29 offset:53248
    v_mfma_f32_16x16x32_bf16 v[96:99], a[20:23], a[8:11], v[96:99]
    buffer_load_dwordx4 v19, s[8:11], s52 offen offset:3072 lds
    ds_read_b64_tr_b16 a[114:115], v29 offset:54272
    v_mfma_f32_16x16x32_bf16 v[100:103], a[20:23], a[12:15], v[100:103]
    ds_read_b64_tr_b16 a[116:117], v30 offset:53248
    ds_read_b64_tr_b16 a[118:119], v30 offset:54272
    v_mfma_f32_16x16x32_bf16 v[72:75], a[48:51], a[32:35], v[72:75]
    s_add_u32 s71, s75, 4
    s_and_b32 s71, s71, 7
    s_lshl_b32 s71, s71, 7
    s_add_u32 s71, s71, 3072
    buffer_load_dwordx4 a[224:227], v23, s[24:27], s71 offen offset:0
    ds_read_b128 a[96:99], v15 offset:24576
    v_mfma_f32_16x16x32_bf16 v[76:79], a[48:51], a[36:39], v[76:79]
    ds_read_b128 a[100:103], v15 offset:26624
    ds_read_b128 a[104:107], v15 offset:28672
    v_mfma_f32_16x16x32_bf16 v[80:83], a[48:51], a[40:43], v[80:83]
    buffer_load_dwordx4 a[228:231], v24, s[24:27], s71 offen offset:1024
    ds_read_b128 a[108:111], v15 offset:30720
    v_mfma_f32_16x16x32_bf16 v[84:87], a[48:51], a[44:47], v[84:87]
    v_mfma_f32_16x16x32_bf16 v[88:91], a[52:55], a[32:35], v[88:91]
    s_add_u32 s71, s75, 5
    s_and_b32 s71, s71, 7
    s_lshl_b32 s71, s71, 7
    s_add_u32 s71, s71, 3072
    buffer_load_dwordx4 a[232:235], v23, s[24:27], s71 offen offset:0
    v_mfma_f32_16x16x32_bf16 v[92:95], a[52:55], a[36:39], v[92:95]
    v_mfma_f32_16x16x32_bf16 v[96:99], a[52:55], a[40:43], v[96:99]
    buffer_load_dwordx4 a[236:239], v24, s[24:27], s71 offen offset:1024
    v_mfma_f32_16x16x32_bf16 v[100:103], a[52:55], a[44:47], v[100:103]
    s_waitcnt lgkmcnt(0)
    s_waitcnt vmcnt(10)
    s_barrier
    v_mfma_f32_16x16x32_bf16 v[72:75], a[80:83], a[64:67], v[72:75]
    s_add_u32 s51, s47, 6
    s_and_b32 s51, s51, 7
    s_add_u32 m0, s63, 122880
    s_mul_i32 s52, s51, 229376
    buffer_load_dwordx4 v16, s[8:11], s52 offen offset:0 lds
    ds_read_b64_tr_b16 a[16:17], v29 offset:0
    v_mfma_f32_16x16x32_bf16 v[76:79], a[80:83], a[68:71], v[76:79]
    ds_read_b64_tr_b16 a[18:19], v29 offset:1024
    ds_read_b64_tr_b16 a[20:21], v30 offset:0
    v_mfma_f32_16x16x32_bf16 v[80:83], a[80:83], a[72:75], v[80:83]
    buffer_load_dwordx4 v17, s[8:11], s52 offen offset:1024 lds
    ds_read_b64_tr_b16 a[22:23], v30 offset:1024
    v_mfma_f32_16x16x32_bf16 v[84:87], a[80:83], a[76:79], v[84:87]
    ds_read_b128 a[0:3], v14 offset:32768
    ds_read_b128 a[4:7], v14 offset:34816
    v_mfma_f32_16x16x32_bf16 v[88:91], a[84:87], a[64:67], v[88:91]
    ds_read_b128 a[8:11], v14 offset:36864
    v_mfma_f32_16x16x32_bf16 v[92:95], a[84:87], a[68:71], v[92:95]
    buffer_load_dwordx4 v18, s[8:11], s52 offen offset:2048 lds
    ds_read_b128 a[12:15], v14 offset:38912
    ds_read_b64_tr_b16 a[48:49], v29 offset:8192
    v_mfma_f32_16x16x32_bf16 v[96:99], a[84:87], a[72:75], v[96:99]
    ds_read_b64_tr_b16 a[50:51], v29 offset:9216
    v_mfma_f32_16x16x32_bf16 v[100:103], a[84:87], a[76:79], v[100:103]
    ds_read_b64_tr_b16 a[52:53], v30 offset:8192
    ds_read_b64_tr_b16 a[54:55], v30 offset:9216
    v_mfma_f32_16x16x32_bf16 v[72:75], a[112:115], a[96:99], v[72:75]
    buffer_load_dwordx4 v19, s[8:11], s52 offen offset:3072 lds
    ds_read_b128 a[32:35], v15 offset:32768
    v_mfma_f32_16x16x32_bf16 v[76:79], a[112:115], a[100:103], v[76:79]
    ds_read_b128 a[36:39], v15 offset:34816
    ds_read_b128 a[40:43], v15 offset:36864
    v_mfma_f32_16x16x32_bf16 v[80:83], a[112:115], a[104:107], v[80:83]
    s_add_u32 s71, s75, 6
    s_and_b32 s71, s71, 7
    s_lshl_b32 s71, s71, 7
    s_add_u32 s71, s71, 3072
    buffer_load_dwordx4 a[240:243], v23, s[24:27], s71 offen offset:0
    ds_read_b128 a[44:47], v15 offset:38912
    v_mfma_f32_16x16x32_bf16 v[84:87], a[112:115], a[108:111], v[84:87]
    v_mfma_f32_16x16x32_bf16 v[88:91], a[116:119], a[96:99], v[88:91]
    v_mfma_f32_16x16x32_bf16 v[92:95], a[116:119], a[100:103], v[92:95]
    buffer_load_dwordx4 a[244:247], v24, s[24:27], s71 offen offset:1024
    v_mfma_f32_16x16x32_bf16 v[96:99], a[116:119], a[104:107], v[96:99]
    v_mfma_f32_16x16x32_bf16 v[100:103], a[116:119], a[108:111], v[100:103]
    s_waitcnt lgkmcnt(0)
    s_waitcnt vmcnt(10)
    s_barrier
    s_lshl_b32 s73, s44, 13
    s_add_u32 s73, s73, 65536
    buffer_load_dwordx4 v[164:167], v38, s[20:23], s73 offen sc1
    buffer_load_dwordx4 v[168:171], v39, s[20:23], s73 offen sc1
    v_mfma_f32_16x16x32_bf16 v[72:75], a[16:19], a[0:3], v[72:75]
    s_add_u32 s51, s47, 7
    s_and_b32 s51, s51, 7
    s_add_u32 m0, s63, 77824
    s_mul_i32 s52, s51, 229376
    buffer_load_dwordx4 v16, s[8:11], s52 offen offset:0 lds
    ds_read_b64_tr_b16 a[80:81], v29 offset:16384
    v_mfma_f32_16x16x32_bf16 v[76:79], a[16:19], a[4:7], v[76:79]
    ds_read_b64_tr_b16 a[82:83], v29 offset:17408
    ds_read_b64_tr_b16 a[84:85], v30 offset:16384
    v_mfma_f32_16x16x32_bf16 v[80:83], a[16:19], a[8:11], v[80:83]
    buffer_load_dwordx4 v17, s[8:11], s52 offen offset:1024 lds
    ds_read_b64_tr_b16 a[86:87], v30 offset:17408
    v_mfma_f32_16x16x32_bf16 v[84:87], a[16:19], a[12:15], v[84:87]
    ds_read_b128 a[64:67], v14 offset:40960
    ds_read_b128 a[68:71], v14 offset:43008
    v_mfma_f32_16x16x32_bf16 v[88:91], a[20:23], a[0:3], v[88:91]
    ds_read_b128 a[72:75], v14 offset:45056
    v_mfma_f32_16x16x32_bf16 v[92:95], a[20:23], a[4:7], v[92:95]
    buffer_load_dwordx4 v18, s[8:11], s52 offen offset:2048 lds
    ds_read_b128 a[76:79], v14 offset:47104
    ds_read_b64_tr_b16 a[112:113], v29 offset:24576
    v_mfma_f32_16x16x32_bf16 v[96:99], a[20:23], a[8:11], v[96:99]
    ds_read_b64_tr_b16 a[114:115], v29 offset:25600
    v_mfma_f32_16x16x32_bf16 v[100:103], a[20:23], a[12:15], v[100:103]
    ds_read_b64_tr_b16 a[116:117], v30 offset:24576
    ds_read_b64_tr_b16 a[118:119], v30 offset:25600
    v_mfma_f32_16x16x32_bf16 v[72:75], a[48:51], a[32:35], v[72:75]
    buffer_load_dwordx4 v19, s[8:11], s52 offen offset:3072 lds
    ds_read_b128 a[96:99], v15 offset:40960
    v_mfma_f32_16x16x32_bf16 v[76:79], a[48:51], a[36:39], v[76:79]
    ds_read_b128 a[100:103], v15 offset:43008
    ds_read_b128 a[104:107], v15 offset:45056
    v_mfma_f32_16x16x32_bf16 v[80:83], a[48:51], a[40:43], v[80:83]
    s_add_u32 s71, s75, 7
    s_and_b32 s71, s71, 7
    s_lshl_b32 s71, s71, 7
    s_add_u32 s71, s71, 3072
    buffer_load_dwordx4 a[248:251], v23, s[24:27], s71 offen offset:0
    ds_read_b128 a[108:111], v15 offset:47104
    v_mfma_f32_16x16x32_bf16 v[84:87], a[48:51], a[44:47], v[84:87]
    v_mfma_f32_16x16x32_bf16 v[88:91], a[52:55], a[32:35], v[88:91]
    v_mfma_f32_16x16x32_bf16 v[92:95], a[52:55], a[36:39], v[92:95]
    buffer_load_dwordx4 a[252:255], v24, s[24:27], s71 offen offset:1024
    v_mfma_f32_16x16x32_bf16 v[96:99], a[52:55], a[40:43], v[96:99]
    v_mfma_f32_16x16x32_bf16 v[100:103], a[52:55], a[44:47], v[100:103]
    s_waitcnt lgkmcnt(0)
    s_waitcnt vmcnt(10)
L_h2:
    s_cbranch_execz L_h6
    s_barrier
    v_mfma_f32_16x16x32_bf16 v[72:75], a[80:83], a[64:67], v[72:75]
    s_add_u32 s51, s47, 0
    s_and_b32 s51, s51, 7
    s_add_u32 m0, s64, 94208
    s_mul_i32 s52, s51, 196608
    buffer_load_dwordx4 v20, s[12:15], s52 offen offset:0 lds
    ds_read_b64_tr_b16 a[16:17], v29 offset:45056
    v_mfma_f32_16x16x32_bf16 v[76:79], a[80:83], a[68:71], v[76:79]
    ds_read_b64_tr_b16 a[18:19], v29 offset:46080
    ds_read_b64_tr_b16 a[20:21], v30 offset:45056
    v_mfma_f32_16x16x32_bf16 v[80:83], a[80:83], a[72:75], v[80:83]
    buffer_load_dwordx4 v20, s[12:15], s52 offen offset:1024 lds
    ds_read_b64_tr_b16 a[22:23], v30 offset:46080
    v_mfma_f32_16x16x32_bf16 v[84:87], a[80:83], a[76:79], v[84:87]
    ds_read_b128 a[0:3], v14 offset:49152
    ds_read_b128 a[4:7], v14 offset:51200
    v_mfma_f32_16x16x32_bf16 v[88:91], a[84:87], a[64:67], v[88:91]
    buffer_load_dwordx4 v20, s[12:15], s52 offen offset:2048 lds
    s_add_u32 m0, s64, 97280
    ds_read_b128 a[8:11], v14 offset:53248
    v_mfma_f32_16x16x32_bf16 v[92:95], a[84:87], a[68:71], v[92:95]
    ds_read_b128 a[12:15], v14 offset:55296
    ds_read_b64_tr_b16 a[48:49], v29 offset:53248
    v_mfma_f32_16x16x32_bf16 v[96:99], a[84:87], a[72:75], v[96:99]
    buffer_load_dwordx4 v21, s[12:15], s52 offen offset:0 lds
    ds_read_b64_tr_b16 a[50:51], v29 offset:54272
    v_mfma_f32_16x16x32_bf16 v[100:103], a[84:87], a[76:79], v[100:103]
    ds_read_b64_tr_b16 a[52:53], v30 offset:53248
    ds_read_b64_tr_b16 a[54:55], v30 offset:54272
    v_mfma_f32_16x16x32_bf16 v[72:75], a[112:115], a[96:99], v[72:75]
    ds_read_b128 a[32:35], v15 offset:49152
    v_mfma_f32_16x16x32_bf16 v[76:79], a[112:115], a[100:103], v[76:79]
    buffer_load_dwordx4 v21, s[12:15], s52 offen offset:1024 lds
    ds_read_b128 a[36:39], v15 offset:51200
    ds_read_b128 a[40:43], v15 offset:53248
    v_mfma_f32_16x16x32_bf16 v[80:83], a[112:115], a[104:107], v[80:83]
    ds_read_b128 a[44:47], v15 offset:55296
    v_mfma_f32_16x16x32_bf16 v[84:87], a[112:115], a[108:111], v[84:87]
    buffer_load_dwordx4 v21, s[12:15], s52 offen offset:2048 lds
    v_mfma_f32_16x16x32_bf16 v[88:91], a[116:119], a[96:99], v[88:91]
    v_mfma_f32_16x16x32_bf16 v[92:95], a[116:119], a[100:103], v[92:95]
    s_add_u32 m0, s65, 118784
    s_add_u32 s51, s66, 0
    s_and_b32 s51, s51, 7
    s_lshl_b32 s51, s51, 7
    buffer_load_dwordx4 v22, s[4:7], s51 offen offset:0 lds
    v_mfma_f32_16x16x32_bf16 v[96:99], a[116:119], a[104:107], v[96:99]
    v_mfma_f32_16x16x32_bf16 v[100:103], a[116:119], a[108:111], v[100:103]
    s_waitcnt lgkmcnt(0)
    s_waitcnt vmcnt(9)
    s_barrier
    s_mov_b32 s58, 0x40000
L_poll0:
    v_cmp_ne_u64 vcc, s[56:57], v[166:167]
    v_cmp_ne_u64 s[60:61], s[56:57], v[170:171]
    s_nop 1
    s_or_b64 vcc, vcc, s[60:61]
    s_nop 4
    s_cbranch_vccz L_polld0
    s_sub_u32 s58, s58, 1
    s_cbranch_scc1 L_polld0
    s_sleep 1
    s_lshl_b32 s73, s44, 13
    s_add_u32 s73, s73, 65536
    buffer_load_dwordx4 v[164:167], v38, s[20:23], s73 offen sc1
    buffer_load_dwordx4 v[168:171], v39, s[20:23], s73 offen sc1
    s_waitcnt vmcnt(0)
    s_branch L_poll0
L_polld0:
    v_mfma_f32_16x16x32_bf16 v[72:75], a[16:19], a[0:3], v[72:75]
    s_add_u32 s51, s47, 1
    s_and_b32 s51, s51, 7
    s_add_u32 m0, s64, 122880
    s_mul_i32 s52, s51, 196608
    buffer_load_dwordx4 v20, s[12:15], s52 offen offset:0 lds
    ds_read_b64_tr_b16 a[80:81], v29 offset:0
    v_cmp_gt_u32 vcc, 3, v3
    s_lshl_b32 s48, s3, 7
    s_add_u32 s48, s48, 162816
    v_mfma_f32_16x16x32_bf16 v[76:79], a[16:19], a[4:7], v[76:79]
    ds_read_b64_tr_b16 a[82:83], v29 offset:1024
    ds_read_b64_tr_b16 a[84:85], v30 offset:0
    v_cndmask_b32 v168, 0, v168, vcc
    v_cndmask_b32 v169, 0, v169, vcc
    v_mfma_f32_16x16x32_bf16 v[80:83], a[16:19], a[8:11], v[80:83]
    buffer_load_dwordx4 v20, s[12:15], s52 offen offset:1024 lds
    ds_read_b64_tr_b16 a[86:87], v30 offset:1024
    v_add_f32 v164, v164, v168
    v_add_f32 v165, v165, v169
    v_mfma_f32_16x16x32_bf16 v[84:87], a[16:19], a[12:15], v[84:87]
    ds_read_b128 a[64:67], v14 offset:57344
    ds_read_b128 a[68:71], v14 offset:59392
    v_mov_b32 v168, v164
    v_mov_b32 v169, v165
    v_mfma_f32_16x16x32_bf16 v[88:91], a[20:23], a[0:3], v[88:91]
    ds_read_b128 a[72:75], v14 offset:61440
    v_permlane32_swap_b32 v164, v168
    v_permlane32_swap_b32 v165, v169
    v_add_f32 v164, v164, v168
    v_mfma_f32_16x16x32_bf16 v[92:95], a[20:23], a[4:7], v[92:95]
    buffer_load_dwordx4 v20, s[12:15], s52 offen offset:2048 lds
    s_add_u32 m0, s64, 125952
    ds_read_b128 a[76:79], v14 offset:63488
    ds_read_b64_tr_b16 a[112:113], v29 offset:8192
    v_add_f32 v165, v165, v169
    v_mov_b32 v168, v164
    v_mfma_f32_16x16x32_bf16 v[96:99], a[20:23], a[8:11], v[96:99]
    ds_read_b64_tr_b16 a[114:115], v29 offset:9216
    v_mov_b32 v169, v165
    v_permlane16_swap_b32 v164, v168
    v_mfma_f32_16x16x32_bf16 v[100:103], a[20:23], a[12:15], v[100:103]
    ds_read_b64_tr_b16 a[116:117], v30 offset:8192
    ds_read_b64_tr_b16 a[118:119], v30 offset:9216
    v_permlane16_swap_b32 v165, v169
    v_add_f32 v164, v164, v168
    v_mfma_f32_16x16x32_bf16 v[72:75], a[48:51], a[32:35], v[72:75]
    buffer_load_dwordx4 v21, s[12:15], s52 offen offset:0 lds
    ds_read_b128 a[96:99], v15 offset:57344
    v_add_f32 v165, v165, v169
    v_mul_f32 v164, 0x3a924925, v164
    v_mul_f32 v165, 0x3a924925, v165
    v_mfma_f32_16x16x32_bf16 v[76:79], a[48:51], a[36:39], v[76:79]
    ds_read_b128 a[100:103], v15 offset:59392
    ds_read_b128 a[104:107], v15 offset:61440
    v_fma_f32 v165, -v164, v164, v165
    v_max_f32 v165, 0, v165
    v_mfma_f32_16x16x32_bf16 v[80:83], a[48:51], a[40:43], v[80:83]
    buffer_load_dwordx4 v21, s[12:15], s52 offen offset:1024 lds
    ds_read_b128 a[108:111], v15 offset:63488
    v_add_f32 v165, 0x3727c5ac, v165
    v_rsq_f32 v166, v165
    v_mfma_f32_16x16x32_bf16 v[84:87], a[48:51], a[44:47], v[84:87]
    v_lshl_add_u32 v35, v2, 3, s48
    v_mfma_f32_16x16x32_bf16 v[88:91], a[52:55], a[32:35], v[88:91]
    v_mul_f32 v167, -v164, v166
    ds_write_b64 v35, v[166:167]
    v_mfma_f32_16x16x32_bf16 v[92:95], a[52:55], a[36:39], v[92:95]
    buffer_load_dwordx4 v21, s[12:15], s52 offen offset:2048 lds
    v_mfma_f32_16x16x32_bf16 v[96:99], a[52:55], a[40:43], v[96:99]
    v_mfma_f32_16x16x32_bf16 v[100:103], a[52:55], a[44:47], v[100:103]
    s_waitcnt lgkmcnt(0)
    s_waitcnt vmcnt(6)
    s_barrier
    v_lshlrev_b32 v35, 3, v2
    v_add_u32 v35, 162816, v35
    ds_read_b64 v[164:165], v35 offset:0
    ds_read_b64 v[166:167], v35 offset:128
    ds_read_b64 v[168:169], v35 offset:256
    ds_read_b64 v[170:171], v35 offset:384
    s_mul_i32 s48, s3, 2304
    s_add_u32 s48, s48, 151552
    v_mul_u32_u24 v35, 576, v3
    v_lshl_add_u32 v35, v2, 3, v35
    v_add_u32 v35, s48, v35
    v_mul_u32_u24 v38, 576, v5
    v_and_b32 v8, 1, v4
    v_mul_u32_u24 v8, 272, v8
    v_lshrrev_b32 v9, 1, v4
    v_lshl_add_u32 v9, v3, 2, v9
    v_lshl_add_u32 v38, v9, 3, v38
    v_add3_u32 v38, v38, v8, s48
    s_lshl_b32 s49, s44, 11
    s_waitcnt lgkmcnt(0)
    v_pk_fma_f32 v[40:41], v[40:41], v[164:165], v[164:165] op_sel:[0,0,1] op_sel_hi:[1,0,1]
    v_pk_fma_f32 v[42:43], v[42:43], v[164:165], v[164:165] op_sel:[0,0,1] op_sel_hi:[1,0,1]
    v_pk_fma_f32 v[44:45], v[44:45], v[166:167], v[166:167] op_sel:[0,0,1] op_sel_hi:[1,0,1]
    v_pk_fma_f32 v[46:47], v[46:47], v[166:167], v[166:167] op_sel:[0,0,1] op_sel_hi:[1,0,1]
    v_pk_fma_f32 v[48:49], v[48:49], v[168:169], v[168:169] op_sel:[0,0,1] op_sel_hi:[1,0,1]
    v_pk_fma_f32 v[50:51], v[50:51], v[168:169], v[168:169] op_sel:[0,0,1] op_sel_hi:[1,0,1]
    v_pk_fma_f32 v[52:53], v[52:53], v[170:171], v[170:171] op_sel:[0,0,1] op_sel_hi:[1,0,1]
    v_pk_fma_f32 v[54:55], v[54:55], v[170:171], v[170:171] op_sel:[0,0,1] op_sel_hi:[1,0,1]
    v_cvt_pk_bf16_f32 v40, v40, v41
    v_cvt_pk_bf16_f32 v41, v42, v43
    v_cvt_pk_bf16_f32 v44, v44, v45
    v_cvt_pk_bf16_f32 v45, v46, v47
    v_cvt_pk_bf16_f32 v48, v48, v49
    v_cvt_pk_bf16_f32 v49, v50, v51
    v_cvt_pk_bf16_f32 v52, v52, v53
    v_cvt_pk_bf16_f32 v53, v54, v55
    ds_write_b64 v35, v[40:41] offset:0
    ds_write_b64 v35, v[44:45] offset:128
    ds_write_b64 v35, v[48:49] offset:272
    ds_write_b64 v35, v[52:53] offset:400
    ds_read_b64_tr_b16 v[188:189], v38 offset:0
    ds_read_b64_tr_b16 v[190:191], v38 offset:16
    ds_read_b64_tr_b16 v[192:193], v38 offset:128
    ds_read_b64_tr_b16 v[194:195], v38 offset:144
    v_pk_fma_f32 v[56:57], v[56:57], v[164:165], v[164:165] op_sel:[0,0,1] op_sel_hi:[1,0,1]
    v_pk_fma_f32 v[58:59], v[58:59], v[164:165], v[164:165] op_sel:[0,0,1] op_sel_hi:[1,0,1]
    v_pk_fma_f32 v[60:61], v[60:61], v[166:167], v[166:167] op_sel:[0,0,1] op_sel_hi:[1,0,1]
    v_pk_fma_f32 v[62:63], v[62:63], v[166:167], v[166:167] op_sel:[0,0,1] op_sel_hi:[1,0,1]
    v_pk_fma_f32 v[64:65], v[64:65], v[168:169], v[168:169] op_sel:[0,0,1] op_sel_hi:[1,0,1]
    v_pk_fma_f32 v[66:67], v[66:67], v[168:169], v[168:169] op_sel:[0,0,1] op_sel_hi:[1,0,1]
    v_pk_fma_f32 v[68:69], v[68:69], v[170:171], v[170:171] op_sel:[0,0,1] op_sel_hi:[1,0,1]
    v_pk_fma_f32 v[70:71], v[70:71], v[170:171], v[170:171] op_sel:[0,0,1] op_sel_hi:[1,0,1]
    v_cvt_pk_bf16_f32 v56, v56, v57
    v_cvt_pk_bf16_f32 v57, v58, v59
    v_cvt_pk_bf16_f32 v60, v60, v61
    v_cvt_pk_bf16_f32 v61, v62, v63
    v_cvt_pk_bf16_f32 v64, v64, v65
    v_cvt_pk_bf16_f32 v65, v66, v67
    v_cvt_pk_bf16_f32 v68, v68, v69
    v_cvt_pk_bf16_f32 v69, v70, v71
    ds_write_b64 v35, v[56:57] offset:0
    ds_write_b64 v35, v[60:61] offset:128
    ds_write_b64 v35, v[64:65] offset:272
    ds_write_b64 v35, v[68:69] offset:400
    ds_read_b64_tr_b16 v[196:197], v38 offset:0
    ds_read_b64_tr_b16 v[198:199], v38 offset:16
    ds_read_b64_tr_b16 v[200:201], v38 offset:128
    ds_read_b64_tr_b16 v[202:203], v38 offset:144
    v_mfma_f32_16x16x32_bf16 v[72:75], a[80:83], a[64:67], v[72:75]
    s_add_u32 s51, s47, 2
    s_and_b32 s51, s51, 7
    s_add_u32 m0, s64, 65536
    s_mul_i32 s52, s51, 196608
    buffer_load_dwordx4 v20, s[12:15], s52 offen offset:0 lds
    ds_read_b64_tr_b16 a[20:21], v31 offset:28672
    ds_read_b64_tr_b16 a[22:23], v31 offset:29184
    v_mfma_f32_16x16x32_bf16 v[76:79], a[80:83], a[68:71], v[76:79]
    ds_read_b64_tr_b16 a[24:25], v31 offset:29696
    ds_read_b64_tr_b16 a[26:27], v31 offset:30208
    v_mfma_f32_16x16x32_bf16 v[80:83], a[80:83], a[72:75], v[80:83]
    buffer_load_dwordx4 v20, s[12:15], s52 offen offset:1024 lds
    ds_read_b64_tr_b16 a[28:29], v31 offset:30720
    ds_read_b64_tr_b16 a[30:31], v31 offset:31232
    v_mfma_f32_16x16x32_bf16 v[84:87], a[80:83], a[76:79], v[84:87]
    ds_read_b128 a[0:3], v14 offset:0
    ds_read_b128 a[4:7], v14 offset:2048
    v_mfma_f32_16x16x32_bf16 v[88:91], a[84:87], a[64:67], v[88:91]
    buffer_load_dwordx4 v20, s[12:15], s52 offen offset:2048 lds
    s_add_u32 m0, s64, 68608
    ds_read_b128 a[8:11], v14 offset:4096
    ds_read_b128 a[12:15], v14 offset:6144
    v_mfma_f32_16x16x32_bf16 v[92:95], a[84:87], a[68:71], v[92:95]
    ds_read_b128 a[16:19], v27 offset:28672
    ds_read_b64_tr_b16 a[52:53], v31 offset:40960
    v_mfma_f32_16x16x32_bf16 v[96:99], a[84:87], a[72:75], v[96:99]
    buffer_load_dwordx4 v21, s[12:15], s52 offen offset:0 lds
    ds_read_b64_tr_b16 a[54:55], v31 offset:41472
    ds_read_b64_tr_b16 a[56:57], v31 offset:41984
    v_mfma_f32_16x16x32_bf16 v[100:103], a[84:87], a[76:79], v[100:103]
    ds_read_b64_tr_b16 a[58:59], v31 offset:42496
    ds_read_b64_tr_b16 a[60:61], v31 offset:43008
    v_mfma_f32_16x16x32_bf16 v[72:75], a[112:115], a[96:99], v[72:75]
    ds_read_b64_tr_b16 a[62:63], v31 offset:43520
    ds_read_b128 a[32:35], v15 offset:0
    v_mfma_f32_16x16x32_bf16 v[76:79], a[112:115], a[100:103], v[76:79]
    buffer_load_dwordx4 v21, s[12:15], s52 offen offset:1024 lds
    ds_read_b128 a[36:39], v15 offset:2048
    ds_read_b128 a[40:43], v15 offset:4096
    v_mfma_f32_16x16x32_bf16 v[80:83], a[112:115], a[104:107], v[80:83]
    ds_read_b128 a[44:47], v15 offset:6144
    ds_read_b128 a[48:51], v28 offset:28672
    v_mfma_f32_16x16x32_bf16 v[84:87], a[112:115], a[108:111], v[84:87]
    buffer_load_dwordx4 v21, s[12:15], s52 offen offset:2048 lds
    v_mfma_f32_16x16x32_bf16 v[88:91], a[116:119], a[96:99], v[88:91]
    v_mfma_f32_16x16x32_bf16 v[92:95], a[116:119], a[100:103], v[92:95]
    s_add_u32 m0, s65, 90112
    s_add_u32 s51, s66, 2
    s_and_b32 s51, s51, 7
    s_lshl_b32 s51, s51, 7
    buffer_load_dwordx4 v22, s[4:7], s51 offen offset:0 lds
    v_mfma_f32_16x16x32_bf16 v[96:99], a[116:119], a[104:107], v[96:99]
    v_mfma_f32_16x16x32_bf16 v[100:103], a[116:119], a[108:111], v[100:103]
    s_waitcnt lgkmcnt(0)
    s_waitcnt vmcnt(7)
    s_barrier
    v_mfma_f32_16x16x32_bf16 v[108:111], a[20:23], a[0:3], 0
    buffer_store_dwordx4 v[200:203], v187, s[20:23], s49 offen offset:1024 sc1
    ds_read_b64_tr_b16 a[84:85], v32 offset:0
    v_mfma_f32_16x16x32_bf16 v[124:127], a[24:27], a[0:3], 0
    ds_read_b64_tr_b16 a[86:87], v32 offset:512
    v_mfma_f32_16x16x32_bf16 v[144:147], a[0:3], a[28:31], 0
    buffer_store_dwordx4 v[196:199], v187, s[20:23], s49 offen offset:0 sc1
    ds_read_b64_tr_b16 a[88:89], v32 offset:1024
    v_mfma_f32_16x16x32_bf16 v[112:115], a[20:23], a[4:7], 0
    ds_read_b64_tr_b16 a[90:91], v32 offset:1536
    v_mfma_f32_16x16x32_bf16 v[128:131], a[24:27], a[4:7], 0
    buffer_store_dwordx4 v[192:195], v186, s[20:23], s49 offen offset:1024 sc1
    ds_read_b64_tr_b16 a[92:93], v32 offset:2048
    v_mfma_f32_16x16x32_bf16 v[148:151], a[4:7], a[28:31], 0
    ds_read_b64_tr_b16 a[94:95], v32 offset:2560
    ds_read_b128 a[64:67], v14 offset:8192
    v_mfma_f32_16x16x32_bf16 v[116:119], a[20:23], a[8:11], 0
    ds_read_b128 a[68:71], v14 offset:10240
    v_mfma_f32_16x16x32_bf16 v[132:135], a[24:27], a[8:11], 0
    buffer_store_dwordx4 v[188:191], v186, s[20:23], s49 offen offset:0 sc1
    ds_read_b128 a[72:75], v14 offset:12288
    v_mfma_f32_16x16x32_bf16 v[152:155], a[8:11], a[28:31], 0
    ds_read_b128 a[76:79], v14 offset:14336
    v_mfma_f32_16x16x32_bf16 v[120:123], a[20:23], a[12:15], 0
    s_add_u32 s51, s47, 3
    s_and_b32 s51, s51, 7
    s_add_u32 m0, s64, 94208
    s_mul_i32 s52, s51, 196608
    buffer_load_dwordx4 v20, s[12:15], s52 offen offset:0 lds
    ds_read_b128 a[80:83], v27 offset:30720
    v_mfma_f32_16x16x32_bf16 v[136:139], a[24:27], a[12:15], 0
    ds_read_b64_tr_b16 a[116:117], v32 offset:12288
    v_mfma_f32_16x16x32_bf16 v[156:159], a[12:15], a[28:31], 0
    buffer_load_dwordx4 v20, s[12:15], s52 offen offset:1024 lds
    ds_read_b64_tr_b16 a[118:119], v32 offset:12800
    ds_read_b64_tr_b16 a[120:121], v32 offset:13312
    v_mfma_f32_16x16x32_bf16 v[140:143], a[24:27], a[16:19], 0
    ds_read_b64_tr_b16 a[122:123], v32 offset:13824
    v_mfma_f32_16x16x32_bf16 v[160:163], a[16:19], a[28:31], 0
    ds_read_b64_tr_b16 a[124:125], v32 offset:14336
    v_mfma_f32_16x16x32_bf16 v[108:111], a[52:55], a[32:35], v[108:111]
    buffer_load_dwordx4 v20, s[12:15], s52 offen offset:2048 lds
    s_add_u32 m0, s64, 97280
    ds_read_b64_tr_b16 a[126:127], v32 offset:14848
    v_mfma_f32_16x16x32_bf16 v[124:127], a[56:59], a[32:35], v[124:127]
    ds_read_b128 a[96:99], v15 offset:8192
    v_mfma_f32_16x16x32_bf16 v[144:147], a[32:35], a[60:63], v[144:147]
    buffer_load_dwordx4 v21, s[12:15], s52 offen offset:0 lds
    ds_read_b128 a[100:103], v15 offset:10240
    v_mfma_f32_16x16x32_bf16 v[112:115], a[52:55], a[36:39], v[112:115]
    ds_read_b128 a[104:107], v15 offset:12288
    ds_read_b128 a[108:111], v15 offset:14336
    v_mfma_f32_16x16x32_bf16 v[128:131], a[56:59], a[36:39], v[128:131]
    buffer_load_dwordx4 v21, s[12:15], s52 offen offset:1024 lds
    ds_read_b128 a[112:115], v28 offset:30720
    v_mfma_f32_16x16x32_bf16 v[148:151], a[36:39], a[60:63], v[148:151]
    v_mfma_f32_16x16x32_bf16 v[116:119], a[52:55], a[40:43], v[116:119]
    v_mfma_f32_16x16x32_bf16 v[132:135], a[56:59], a[40:43], v[132:135]
    buffer_load_dwordx4 v21, s[12:15], s52 offen offset:2048 lds
    v_mfma_f32_16x16x32_bf16 v[152:155], a[40:43], a[60:63], v[152:155]
    v_mfma_f32_16x16x32_bf16 v[120:123], a[52:55], a[44:47], v[120:123]
    s_add_u32 m0, s62, 0
    s_add_u32 s51, s75, 0
    s_and_b32 s51, s51, 7
    s_lshl_b32 s51, s51, 7
    buffer_load_dwordx4 v23, s[24:27], s51 offen offset:0 lds
    v_mfma_f32_16x16x32_bf16 v[136:139], a[56:59], a[44:47], v[136:139]
    v_mfma_f32_16x16x32_bf16 v[156:159], a[44:47], a[60:63], v[156:159]
    buffer_load_dwordx4 v24, s[24:27], s51 offen offset:1024 lds
    v_mfma_f32_16x16x32_bf16 v[140:143], a[56:59], a[48:51], v[140:143]
    v_mfma_f32_16x16x32_bf16 v[160:163], a[48:51], a[60:63], v[160:163]
    s_waitcnt lgkmcnt(0)
    s_waitcnt vmcnt(12)
    s_barrier
    v_mfma_f32_16x16x32_bf16 v[108:111], a[84:87], a[64:67], v[108:111]
    s_add_u32 s51, s47, 4
    s_and_b32 s51, s51, 7
    s_add_u32 m0, s64, 122880
    s_mul_i32 s52, s51, 196608
    buffer_load_dwordx4 v20, s[12:15], s52 offen offset:0 lds
    ds_read_b64_tr_b16 a[20:21], v31 offset:0
    v_mfma_f32_16x16x32_bf16 v[124:127], a[88:91], a[64:67], v[124:127]
    ds_read_b64_tr_b16 a[22:23], v31 offset:512
    v_mfma_f32_16x16x32_bf16 v[144:147], a[64:67], a[92:95], v[144:147]
    ds_read_b64_tr_b16 a[24:25], v31 offset:1024
    v_mfma_f32_16x16x32_bf16 v[112:115], a[84:87], a[68:71], v[112:115]
    buffer_load_dwordx4 v20, s[12:15], s52 offen offset:1024 lds
    ds_read_b64_tr_b16 a[26:27], v31 offset:1536
    v_mfma_f32_16x16x32_bf16 v[128:131], a[88:91], a[68:71], v[128:131]
    ds_read_b64_tr_b16 a[28:29], v31 offset:2048
    v_mfma_f32_16x16x32_bf16 v[148:151], a[68:71], a[92:95], v[148:151]
    ds_read_b64_tr_b16 a[30:31], v31 offset:2560
    ds_read_b128 a[0:3], v14 offset:16384
    v_mfma_f32_16x16x32_bf16 v[116:119], a[84:87], a[72:75], v[116:119]
    buffer_load_dwordx4 v20, s[12:15], s52 offen offset:2048 lds
    s_add_u32 m0, s64, 125952
    ds_read_b128 a[4:7], v14 offset:18432
    v_mfma_f32_16x16x32_bf16 v[132:135], a[88:91], a[72:75], v[132:135]
    ds_read_b128 a[8:11], v14 offset:20480
    v_mfma_f32_16x16x32_bf16 v[152:155], a[72:75], a[92:95], v[152:155]
    ds_read_b128 a[12:15], v14 offset:22528
    v_mfma_f32_16x16x32_bf16 v[120:123], a[84:87], a[76:79], v[120:123]
    buffer_load_dwordx4 v21, s[12:15], s52 offen offset:0 lds
    ds_read_b128 a[16:19], v27 offset:0
    v_mfma_f32_16x16x32_bf16 v[136:139], a[88:91], a[76:79], v[136:139]
    ds_read_b64_tr_b16 a[52:53], v31 offset:12288
    v_mfma_f32_16x16x32_bf16 v[156:159], a[76:79], a[92:95], v[156:159]
    ds_read_b64_tr_b16 a[54:55], v31 offset:12800
    ds_read_b64_tr_b16 a[56:57], v31 offset:13312
    v_mfma_f32_16x16x32_bf16 v[140:143], a[88:91], a[80:83], v[140:143]
    buffer_load_dwordx4 v21, s[12:15], s52 offen offset:1024 lds
    ds_read_b64_tr_b16 a[58:59], v31 offset:13824
    v_mfma_f32_16x16x32_bf16 v[160:163], a[80:83], a[92:95], v[160:163]
    ds_read_b64_tr_b16 a[60:61], v31 offset:14336
    v_mfma_f32_16x16x32_bf16 v[108:111], a[116:119], a[96:99], v[108:111]
    ds_read_b64_tr_b16 a[62:63], v31 offset:14848
    v_mfma_f32_16x16x32_bf16 v[124:127], a[120:123], a[96:99], v[124:127]
    buffer_load_dwordx4 v21, s[12:15], s52 offen offset:2048 lds
    ds_read_b128 a[32:35], v15 offset:16384
    v_mfma_f32_16x16x32_bf16 v[144:147], a[96:99], a[124:127], v[144:147]
    ds_read_b128 a[36:39], v15 offset:18432
    v_mfma_f32_16x16x32_bf16 v[112:115], a[116:119], a[100:103], v[112:115]
    ds_read_b128 a[40:43], v15 offset:20480
    ds_read_b128 a[44:47], v15 offset:22528
    v_mfma_f32_16x16x32_bf16 v[128:131], a[120:123], a[100:103], v[128:131]
    s_add_u32 m0, s65, 147456
    s_add_u32 s51, s66, 4
    s_and_b32 s51, s51, 7
    s_lshl_b32 s51, s51, 7
    buffer_load_dwordx4 v22, s[4:7], s51 offen offset:0 lds
    ds_read_b128 a[48:51], v28 offset:0
    v_mfma_f32_16x16x32_bf16 v[148:151], a[100:103], a[124:127], v[148:151]
    v_mfma_f32_16x16x32_bf16 v[116:119], a[116:119], a[104:107], v[116:119]
    v_mfma_f32_16x16x32_bf16 v[132:135], a[120:123], a[104:107], v[132:135]
    s_add_u32 m0, s62, 8192
    s_add_u32 s51, s75, 1
    s_and_b32 s51, s51, 7
    s_lshl_b32 s51, s51, 7
    buffer_load_dwordx4 v23, s[24:27], s51 offen offset:0 lds
    v_mfma_f32_16x16x32_bf16 v[152:155], a[104:107], a[124:127], v[152:155]
    v_mfma_f32_16x16x32_bf16 v[120:123], a[116:119], a[108:111], v[120:123]
    v_mfma_f32_16x16x32_bf16 v[136:139], a[120:123], a[108:111], v[136:139]
    buffer_load_dwordx4 v24, s[24:27], s51 offen offset:1024 lds
    v_mfma_f32_16x16x32_bf16 v[156:159], a[108:111], a[124:127], v[156:159]
    v_mfma_f32_16x16x32_bf16 v[140:143], a[120:123], a[112:115], v[140:143]
    v_mfma_f32_16x16x32_bf16 v[160:163], a[112:115], a[124:127], v[160:163]
    s_waitcnt lgkmcnt(0)
    s_waitcnt vmcnt(11)
    s_barrier
    s_lshl_b32 s48, s46, 10
    s_lshl_b32 s50, s3, 8
    s_add_u32 s48, s48, s50
    s_lshl_b32 s50, s44, 3
    s_add_u32 s48, s48, s50
    s_add_u32 s48, s48, 393216
    v_lshlrev_b32 v10, 3, v1
    s_mov_b64 exec, 1
    buffer_store_dwordx2 v[172:173], v10, s[20:23], s48 offen sc1
    s_mov_b64 exec, -1
    v_mfma_f32_16x16x32_bf16 v[108:111], a[20:23], a[0:3], v[108:111]
    s_add_u32 s51, s47, 5
    s_and_b32 s51, s51, 7
    s_add_u32 m0, s64, 65536
    s_mul_i32 s52, s51, 196608
    buffer_load_dwordx4 v20, s[12:15], s52 offen offset:0 lds
    ds_read_b64_tr_b16 a[84:85], v31 offset:28672
    v_mfma_f32_16x16x32_bf16 v[124:127], a[24:27], a[0:3], v[124:127]
    ds_read_b64_tr_b16 a[86:87], v31 offset:29184
    v_mfma_f32_16x16x32_bf16 v[144:147], a[0:3], a[28:31], v[144:147]
    ds_read_b64_tr_b16 a[88:89], v31 offset:29696
    v_mfma_f32_16x16x32_bf16 v[112:115], a[20:23], a[4:7], v[112:115]
    buffer_load_dwordx4 v20, s[12:15], s52 offen offset:1024 lds
    ds_read_b64_tr_b16 a[90:91], v31 offset:30208
    v_mfma_f32_16x16x32_bf16 v[128:131], a[24:27], a[4:7], v[128:131]
    ds_read_b64_tr_b16 a[92:93], v31 offset:30720
    v_mfma_f32_16x16x32_bf16 v[148:151], a[4:7], a[28:31], v[148:151]
    ds_read_b64_tr_b16 a[94:95], v31 offset:31232
    ds_read_b128 a[64:67], v14 offset:24576
    v_mfma_f32_16x16x32_bf16 v[116:119], a[20:23], a[8:11], v[116:119]
    ds_read_b128 a[68:71], v14 offset:26624
    v_mfma_f32_16x16x32_bf16 v[132:135], a[24:27], a[8:11], v[132:135]
    buffer_load_dwordx4 v20, s[12:15], s52 offen offset:2048 lds
    s_add_u32 m0, s64, 68608
    ds_read_b128 a[72:75], v14 offset:28672
    v_mfma_f32_16x16x32_bf16 v[152:155], a[8:11], a[28:31], v[152:155]
    ds_read_b128 a[76:79], v14 offset:30720
    v_mfma_f32_16x16x32_bf16 v[120:123], a[20:23], a[12:15], v[120:123]
    ds_read_b128 a[80:83], v27 offset:2048
    v_mfma_f32_16x16x32_bf16 v[136:139], a[24:27], a[12:15], v[136:139]
    buffer_load_dwordx4 v21, s[12:15], s52 offen offset:0 lds
    ds_read_b64_tr_b16 a[116:117], v31 offset:40960
    v_mfma_f32_16x16x32_bf16 v[156:159], a[12:15], a[28:31], v[156:159]
    ds_read_b64_tr_b16 a[118:119], v31 offset:41472
    ds_read_b64_tr_b16 a[120:121], v31 offset:41984
    v_mfma_f32_16x16x32_bf16 v[140:143], a[24:27], a[16:19], v[140:143]
    ds_read_b64_tr_b16 a[122:123], v31 offset:42496
    v_mfma_f32_16x16x32_bf16 v[160:163], a[16:19], a[28:31], v[160:163]
    ds_read_b64_tr_b16 a[124:125], v31 offset:43008
    v_mfma_f32_16x16x32_bf16 v[108:111], a[52:55], a[32:35], v[108:111]
    buffer_load_dwordx4 v21, s[12:15], s52 offen offset:1024 lds
    ds_read_b64_tr_b16 a[126:127], v31 offset:43520
    v_mfma_f32_16x16x32_bf16 v[124:127], a[56:59], a[32:35], v[124:127]
    ds_read_b128 a[96:99], v15 offset:24576
    v_mfma_f32_16x16x32_bf16 v[144:147], a[32:35], a[60:63], v[144:147]
    ds_read_b128 a[100:103], v15 offset:26624
    v_mfma_f32_16x16x32_bf16 v[112:115], a[52:55], a[36:39], v[112:115]
    buffer_load_dwordx4 v21, s[12:15], s52 offen offset:2048 lds
    ds_read_b128 a[104:107], v15 offset:28672
    ds_read_b128 a[108:111], v15 offset:30720
    v_mfma_f32_16x16x32_bf16 v[128:131], a[56:59], a[36:39], v[128:131]
    ds_read_b128 a[112:115], v28 offset:2048
    v_mfma_f32_16x16x32_bf16 v[148:151], a[36:39], a[60:63], v[148:151]
    v_mfma_f32_16x16x32_bf16 v[116:119], a[52:55], a[40:43], v[116:119]
    v_mfma_f32_16x16x32_bf16 v[132:135], a[56:59], a[40:43], v[132:135]
    s_add_u32 m0, s62, 16384
    s_add_u32 s51, s75, 2
    s_and_b32 s51, s51, 7
    s_lshl_b32 s51, s51, 7
    buffer_load_dwordx4 v23, s[24:27], s51 offen offset:0 lds
    v_mfma_f32_16x16x32_bf16 v[152:155], a[40:43], a[60:63], v[152:155]
    v_mfma_f32_16x16x32_bf16 v[120:123], a[52:55], a[44:47], v[120:123]
    v_mfma_f32_16x16x32_bf16 v[136:139], a[56:59], a[44:47], v[136:139]
    buffer_load_dwordx4 v24, s[24:27], s51 offen offset:1024 lds
    v_mfma_f32_16x16x32_bf16 v[156:159], a[44:47], a[60:63], v[156:159]
    v_mfma_f32_16x16x32_bf16 v[140:143], a[56:59], a[48:51], v[140:143]
    v_mfma_f32_16x16x32_bf16 v[160:163], a[48:51], a[60:63], v[160:163]
    s_waitcnt lgkmcnt(0)
    s_waitcnt vmcnt(11)
    s_barrier
    v_mfma_f32_16x16x32_bf16 v[108:111], a[84:87], a[64:67], v[108:111]
    s_add_u32 s51, s47, 6
    s_and_b32 s51, s51, 7
    s_add_u32 m0, s64, 94208
    s_mul_i32 s52, s51, 196608
    buffer_load_dwordx4 v20, s[12:15], s52 offen offset:0 lds
    ds_read_b64_tr_b16 a[20:21], v32 offset:0
    v_mfma_f32_16x16x32_bf16 v[124:127], a[88:91], a[64:67], v[124:127]
    ds_read_b64_tr_b16 a[22:23], v32 offset:512
    v_mfma_f32_16x16x32_bf16 v[144:147], a[64:67], a[92:95], v[144:147]
    ds_read_b64_tr_b16 a[24:25], v32 offset:1024
    v_mfma_f32_16x16x32_bf16 v[112:115], a[84:87], a[68:71], v[112:115]
    buffer_load_dwordx4 v20, s[12:15], s52 offen offset:1024 lds
    ds_read_b64_tr_b16 a[26:27], v32 offset:1536
    v_mfma_f32_16x16x32_bf16 v[128:131], a[88:91], a[68:71], v[128:131]
    ds_read_b64_tr_b16 a[28:29], v32 offset:2048
    v_mfma_f32_16x16x32_bf16 v[148:151], a[68:71], a[92:95], v[148:151]
    ds_read_b64_tr_b16 a[30:31], v32 offset:2560
    ds_read_b128 a[0:3], v14 offset:32768
    v_mfma_f32_16x16x32_bf16 v[116:119], a[84:87], a[72:75], v[116:119]
    buffer_load_dwordx4 v20, s[12:15], s52 offen offset:2048 lds
    s_add_u32 m0, s64, 97280
    ds_read_b128 a[4:7], v14 offset:34816
    v_mfma_f32_16x16x32_bf16 v[132:135], a[88:91], a[72:75], v[132:135]
    ds_read_b128 a[8:11], v14 offset:36864
    v_mfma_f32_16x16x32_bf16 v[152:155], a[72:75], a[92:95], v[152:155]
    ds_read_b128 a[12:15], v14 offset:38912
    v_mfma_f32_16x16x32_bf16 v[120:123], a[84:87], a[76:79], v[120:123]
    buffer_load_dwordx4 v21, s[12:15], s52 offen offset:0 lds
    ds_read_b128 a[16:19], v27 offset:57344
    v_mfma_f32_16x16x32_bf16 v[136:139], a[88:91], a[76:79], v[136:139]
    ds_read_b64_tr_b16 a[52:53], v32 offset:12288
    v_mfma_f32_16x16x32_bf16 v[156:159], a[76:79], a[92:95], v[156:159]
    ds_read_b64_tr_b16 a[54:55], v32 offset:12800
    ds_read_b64_tr_b16 a[56:57], v32 offset:13312
    v_mfma_f32_16x16x32_bf16 v[140:143], a[88:91], a[80:83], v[140:143]
    buffer_load_dwordx4 v21, s[12:15], s52 offen offset:1024 lds
    ds_read_b64_tr_b16 a[58:59], v32 offset:13824
    v_mfma_f32_16x16x32_bf16 v[160:163], a[80:83], a[92:95], v[160:163]
    ds_read_b64_tr_b16 a[60:61], v32 offset:14336
    v_mfma_f32_16x16x32_bf16 v[108:111], a[116:119], a[96:99], v[108:111]
    ds_read_b64_tr_b16 a[62:63], v32 offset:14848
    v_mfma_f32_16x16x32_bf16 v[124:127], a[120:123], a[96:99], v[124:127]
    buffer_load_dwordx4 v21, s[12:15], s52 offen offset:2048 lds
    ds_read_b128 a[32:35], v15 offset:32768
    v_mfma_f32_16x16x32_bf16 v[144:147], a[96:99], a[124:127], v[144:147]
    ds_read_b128 a[36:39], v15 offset:34816
    v_mfma_f32_16x16x32_bf16 v[112:115], a[116:119], a[100:103], v[112:115]
    ds_read_b128 a[40:43], v15 offset:36864
    ds_read_b128 a[44:47], v15 offset:38912
    v_mfma_f32_16x16x32_bf16 v[128:131], a[120:123], a[100:103], v[128:131]
    s_add_u32 m0, s65, 118784
    s_add_u32 s51, s66, 6
    s_and_b32 s51, s51, 7
    s_lshl_b32 s51, s51, 7
    buffer_load_dwordx4 v22, s[4:7], s51 offen offset:0 lds
    ds_read_b128 a[48:51], v28 offset:57344
    v_mfma_f32_16x16x32_bf16 v[148:151], a[100:103], a[124:127], v[148:151]
    v_mfma_f32_16x16x32_bf16 v[116:119], a[116:119], a[104:107], v[116:119]
    v_mfma_f32_16x16x32_bf16 v[132:135], a[120:123], a[104:107], v[132:135]
    s_add_u32 m0, s62, 24576
    s_add_u32 s51, s75, 3
    s_and_b32 s51, s51, 7
    s_lshl_b32 s51, s51, 7
    buffer_load_dwordx4 v23, s[24:27], s51 offen offset:0 lds
    v_mfma_f32_16x16x32_bf16 v[152:155], a[104:107], a[124:127], v[152:155]
    v_mfma_f32_16x16x32_bf16 v[120:123], a[116:119], a[108:111], v[120:123]
L_h3:
    s_cbranch_execz L_h7
    v_mfma_f32_16x16x32_bf16 v[136:139], a[120:123], a[108:111], v[136:139]
    buffer_load_dwordx4 v24, s[24:27], s51 offen offset:1024 lds
    v_mfma_f32_16x16x32_bf16 v[156:159], a[108:111], a[124:127], v[156:159]
    v_mfma_f32_16x16x32_bf16 v[140:143], a[120:123], a[112:115], v[140:143]
    v_mfma_f32_16x16x32_bf16 v[160:163], a[112:115], a[124:127], v[160:163]
    s_waitcnt lgkmcnt(0)
    s_waitcnt vmcnt(11)
    s_barrier
    v_mfma_f32_16x16x32_bf16 v[108:111], a[20:23], a[0:3], v[108:111]
    s_add_u32 s51, s47, 7
    s_and_b32 s51, s51, 7
    s_add_u32 m0, s64, 122880
    s_mul_i32 s52, s51, 196608
    buffer_load_dwordx4 v20, s[12:15], s52 offen offset:0 lds
    ds_read_b64_tr_b16 a[84:85], v31 offset:0
    v_mfma_f32_16x16x32_bf16 v[124:127], a[24:27], a[0:3], v[124:127]
    ds_read_b64_tr_b16 a[86:87], v31 offset:512
    v_mfma_f32_16x16x32_bf16 v[144:147], a[0:3], a[28:31], v[144:147]
    ds_read_b64_tr_b16 a[88:89], v31 offset:1024
    v_mfma_f32_16x16x32_bf16 v[112:115], a[20:23], a[4:7], v[112:115]
    buffer_load_dwordx4 v20, s[12:15], s52 offen offset:1024 lds
    ds_read_b64_tr_b16 a[90:91], v31 offset:1536
    v_mfma_f32_16x16x32_bf16 v[128:131], a[24:27], a[4:7], v[128:131]
    ds_read_b64_tr_b16 a[92:93], v31 offset:2048
    v_mfma_f32_16x16x32_bf16 v[148:151], a[4:7], a[28:31], v[148:151]
    ds_read_b64_tr_b16 a[94:95], v31 offset:2560
    ds_read_b128 a[64:67], v14 offset:40960
    v_mfma_f32_16x16x32_bf16 v[116:119], a[20:23], a[8:11], v[116:119]
    ds_read_b128 a[68:71], v14 offset:43008
    v_mfma_f32_16x16x32_bf16 v[132:135], a[24:27], a[8:11], v[132:135]
    buffer_load_dwordx4 v20, s[12:15], s52 offen offset:2048 lds
    s_add_u32 m0, s64, 125952
    ds_read_b128 a[72:75], v14 offset:45056
    v_mfma_f32_16x16x32_bf16 v[152:155], a[8:11], a[28:31], v[152:155]
    ds_read_b128 a[76:79], v14 offset:47104
    v_mfma_f32_16x16x32_bf16 v[120:123], a[20:23], a[12:15], v[120:123]
    ds_read_b128 a[80:83], v27 offset:59392
    v_mfma_f32_16x16x32_bf16 v[136:139], a[24:27], a[12:15], v[136:139]
    buffer_load_dwordx4 v21, s[12:15], s52 offen offset:0 lds
    ds_read_b64_tr_b16 a[116:117], v31 offset:12288
    v_mfma_f32_16x16x32_bf16 v[156:159], a[12:15], a[28:31], v[156:159]
    ds_read_b64_tr_b16 a[118:119], v31 offset:12800
    ds_read_b64_tr_b16 a[120:121], v31 offset:13312
    v_mfma_f32_16x16x32_bf16 v[140:143], a[24:27], a[16:19], v[140:143]
    ds_read_b64_tr_b16 a[122:123], v31 offset:13824
    v_mfma_f32_16x16x32_bf16 v[160:163], a[16:19], a[28:31], v[160:163]
    ds_read_b64_tr_b16 a[124:125], v31 offset:14336
    v_mfma_f32_16x16x32_bf16 v[108:111], a[52:55], a[32:35], v[108:111]
    buffer_load_dwordx4 v21, s[12:15], s52 offen offset:1024 lds
    ds_read_b64_tr_b16 a[126:127], v31 offset:14848
    v_mfma_f32_16x16x32_bf16 v[124:127], a[56:59], a[32:35], v[124:127]
    ds_read_b128 a[96:99], v15 offset:40960
    v_mfma_f32_16x16x32_bf16 v[144:147], a[32:35], a[60:63], v[144:147]
    ds_read_b128 a[100:103], v15 offset:43008
    v_mfma_f32_16x16x32_bf16 v[112:115], a[52:55], a[36:39], v[112:115]
    buffer_load_dwordx4 v21, s[12:15], s52 offen offset:2048 lds
    ds_read_b128 a[104:107], v15 offset:45056
    ds_read_b128 a[108:111], v15 offset:47104
    v_mfma_f32_16x16x32_bf16 v[128:131], a[56:59], a[36:39], v[128:131]
    ds_read_b128 a[112:115], v28 offset:59392
    v_mfma_f32_16x16x32_bf16 v[148:151], a[36:39], a[60:63], v[148:151]
    v_mfma_f32_16x16x32_bf16 v[116:119], a[52:55], a[40:43], v[116:119]
    v_mfma_f32_16x16x32_bf16 v[132:135], a[56:59], a[40:43], v[132:135]
    s_add_u32 m0, s62, 32768
    s_add_u32 s51, s75, 4
    s_and_b32 s51, s51, 7
    s_lshl_b32 s51, s51, 7
    buffer_load_dwordx4 v23, s[24:27], s51 offen offset:0 lds
    v_mfma_f32_16x16x32_bf16 v[152:155], a[40:43], a[60:63], v[152:155]
    v_mfma_f32_16x16x32_bf16 v[120:123], a[52:55], a[44:47], v[120:123]
    v_mfma_f32_16x16x32_bf16 v[136:139], a[56:59], a[44:47], v[136:139]
    buffer_load_dwordx4 v24, s[24:27], s51 offen offset:1024 lds
    v_mfma_f32_16x16x32_bf16 v[156:159], a[44:47], a[60:63], v[156:159]
    v_mfma_f32_16x16x32_bf16 v[140:143], a[56:59], a[48:51], v[140:143]
    v_mfma_f32_16x16x32_bf16 v[160:163], a[48:51], a[60:63], v[160:163]
    s_waitcnt lgkmcnt(0)
    s_waitcnt vmcnt(10)
    s_barrier
    v_min_u32 v185, 31, v1
    v_lshlrev_b32 v185, 3, v185
    s_lshl_b32 s72, s46, 10
    s_lshl_b32 s50, s3, 8
    s_add_u32 s72, s72, s50
    s_add_u32 s72, s72, 393216
    buffer_load_dwordx2 v[174:175], v185, s[20:23], s72 offen sc1
    v_mfma_f32_16x16x32_bf16 v[108:111], a[84:87], a[64:67], v[108:111]
    s_add_u32 m0, s62, 40960
    s_add_u32 s51, s75, 5
    s_and_b32 s51, s51, 7
    s_lshl_b32 s51, s51, 7
    buffer_load_dwordx4 v23, s[24:27], s51 offen offset:0 lds
    ds_read_b64_tr_b16 a[20:21], v31 offset:28672
    v_mfma_f32_16x16x32_bf16 v[124:127], a[88:91], a[64:67], v[124:127]
    ds_read_b64_tr_b16 a[22:23], v31 offset:29184
    v_mfma_f32_16x16x32_bf16 v[144:147], a[64:67], a[92:95], v[144:147]
    ds_read_b64_tr_b16 a[24:25], v31 offset:29696
    v_mfma_f32_16x16x32_bf16 v[112:115], a[84:87], a[68:71], v[112:115]
    buffer_load_dwordx4 v24, s[24:27], s51 offen offset:1024 lds
    ds_read_b64_tr_b16 a[26:27], v31 offset:30208
    v_mfma_f32_16x16x32_bf16 v[128:131], a[88:91], a[68:71], v[128:131]
    ds_read_b64_tr_b16 a[28:29], v31 offset:30720
    v_mfma_f32_16x16x32_bf16 v[148:151], a[68:71], a[92:95], v[148:151]
    ds_read_b64_tr_b16 a[30:31], v31 offset:31232
    ds_read_b128 a[0:3], v14 offset:49152
    v_mfma_f32_16x16x32_bf16 v[116:119], a[84:87], a[72:75], v[116:119]
    ds_read_b128 a[4:7], v14 offset:51200
    v_mfma_f32_16x16x32_bf16 v[132:135], a[88:91], a[72:75], v[132:135]
    s_add_u32 m0, s62, 65536
    s_add_u32 s51, s75, 0
    s_and_b32 s51, s51, 7
    s_lshl_b32 s51, s51, 7
    s_add_u32 s51, s51, 1024
    buffer_load_dwordx4 v23, s[24:27], s51 offen offset:0 lds
    ds_read_b128 a[8:11], v14 offset:53248
    v_mfma_f32_16x16x32_bf16 v[152:155], a[72:75], a[92:95], v[152:155]
    ds_read_b128 a[12:15], v14 offset:55296
    v_mfma_f32_16x16x32_bf16 v[120:123], a[84:87], a[76:79], v[120:123]
    ds_read_b128 a[16:19], v27 offset:28672
    v_mfma_f32_16x16x32_bf16 v[136:139], a[88:91], a[76:79], v[136:139]
    buffer_load_dwordx4 v24, s[24:27], s51 offen offset:1024 lds
    ds_read_b64_tr_b16 a[52:53], v31 offset:40960
    v_mfma_f32_16x16x32_bf16 v[156:159], a[76:79], a[92:95], v[156:159]
    ds_read_b64_tr_b16 a[54:55], v31 offset:41472
    ds_read_b64_tr_b16 a[56:57], v31 offset:41984
    v_mfma_f32_16x16x32_bf16 v[140:143], a[88:91], a[80:83], v[140:143]
    ds_read_b64_tr_b16 a[58:59], v31 offset:42496
    v_mfma_f32_16x16x32_bf16 v[160:163], a[80:83], a[92:95], v[160:163]
    ds_read_b64_tr_b16 a[60:61], v31 offset:43008
    v_mfma_f32_16x16x32_bf16 v[108:111], a[116:119], a[96:99], v[108:111]
    s_add_u32 m0, s62, 73728
    s_add_u32 s51, s75, 1
    s_and_b32 s51, s51, 7
    s_lshl_b32 s51, s51, 7
    s_add_u32 s51, s51, 1024
    buffer_load_dwordx4 v23, s[24:27], s51 offen offset:0 lds
    ds_read_b64_tr_b16 a[62:63], v31 offset:43520
    v_mfma_f32_16x16x32_bf16 v[124:127], a[120:123], a[96:99], v[124:127]
    ds_read_b128 a[32:35], v15 offset:49152
    v_mfma_f32_16x16x32_bf16 v[144:147], a[96:99], a[124:127], v[144:147]
    ds_read_b128 a[36:39], v15 offset:51200
    v_mfma_f32_16x16x32_bf16 v[112:115], a[116:119], a[100:103], v[112:115]
    buffer_load_dwordx4 v24, s[24:27], s51 offen offset:1024 lds
    ds_read_b128 a[40:43], v15 offset:53248
    ds_read_b128 a[44:47], v15 offset:55296
    v_mfma_f32_16x16x32_bf16 v[128:131], a[120:123], a[100:103], v[128:131]
    ds_read_b128 a[48:51], v28 offset:28672
    v_mfma_f32_16x16x32_bf16 v[148:151], a[100:103], a[124:127], v[148:151]
    v_mfma_f32_16x16x32_bf16 v[116:119], a[116:119], a[104:107], v[116:119]
    v_mfma_f32_16x16x32_bf16 v[132:135], a[120:123], a[104:107], v[132:135]
    s_add_u32 m0, s62, 81920
    s_add_u32 s51, s75, 2
    s_and_b32 s51, s51, 7
    s_lshl_b32 s51, s51, 7
    s_add_u32 s51, s51, 1024
    buffer_load_dwordx4 v23, s[24:27], s51 offen offset:0 lds
    v_mfma_f32_16x16x32_bf16 v[152:155], a[104:107], a[124:127], v[152:155]
    v_mfma_f32_16x16x32_bf16 v[120:123], a[116:119], a[108:111], v[120:123]
    v_mfma_f32_16x16x32_bf16 v[136:139], a[120:123], a[108:111], v[136:139]
    buffer_load_dwordx4 v24, s[24:27], s51 offen offset:1024 lds
    v_mfma_f32_16x16x32_bf16 v[156:159], a[108:111], a[124:127], v[156:159]
    v_mfma_f32_16x16x32_bf16 v[140:143], a[120:123], a[112:115], v[140:143]
    v_mfma_f32_16x16x32_bf16 v[160:163], a[112:115], a[124:127], v[160:163]
    s_waitcnt lgkmcnt(0)
    s_waitcnt vmcnt(11)
    s_barrier
    v_mfma_f32_16x16x32_bf16 v[108:111], a[20:23], a[0:3], v[108:111]
    s_add_u32 m0, s62, 49152
    s_add_u32 s51, s75, 6
    s_and_b32 s51, s51, 7
    s_lshl_b32 s51, s51, 7
    buffer_load_dwordx4 v23, s[24:27], s51 offen offset:0 lds
    ds_read_b64_tr_b16 a[84:85], v32 offset:0
    v_mfma_f32_16x16x32_bf16 v[124:127], a[24:27], a[0:3], v[124:127]
    ds_read_b64_tr_b16 a[86:87], v32 offset:512
    v_mfma_f32_16x16x32_bf16 v[144:147], a[0:3], a[28:31], v[144:147]
    ds_read_b64_tr_b16 a[88:89], v32 offset:1024
    v_mfma_f32_16x16x32_bf16 v[112:115], a[20:23], a[4:7], v[112:115]
    buffer_load_dwordx4 v24, s[24:27], s51 offen offset:1024 lds
    ds_read_b64_tr_b16 a[90:91], v32 offset:1536
    v_mfma_f32_16x16x32_bf16 v[128:131], a[24:27], a[4:7], v[128:131]
    ds_read_b64_tr_b16 a[92:93], v32 offset:2048
    v_mfma_f32_16x16x32_bf16 v[148:151], a[4:7], a[28:31], v[148:151]
    ds_read_b64_tr_b16 a[94:95], v32 offset:2560
    ds_read_b128 a[64:67], v14 offset:57344
    v_mfma_f32_16x16x32_bf16 v[116:119], a[20:23], a[8:11], v[116:119]
    ds_read_b128 a[68:71], v14 offset:59392
    v_mfma_f32_16x16x32_bf16 v[132:135], a[24:27], a[8:11], v[132:135]
    s_add_u32 m0, s62, 90112
    s_add_u32 s51, s75, 3
    s_and_b32 s51, s51, 7
    s_lshl_b32 s51, s51, 7
    s_add_u32 s51, s51, 1024
    buffer_load_dwordx4 v23, s[24:27], s51 offen offset:0 lds
    ds_read_b128 a[72:75], v14 offset:61440
    v_mfma_f32_16x16x32_bf16 v[152:155], a[8:11], a[28:31], v[152:155]
    ds_read_b128 a[76:79], v14 offset:63488
    v_mfma_f32_16x16x32_bf16 v[120:123], a[20:23], a[12:15], v[120:123]
    ds_read_b128 a[80:83], v27 offset:30720
    v_mfma_f32_16x16x32_bf16 v[136:139], a[24:27], a[12:15], v[136:139]
    buffer_load_dwordx4 v24, s[24:27], s51 offen offset:1024 lds
    ds_read_b64_tr_b16 a[116:117], v32 offset:12288
    v_mfma_f32_16x16x32_bf16 v[156:159], a[12:15], a[28:31], v[156:159]
    ds_read_b64_tr_b16 a[118:119], v32 offset:12800
    ds_read_b64_tr_b16 a[120:121], v32 offset:13312
    v_mfma_f32_16x16x32_bf16 v[140:143], a[24:27], a[16:19], v[140:143]
    ds_read_b64_tr_b16 a[122:123], v32 offset:13824
    v_mfma_f32_16x16x32_bf16 v[160:163], a[16:19], a[28:31], v[160:163]
    ds_read_b64_tr_b16 a[124:125], v32 offset:14336
    v_mfma_f32_16x16x32_bf16 v[108:111], a[52:55], a[32:35], v[108:111]
    s_add_u32 m0, s62, 98304
    s_add_u32 s51, s75, 4
    s_and_b32 s51, s51, 7
    s_lshl_b32 s51, s51, 7
    s_add_u32 s51, s51, 1024
    buffer_load_dwordx4 v23, s[24:27], s51 offen offset:0 lds
    ds_read_b64_tr_b16 a[126:127], v32 offset:14848
    v_mfma_f32_16x16x32_bf16 v[124:127], a[56:59], a[32:35], v[124:127]
    ds_read_b128 a[96:99], v15 offset:57344
    v_mfma_f32_16x16x32_bf16 v[144:147], a[32:35], a[60:63], v[144:147]
    ds_read_b128 a[100:103], v15 offset:59392
    v_mfma_f32_16x16x32_bf16 v[112:115], a[52:55], a[36:39], v[112:115]
    buffer_load_dwordx4 v24, s[24:27], s51 offen offset:1024 lds
    ds_read_b128 a[104:107], v15 offset:61440
    ds_read_b128 a[108:111], v15 offset:63488
    v_mfma_f32_16x16x32_bf16 v[128:131], a[56:59], a[36:39], v[128:131]
    ds_read_b128 a[112:115], v28 offset:30720
    v_mfma_f32_16x16x32_bf16 v[148:151], a[36:39], a[60:63], v[148:151]
    v_mfma_f32_16x16x32_bf16 v[116:119], a[52:55], a[40:43], v[116:119]
    v_mfma_f32_16x16x32_bf16 v[132:135], a[56:59], a[40:43], v[132:135]
    s_add_u32 m0, s62, 106496
    s_add_u32 s51, s75, 5
    s_and_b32 s51, s51, 7
    s_lshl_b32 s51, s51, 7
    s_add_u32 s51, s51, 1024
    buffer_load_dwordx4 v23, s[24:27], s51 offen offset:0 lds
    v_mfma_f32_16x16x32_bf16 v[152:155], a[40:43], a[60:63], v[152:155]
    v_mfma_f32_16x16x32_bf16 v[120:123], a[52:55], a[44:47], v[120:123]
    v_mfma_f32_16x16x32_bf16 v[136:139], a[56:59], a[44:47], v[136:139]
    buffer_load_dwordx4 v24, s[24:27], s51 offen offset:1024 lds
    v_mfma_f32_16x16x32_bf16 v[156:159], a[44:47], a[60:63], v[156:159]
    v_mfma_f32_16x16x32_bf16 v[140:143], a[56:59], a[48:51], v[140:143]
    v_mfma_f32_16x16x32_bf16 v[160:163], a[48:51], a[60:63], v[160:163]
    s_waitcnt lgkmcnt(0)
    s_barrier
    s_waitcnt vmcnt(16)
    s_mov_b32 s58, 0x40000
L_poll1:
    v_cmp_ne_u64 vcc, s[56:57], v[174:175]
    s_nop 4
    s_cbranch_vccz L_polld1
    s_sub_u32 s58, s58, 1
    s_cbranch_scc1 L_polld1
    s_sleep 1
    v_min_u32 v185, 31, v1
    v_lshlrev_b32 v185, 3, v185
    s_lshl_b32 s72, s46, 10
    s_lshl_b32 s50, s3, 8
    s_add_u32 s72, s72, s50
    s_add_u32 s72, s72, 393216
    buffer_load_dwordx2 v[174:175], v185, s[20:23], s72 offen sc1
    s_waitcnt vmcnt(0)
    s_branch L_poll1
L_polld1:
    v_mfma_f32_16x16x32_bf16 v[108:111], a[84:87], a[64:67], v[108:111]
    s_add_u32 s71, s75, 0
    s_and_b32 s71, s71, 7
    s_lshl_b32 s71, s71, 11
    buffer_load_dwordx4 a[128:131], v186, s[20:23], s71 offen offset:0 sc1
    ds_read_b128 a[0:3], v14 offset:0
    v_mfma_f32_16x16x32_bf16 v[124:127], a[88:91], a[64:67], v[124:127]
    v_mfma_f32_16x16x32_bf16 v[144:147], a[64:67], a[92:95], v[144:147]
    buffer_load_dwordx4 a[136:139], v187, s[20:23], s71 offen offset:0 sc1
    v_mfma_f32_16x16x32_bf16 v[112:115], a[84:87], a[68:71], v[112:115]
    ds_read_b128 a[4:7], v14 offset:2048
    v_mfma_f32_16x16x32_bf16 v[128:131], a[88:91], a[68:71], v[128:131]
    buffer_load_dwordx4 a[132:135], v186, s[20:23], s71 offen offset:1024 sc1
    v_mfma_f32_16x16x32_bf16 v[148:151], a[68:71], a[92:95], v[148:151]
    ds_read_b128 a[8:11], v14 offset:4096
    v_mfma_f32_16x16x32_bf16 v[116:119], a[84:87], a[72:75], v[116:119]
    buffer_load_dwordx4 a[140:143], v187, s[20:23], s71 offen offset:1024 sc1
    v_mfma_f32_16x16x32_bf16 v[132:135], a[88:91], a[72:75], v[132:135]
    ds_read_b128 a[12:15], v14 offset:6144
    v_mfma_f32_16x16x32_bf16 v[152:155], a[72:75], a[92:95], v[152:155]
    s_add_u32 s71, s75, 1
    s_and_b32 s71, s71, 7
    s_lshl_b32 s71, s71, 11
    buffer_load_dwordx4 a[144:147], v186, s[20:23], s71 offen offset:0 sc1
    v_mfma_f32_16x16x32_bf16 v[120:123], a[84:87], a[76:79], v[120:123]
    v_mfma_f32_16x16x32_bf16 v[136:139], a[88:91], a[76:79], v[136:139]
    buffer_load_dwordx4 a[152:155], v187, s[20:23], s71 offen offset:0 sc1
    ds_read_b128 a[16:19], v15 offset:0
    v_mfma_f32_16x16x32_bf16 v[156:159], a[76:79], a[92:95], v[156:159]
    v_mfma_f32_16x16x32_bf16 v[140:143], a[88:91], a[80:83], v[140:143]
    buffer_load_dwordx4 a[148:151], v186, s[20:23], s71 offen offset:1024 sc1
    ds_read_b128 a[20:23], v15 offset:2048
    v_mfma_f32_16x16x32_bf16 v[160:163], a[80:83], a[92:95], v[160:163]
    v_mfma_f32_16x16x32_bf16 v[108:111], a[116:119], a[96:99], v[108:111]
    buffer_load_dwordx4 a[156:159], v187, s[20:23], s71 offen offset:1024 sc1
    ds_read_b128 a[24:27], v15 offset:4096
    v_mfma_f32_16x16x32_bf16 v[124:127], a[120:123], a[96:99], v[124:127]
    v_mfma_f32_16x16x32_bf16 v[144:147], a[96:99], a[124:127], v[144:147]
    s_add_u32 m0, s62, 57344
    s_add_u32 s51, s75, 7
    s_and_b32 s51, s51, 7
    s_lshl_b32 s51, s51, 7
    buffer_load_dwordx4 v23, s[24:27], s51 offen offset:0 lds
    v_mfma_f32_16x16x32_bf16 v[112:115], a[116:119], a[100:103], v[112:115]
    ds_read_b128 a[28:31], v15 offset:6144
    v_mfma_f32_16x16x32_bf16 v[128:131], a[120:123], a[100:103], v[128:131]
    buffer_load_dwordx4 v24, s[24:27], s51 offen offset:1024 lds
    v_mfma_f32_16x16x32_bf16 v[148:151], a[100:103], a[124:127], v[148:151]
    v_mfma_f32_16x16x32_bf16 v[116:119], a[116:119], a[104:107], v[116:119]
    s_add_u32 m0, s62, 114688
    s_add_u32 s51, s75, 6
    s_and_b32 s51, s51, 7
    s_lshl_b32 s51, s51, 7
    s_add_u32 s51, s51, 1024
    buffer_load_dwordx4 v23, s[24:27], s51 offen offset:0 lds
    v_mfma_f32_16x16x32_bf16 v[132:135], a[120:123], a[104:107], v[132:135]
    v_mfma_f32_16x16x32_bf16 v[152:155], a[104:107], a[124:127], v[152:155]
    buffer_load_dwordx4 v24, s[24:27], s51 offen offset:1024 lds
    v_mfma_f32_16x16x32_bf16 v[120:123], a[116:119], a[108:111], v[120:123]
    v_mfma_f32_16x16x32_bf16 v[136:139], a[120:123], a[108:111], v[136:139]
    s_add_u32 m0, s62, 122880
    s_add_u32 s51, s75, 7
    s_and_b32 s51, s51, 7
    s_lshl_b32 s51, s51, 7
    s_add_u32 s51, s51, 1024
    buffer_load_dwordx4 v23, s[24:27], s51 offen offset:0 lds
    v_mfma_f32_16x16x32_bf16 v[156:159], a[108:111], a[124:127], v[156:159]
    v_mfma_f32_16x16x32_bf16 v[140:143], a[120:123], a[112:115], v[140:143]
    buffer_load_dwordx4 v24, s[24:27], s51 offen offset:1024 lds
    v_mfma_f32_16x16x32_bf16 v[160:163], a[112:115], a[124:127], v[160:163]
    s_waitcnt lgkmcnt(4)
    s_waitcnt vmcnt(10)
    v_mfma_f32_16x16x32_bf16 v[40:43], a[128:131], a[0:3], 0
    s_add_u32 s71, s75, 2
    s_and_b32 s71, s71, 7
    s_lshl_b32 s71, s71, 11
    buffer_load_dwordx4 a[160:163], v186, s[20:23], s71 offen offset:0 sc1
    v_xor_b32 v246, 0, v37
    v_add_u32 v246, 65536, v246
    v_mfma_f32_16x16x32_bf16 v[44:47], a[128:131], a[4:7], 0
    ds_read_b128 a[64:67], v14 offset:8192
    v_xor_b32 v247, 32, v37
    v_add_u32 v247, 65536, v247
    v_mfma_f32_16x16x32_bf16 v[48:51], a[128:131], a[8:11], 0
    buffer_load_dwordx4 a[168:171], v187, s[20:23], s71 offen offset:0 sc1
    ds_read_b128 a[68:71], v14 offset:10240
    v_xor_b32 v248, 64, v37
    v_add_u32 v248, 65536, v248
    v_mfma_f32_16x16x32_bf16 v[52:55], a[128:131], a[12:15], 0
    v_xor_b32 v249, 96, v37
    v_add_u32 v249, 65536, v249
    v_mfma_f32_16x16x32_bf16 v[56:59], a[136:139], a[0:3], 0
    buffer_load_dwordx4 a[164:167], v186, s[20:23], s71 offen offset:1024 sc1
    ds_read_b128 a[72:75], v14 offset:12288
    v_add_u32 v25, 65536, v14
    v_add_u32 v26, 65536, v15
    v_mfma_f32_16x16x32_bf16 v[60:63], a[136:139], a[4:7], 0
    v_add_u32 v245, s62, v34
    v_mfma_f32_16x16x32_bf16 v[64:67], a[136:139], a[8:11], 0
    buffer_load_dwordx4 a[172:175], v187, s[20:23], s71 offen offset:1024 sc1
    ds_read_b128 a[76:79], v14 offset:14336
    s_lshl_b32 s48, s44, 7
    v_lshlrev_b32 v205, 2, v2
    buffer_load_dword v180, v205, s[36:39], s48 offen
    buffer_load_dword v181, v205, s[36:39], s48 offen offset:64
    v_mfma_f32_16x16x32_bf16 v[68:71], a[136:139], a[12:15], 0
    s_waitcnt lgkmcnt(4)
    v_mfma_f32_16x16x32_bf16 v[40:43], a[132:135], a[16:19], v[40:43]
    s_add_u32 s71, s75, 3
    s_and_b32 s71, s71, 7
    s_lshl_b32 s71, s71, 11
    buffer_load_dwordx4 a[176:179], v186, s[20:23], s71 offen offset:0 sc1
    ds_read_b128 a[80:83], v15 offset:8192
    v_mfma_f32_16x16x32_bf16 v[44:47], a[132:135], a[20:23], v[44:47]
    ds_read_b128 a[84:87], v15 offset:10240
    v_mov_b32 v244, 0xf149f2ca
    v_mfma_f32_16x16x32_bf16 v[48:51], a[132:135], a[24:27], v[48:51]
    buffer_load_dwordx4 a[184:187], v187, s[20:23], s71 offen offset:0 sc1
    s_cmp_eq_u32 s44, 0
    s_cselect_b32 s48, 0xf149f2ca, 0
    v_mov_b32 v207, s48
    v_mfma_f32_16x16x32_bf16 v[52:55], a[132:135], a[28:31], v[52:55]
    ds_read_b128 a[88:91], v15 offset:12288
    v_mfma_f32_16x16x32_bf16 v[56:59], a[140:143], a[16:19], v[56:59]
    buffer_load_dwordx4 a[180:183], v186, s[20:23], s71 offen offset:1024 sc1
    v_lshl_add_u32 v205, v3, 2, 0
    v_sub_u32 v206, v2, v205
    v_mfma_f32_16x16x32_bf16 v[60:63], a[140:143], a[20:23], v[60:63]
    ds_read_b128 a[92:95], v15 offset:14336
    v_cmp_lt_u32 vcc, 7, v206
    v_cmp_lt_i32 s[60:61], -9, v206
    s_nop 0
    v_cndmask_b32 v188, 0, v244, vcc
    v_cndmask_b32 v192, 0, v244, s[60:61]
    v_cndmask_b32 v200, v207, v244, s[60:61]
    v_mfma_f32_16x16x32_bf16 v[64:67], a[140:143], a[24:27], v[64:67]
    buffer_load_dwordx4 a[188:191], v187, s[20:23], s71 offen offset:1024 sc1
    v_mfma_f32_16x16x32_bf16 v[68:71], a[140:143], a[28:31], v[68:71]
    s_waitcnt lgkmcnt(4)
    s_waitcnt vmcnt(16)
    v_mfma_f32_16x16x32_bf16 v[40:43], a[144:147], a[64:67], v[40:43]
    s_add_u32 s71, s75, 4
    s_and_b32 s71, s71, 7
    s_lshl_b32 s71, s71, 11
    buffer_load_dwordx4 a[32:35], v186, s[20:23], s71 offen offset:0 sc1
    v_cmp_lt_i32 vcc, -1, v206
    v_cmp_lt_u32 s[60:61], 7, v205
    s_nop 0
    v_cndmask_b32 v196, v207, v244, vcc
    v_cndmask_b32 v196, v196, v244, s[60:61]
    v_mfma_f32_16x16x32_bf16 v[44:47], a[144:147], a[68:71], v[44:47]
    ds_read_b128 a[0:3], v14 offset:16384
    v_mfma_f32_16x16x32_bf16 v[48:51], a[144:147], a[72:75], v[48:51]
    ds_read_b128 a[4:7], v14 offset:18432
    v_lshl_add_u32 v205, v3, 2, 1
    v_sub_u32 v206, v2, v205
    v_mfma_f32_16x16x32_bf16 v[52:55], a[144:147], a[76:79], v[52:55]
    v_cmp_lt_u32 vcc, 7, v206
    v_cmp_lt_i32 s[60:61], -9, v206
    s_nop 0
    v_cndmask_b32 v189, 0, v244, vcc
    v_cndmask_b32 v193, 0, v244, s[60:61]
    v_cndmask_b32 v201, v207, v244, s[60:61]
    v_mfma_f32_16x16x32_bf16 v[56:59], a[152:155], a[64:67], v[56:59]
    buffer_load_dwordx4 a[40:43], v187, s[20:23], s71 offen offset:0 sc1
    ds_read_b128 a[8:11], v14 offset:20480
    v_mfma_f32_16x16x32_bf16 v[60:63], a[152:155], a[68:71], v[60:63]
    v_mfma_f32_16x16x32_bf16 v[64:67], a[152:155], a[72:75], v[64:67]
    ds_read_b128 a[12:15], v14 offset:22528
    v_cmp_lt_i32 vcc, -1, v206
    v_cmp_lt_u32 s[60:61], 7, v205
    s_nop 0
    v_cndmask_b32 v197, v207, v244, vcc
    v_cndmask_b32 v197, v197, v244, s[60:61]
    v_mfma_f32_16x16x32_bf16 v[68:71], a[152:155], a[76:79], v[68:71]
    s_waitcnt lgkmcnt(4)
    v_mfma_f32_16x16x32_bf16 v[40:43], a[148:151], a[80:83], v[40:43]
    buffer_load_dwordx4 a[36:39], v186, s[20:23], s71 offen offset:1024 sc1
    ds_read_b128 a[16:19], v15 offset:16384
    v_lshl_add_u32 v205, v3, 2, 2
    v_mfma_f32_16x16x32_bf16 v[44:47], a[148:151], a[84:87], v[44:47]
    ds_read_b128 a[20:23], v15 offset:18432
    v_sub_u32 v206, v2, v205
    v_cmp_lt_u32 vcc, 7, v206
    v_cmp_lt_i32 s[60:61], -9, v206
    s_nop 0
    v_cndmask_b32 v190, 0, v244, vcc
    v_cndmask_b32 v194, 0, v244, s[60:61]
    v_cndmask_b32 v202, v207, v244, s[60:61]
    v_mfma_f32_16x16x32_bf16 v[48:51], a[148:151], a[88:91], v[48:51]
    v_mfma_f32_16x16x32_bf16 v[52:55], a[148:151], a[92:95], v[52:55]
    ds_read_b128 a[24:27], v15 offset:20480
    v_mfma_f32_16x16x32_bf16 v[56:59], a[156:159], a[80:83], v[56:59]
    buffer_load_dwordx4 a[44:47], v187, s[20:23], s71 offen offset:1024 sc1
    v_cmp_lt_i32 vcc, -1, v206
    v_cmp_lt_u32 s[60:61], 7, v205
    s_nop 0
    v_cndmask_b32 v198, v207, v244, vcc
    v_cndmask_b32 v198, v198, v244, s[60:61]
    v_mfma_f32_16x16x32_bf16 v[60:63], a[156:159], a[84:87], v[60:63]
    ds_read_b128 a[28:31], v15 offset:22528
    v_mfma_f32_16x16x32_bf16 v[64:67], a[156:159], a[88:91], v[64:67]
    v_lshl_add_u32 v205, v3, 2, 3
    v_mfma_f32_16x16x32_bf16 v[68:71], a[156:159], a[92:95], v[68:71]
    v_sub_u32 v206, v2, v205
    s_waitcnt lgkmcnt(4)
    s_waitcnt vmcnt(10)
    v_mfma_f32_16x16x32_bf16 v[40:43], a[160:163], a[0:3], v[40:43]
    s_add_u32 s71, s75, 5
    s_and_b32 s71, s71, 7
    s_lshl_b32 s71, s71, 11
    buffer_load_dwordx4 a[48:51], v186, s[20:23], s71 offen offset:0 sc1
    v_cmp_lt_u32 vcc, 7, v206
    v_cmp_lt_i32 s[60:61], -9, v206
    s_nop 0
    v_cndmask_b32 v191, 0, v244, vcc
    v_cndmask_b32 v195, 0, v244, s[60:61]
    v_cndmask_b32 v203, v207, v244, s[60:61]
    v_mfma_f32_16x16x32_bf16 v[44:47], a[160:163], a[4:7], v[44:47]
    ds_read_b128 a[64:67], v14 offset:24576
    v_mfma_f32_16x16x32_bf16 v[48:51], a[160:163], a[8:11], v[48:51]
    buffer_load_dwordx4 a[56:59], v187, s[20:23], s71 offen offset:0 sc1
    ds_read_b128 a[68:71], v14 offset:26624
    v_cmp_lt_i32 vcc, -1, v206
    v_cmp_lt_u32 s[60:61], 7, v205
    s_nop 0
    v_cndmask_b32 v199, v207, v244, vcc
    v_cndmask_b32 v199, v199, v244, s[60:61]
    v_mfma_f32_16x16x32_bf16 v[52:55], a[160:163], a[12:15], v[52:55]
    ds_read_b128 a[72:75], v14 offset:28672
    v_mfma_f32_16x16x32_bf16 v[56:59], a[168:171], a[0:3], v[56:59]
    buffer_load_dwordx4 a[52:55], v186, s[20:23], s71 offen offset:1024 sc1
    v_cvt_pk_bf16_f32 v108, v108, v109
    v_mfma_f32_16x16x32_bf16 v[60:63], a[168:171], a[4:7], v[60:63]
    ds_read_b128 a[76:79], v14 offset:30720
    v_cvt_pk_bf16_f32 v109, v110, v111
    v_cvt_pk_bf16_f32 v112, v112, v113
    v_mfma_f32_16x16x32_bf16 v[64:67], a[168:171], a[8:11], v[64:67]
    buffer_load_dwordx4 a[60:63], v187, s[20:23], s71 offen offset:1024 sc1
    ds_read_b128 a[80:83], v15 offset:24576
    v_cvt_pk_bf16_f32 v113, v114, v115
    v_cvt_pk_bf16_f32 v116, v116, v117
    v_mfma_f32_16x16x32_bf16 v[68:71], a[168:171], a[12:15], v[68:71]
    ds_read_b128 a[84:87], v15 offset:26624
    v_cvt_pk_bf16_f32 v117, v118, v119
    v_cvt_pk_bf16_f32 v120, v120, v121
    s_waitcnt lgkmcnt(6)
    v_mfma_f32_16x16x32_bf16 v[40:43], a[164:167], a[16:19], v[40:43]
    s_add_u32 s71, s75, 6
    s_and_b32 s71, s71, 7
    s_lshl_b32 s71, s71, 11
    buffer_load_dwordx4 a[96:99], v186, s[20:23], s71 offen offset:0 sc1
    v_cvt_pk_bf16_f32 v121, v122, v123
    v_cvt_pk_bf16_f32 v124, v124, v125
    v_mfma_f32_16x16x32_bf16 v[44:47], a[164:167], a[20:23], v[44:47]
    ds_read_b128 a[88:91], v15 offset:28672
    v_cvt_pk_bf16_f32 v125, v126, v127
    v_cvt_pk_bf16_f32 v128, v128, v129
    v_mfma_f32_16x16x32_bf16 v[48:51], a[164:167], a[24:27], v[48:51]
    buffer_load_dwordx4 a[104:107], v187, s[20:23], s71 offen offset:0 sc1
    ds_read_b128 a[92:95], v15 offset:30720
    v_cvt_pk_bf16_f32 v129, v130, v131
    v_cvt_pk_bf16_f32 v132, v132, v133
    v_mfma_f32_16x16x32_bf16 v[52:55], a[164:167], a[28:31], v[52:55]
    v_cvt_pk_bf16_f32 v133, v134, v135
    v_cvt_pk_bf16_f32 v136, v136, v137
    v_mfma_f32_16x16x32_bf16 v[56:59], a[172:175], a[16:19], v[56:59]
    buffer_load_dwordx4 a[100:103], v186, s[20:23], s71 offen offset:1024 sc1
    v_cvt_pk_bf16_f32 v137, v138, v139
    v_cvt_pk_bf16_f32 v140, v140, v141
    v_mfma_f32_16x16x32_bf16 v[60:63], a[172:175], a[20:23], v[60:63]
    v_cvt_pk_bf16_f32 v141, v142, v143
    s_nop 1
    v_mfma_f32_16x16x16_bf16 v[208:211], v[140:141], v[108:109], v[196:199]
    v_mfma_f32_16x16x32_bf16 v[64:67], a[172:175], a[24:27], v[64:67]
    buffer_load_dwordx4 a[108:111], v187, s[20:23], s71 offen offset:1024 sc1
    v_mfma_f32_16x16x32_bf16 v[68:71], a[172:175], a[28:31], v[68:71]
    s_waitcnt lgkmcnt(0)
    s_barrier
    s_waitcnt vmcnt(12)
    v_mfma_f32_16x16x32_bf16 v[40:43], a[176:179], a[64:67], v[40:43]
    s_add_u32 s71, s75, 7
    s_and_b32 s71, s71, 7
    s_lshl_b32 s71, s71, 11
    buffer_load_dwordx4 a[112:115], v186, s[20:23], s71 offen offset:0 sc1
    v_mfma_f32_16x16x16_bf16 v[212:215], v[124:125], v[108:109], v[188:191]
    v_mfma_f32_16x16x32_bf16 v[44:47], a[176:179], a[68:71], v[44:47]
    ds_read_b128 a[0:3], v14 offset:32768
    v_mfma_f32_16x16x32_bf16 v[48:51], a[176:179], a[72:75], v[48:51]
    buffer_load_dwordx4 a[120:123], v187, s[20:23], s71 offen offset:0 sc1
    ds_read_b128 a[4:7], v14 offset:34816
    v_mfma_f32_16x16x16_bf16 v[216:219], v[124:125], v[112:113], v[192:195]
    v_mfma_f32_16x16x32_bf16 v[52:55], a[176:179], a[76:79], v[52:55]
    v_mfma_f32_16x16x32_bf16 v[56:59], a[184:187], a[64:67], v[56:59]
    ds_read_b128 a[8:11], v14 offset:36864
    v_mfma_f32_16x16x16_bf16 v[220:223], v[128:129], v[112:113], v[188:191]
    v_mfma_f32_16x16x32_bf16 v[60:63], a[184:187], a[68:71], v[60:63]
    s_add_u32 m0, s62, 0
    s_add_u32 s51, s75, 0
    s_and_b32 s51, s51, 7
    s_lshl_b32 s51, s51, 7
    s_add_u32 s51, s51, 2048
    buffer_load_dwordx4 v24, s[24:27], s51 offen offset:1024 lds
    v_mfma_f32_16x16x32_bf16 v[64:67], a[184:187], a[72:75], v[64:67]
    ds_read_b128 a[12:15], v14 offset:38912
    v_mfma_f32_16x16x16_bf16 v[224:227], v[140:141], v[116:117], v[200:203]
    v_mfma_f32_16x16x32_bf16 v[68:71], a[184:187], a[76:79], v[68:71]
    v_mfma_f32_16x16x32_bf16 v[40:43], a[180:183], a[80:83], v[40:43]
    buffer_load_dwordx4 a[116:119], v186, s[20:23], s71 offen offset:1024 sc1
    ds_read_b128 a[16:19], v15 offset:32768
    v_mfma_f32_16x16x32_bf16 v[44:47], a[180:183], a[84:87], v[44:47]
    ds_read_b128 a[20:23], v15 offset:34816
    v_mfma_f32_16x16x16_bf16 v[228:231], v[132:133], v[116:117], v[188:191]
    v_mfma_f32_16x16x32_bf16 v[48:51], a[180:183], a[88:91], v[48:51]
    buffer_load_dwordx4 a[124:127], v187, s[20:23], s71 offen offset:1024 sc1
    v_mfma_f32_16x16x32_bf16 v[52:55], a[180:183], a[92:95], v[52:55]
    ds_read_b128 a[24:27], v15 offset:36864
    v_mfma_f32_16x16x16_bf16 v[232:235], v[132:133], v[120:121], v[192:195]
    v_mfma_f32_16x16x32_bf16 v[56:59], a[188:191], a[80:83], v[56:59]
    v_mfma_f32_16x16x32_bf16 v[60:63], a[188:191], a[84:87], v[60:63]
    s_add_u32 m0, s62, 0
    s_add_u32 s51, s75, 0
    s_and_b32 s51, s51, 7
    s_lshl_b32 s51, s51, 7
    s_add_u32 s51, s51, 2048
L_h4:
    s_cbranch_execz L_h8
    buffer_load_dwordx4 v23, s[24:27], s51 offen offset:0 lds
    ds_read_b128 a[28:31], v15 offset:38912
    v_mfma_f32_16x16x16_bf16 v[236:239], v[136:137], v[120:121], v[188:191]
    v_mfma_f32_16x16x32_bf16 v[64:67], a[188:191], a[88:91], v[64:67]
    v_mfma_f32_16x16x32_bf16 v[68:71], a[188:191], a[92:95], v[68:71]
    s_waitcnt lgkmcnt(4)
    s_waitcnt vmcnt(14)
    v_mfma_f32_16x16x32_bf16 v[40:43], a[32:35], a[0:3], v[40:43]
    s_add_u32 s71, s75, 0
    s_and_b32 s71, s71, 7
    s_lshl_b32 s71, s71, 11
    s_add_u32 s71, s71, 16384
    buffer_load_dwordx4 a[128:131], v186, s[20:23], s71 offen offset:0 sc1
    v_cvt_pk_bf16_f32 v16, v160, v161
    v_cvt_pk_bf16_f32 v17, v162, v163
    v_mfma_f32_16x16x32_bf16 v[44:47], a[32:35], a[4:7], v[44:47]
    ds_read_b128 a[64:67], v14 offset:40960
    v_cvt_pk_bf16_f32 v18, v144, v145
    v_cvt_pk_bf16_f32 v19, v146, v147
    v_mfma_f32_16x16x32_bf16 v[48:51], a[32:35], a[8:11], v[48:51]
    ds_read_b128 a[68:71], v14 offset:43008
    v_cvt_pk_bf16_f32 v20, v148, v149
    v_cvt_pk_bf16_f32 v21, v150, v151
    v_mfma_f32_16x16x32_bf16 v[52:55], a[32:35], a[12:15], v[52:55]
    buffer_load_dwordx4 a[136:139], v187, s[20:23], s71 offen offset:0 sc1
    v_cvt_pk_bf16_f32 v28, v160, v161
    v_mfma_f32_16x16x32_bf16 v[56:59], a[40:43], a[0:3], v[56:59]
    ds_read_b128 a[72:75], v14 offset:45056
    v_cvt_pk_bf16_f32 v29, v162, v163
    v_cvt_pk_bf16_f32 v30, v152, v153
    v_mfma_f32_16x16x32_bf16 v[60:63], a[40:43], a[4:7], v[60:63]
    v_cvt_pk_bf16_f32 v31, v154, v155
    v_cvt_pk_bf16_f32 v32, v156, v157
    v_mfma_f32_16x16x32_bf16 v[64:67], a[40:43], a[8:11], v[64:67]
    buffer_load_dwordx4 a[132:135], v186, s[20:23], s71 offen offset:1024 sc1
    ds_read_b128 a[76:79], v14 offset:47104
    v_cvt_pk_bf16_f32 v33, v158, v159
    v_mov_b32 v240, 0x3f803f80
    v_mfma_f32_16x16x32_bf16 v[68:71], a[40:43], a[12:15], v[68:71]
    v_mov_b32 v241, 0x3f803f80
    s_waitcnt lgkmcnt(4)
    v_mfma_f32_16x16x32_bf16 v[40:43], a[36:39], a[16:19], v[40:43]
    ds_read_b128 a[80:83], v15 offset:40960
    v_mov_b32 v242, 0x3f803f80
    v_mov_b32 v243, 0x3f803f80
    v_mfma_f32_16x16x32_bf16 v[44:47], a[36:39], a[20:23], v[44:47]
    buffer_load_dwordx4 a[140:143], v187, s[20:23], s71 offen offset:1024 sc1
    ds_read_b128 a[84:87], v15 offset:43008
    v_max3_f32 v164, v208, v209, v210
    v_max3_f32 v165, v211, v212, v213
    v_mfma_f32_16x16x32_bf16 v[48:51], a[36:39], a[24:27], v[48:51]
    v_max3_f32 v166, v216, v217, v218
    v_max3_f32 v167, v219, v220, v221
    v_mfma_f32_16x16x32_bf16 v[52:55], a[36:39], a[28:31], v[52:55]
    ds_read_b128 a[88:91], v15 offset:45056
    v_max3_f32 v168, v224, v225, v226
    v_mfma_f32_16x16x32_bf16 v[56:59], a[44:47], a[16:19], v[56:59]
    s_add_u32 m0, s62, 8192
    s_add_u32 s51, s75, 1
    s_and_b32 s51, s51, 7
    s_lshl_b32 s51, s51, 7
    s_add_u32 s51, s51, 2048
    buffer_load_dwordx4 v23, s[24:27], s51 offen offset:0 lds
    v_max3_f32 v169, v227, v228, v229
    v_max3_f32 v170, v232, v233, v234
    v_mfma_f32_16x16x32_bf16 v[60:63], a[44:47], a[20:23], v[60:63]
    ds_read_b128 a[92:95], v15 offset:47104
    v_max3_f32 v171, v235, v236, v237
    v_max3_f32 v164, v164, v214, v215
    v_mfma_f32_16x16x32_bf16 v[64:67], a[44:47], a[24:27], v[64:67]
    v_max3_f32 v166, v166, v222, v223
    v_max3_f32 v168, v168, v230, v231
    v_mfma_f32_16x16x32_bf16 v[68:71], a[44:47], a[28:31], v[68:71]
    v_max3_f32 v170, v170, v238, v239
    s_waitcnt lgkmcnt(4)
    s_waitcnt vmcnt(15)
    v_mfma_f32_16x16x32_bf16 v[40:43], a[48:51], a[64:67], v[40:43]
    s_add_u32 s71, s75, 1
    s_and_b32 s71, s71, 7
    s_lshl_b32 s71, s71, 11
    s_add_u32 s71, s71, 16384
    buffer_load_dwordx4 a[144:147], v186, s[20:23], s71 offen offset:0 sc1
    v_max_f32 v165, v164, v165
    v_max_f32 v167, v166, v167
    v_mfma_f32_16x16x32_bf16 v[44:47], a[48:51], a[68:71], v[44:47]
    ds_read_b128 a[0:3], v14 offset:49152
    v_max_f32 v169, v168, v169
    v_max_f32 v171, v170, v171
    v_mfma_f32_16x16x32_bf16 v[48:51], a[48:51], a[72:75], v[48:51]
    buffer_load_dwordx4 a[152:155], v187, s[20:23], s71 offen offset:0 sc1
    ds_read_b128 a[4:7], v14 offset:51200
    v_mov_b32 v12, v165
    v_mov_b32 v13, v167
    v_mfma_f32_16x16x32_bf16 v[52:55], a[48:51], a[76:79], v[52:55]
    v_mov_b32 v22, v169
    v_mfma_f32_16x16x32_bf16 v[56:59], a[56:59], a[64:67], v[56:59]
    ds_read_b128 a[8:11], v14 offset:53248
    v_mov_b32 v27, v171
    v_permlane32_swap_b32 v165, v12
    v_mfma_f32_16x16x32_bf16 v[60:63], a[56:59], a[68:71], v[60:63]
    s_add_u32 m0, s62, 16384
    s_add_u32 s51, s75, 2
    s_and_b32 s51, s51, 7
    s_lshl_b32 s51, s51, 7
    s_add_u32 s51, s51, 2048
    buffer_load_dwordx4 v23, s[24:27], s51 offen offset:0 lds
    v_permlane32_swap_b32 v167, v13
    v_permlane32_swap_b32 v169, v22
    v_mfma_f32_16x16x32_bf16 v[64:67], a[56:59], a[72:75], v[64:67]
    ds_read_b128 a[12:15], v14 offset:55296
    v_permlane32_swap_b32 v171, v27
    v_max_f32 v165, v165, v12
    v_mfma_f32_16x16x32_bf16 v[68:71], a[56:59], a[76:79], v[68:71]
    v_max_f32 v167, v167, v13
    s_waitcnt lgkmcnt(4)
    v_mfma_f32_16x16x32_bf16 v[40:43], a[52:55], a[80:83], v[40:43]
    buffer_load_dwordx4 a[148:151], v186, s[20:23], s71 offen offset:1024 sc1
    ds_read_b128 a[16:19], v15 offset:49152
    v_max_f32 v169, v169, v22
    v_max_f32 v171, v171, v27
    v_mfma_f32_16x16x32_bf16 v[44:47], a[52:55], a[84:87], v[44:47]
    ds_read_b128 a[20:23], v15 offset:51200
    v_mov_b32 v12, v165
    v_mov_b32 v13, v167
    v_mfma_f32_16x16x32_bf16 v[48:51], a[52:55], a[88:91], v[48:51]
    buffer_load_dwordx4 a[156:159], v187, s[20:23], s71 offen offset:1024 sc1
    v_mov_b32 v22, v169
    v_mov_b32 v27, v171
    v_mfma_f32_16x16x32_bf16 v[52:55], a[52:55], a[92:95], v[52:55]
    ds_read_b128 a[24:27], v15 offset:53248
    v_permlane16_swap_b32 v165, v12
    v_mfma_f32_16x16x32_bf16 v[56:59], a[60:63], a[80:83], v[56:59]
    v_permlane16_swap_b32 v167, v13
    v_permlane16_swap_b32 v169, v22
    v_mfma_f32_16x16x32_bf16 v[60:63], a[60:63], a[84:87], v[60:63]
    s_add_u32 m0, s62, 8192
    s_add_u32 s51, s75, 1
    s_and_b32 s51, s51, 7
    s_lshl_b32 s51, s51, 7
    s_add_u32 s51, s51, 2048
    buffer_load_dwordx4 v24, s[24:27], s51 offen offset:1024 lds
    ds_read_b128 a[28:31], v15 offset:55296
    v_permlane16_swap_b32 v171, v27
    v_max_f32 v165, v165, v12
    v_mfma_f32_16x16x32_bf16 v[64:67], a[60:63], a[88:91], v[64:67]
    v_max_f32 v167, v167, v13
    v_max_f32 v169, v169, v22
    v_mfma_f32_16x16x32_bf16 v[68:71], a[60:63], a[92:95], v[68:71]
    v_max_f32 v171, v171, v27
    s_waitcnt lgkmcnt(4)
    s_waitcnt vmcnt(17)
    v_mfma_f32_16x16x32_bf16 v[40:43], a[96:99], a[0:3], v[40:43]
    s_add_u32 s71, s75, 2
    s_and_b32 s71, s71, 7
    s_lshl_b32 s71, s71, 11
    s_add_u32 s71, s71, 16384
    buffer_load_dwordx4 a[160:163], v186, s[20:23], s71 offen offset:0 sc1
    v_mov_b32 v164, 0x3eb8aa3b
    v_mul_f32 v165, 0xbeb8aa3b, v165
    v_mfma_f32_16x16x32_bf16 v[44:47], a[96:99], a[4:7], v[44:47]
    ds_read_b128 a[64:67], v14 offset:57344
    v_mov_b32 v166, 0x3eb8aa3b
    v_mul_f32 v167, 0xbeb8aa3b, v167
    v_mfma_f32_16x16x32_bf16 v[48:51], a[96:99], a[8:11], v[48:51]
    ds_read_b128 a[68:71], v14 offset:59392
    v_mov_b32 v168, 0x3eb8aa3b
    v_mul_f32 v169, 0xbeb8aa3b, v169
    v_mfma_f32_16x16x32_bf16 v[52:55], a[96:99], a[12:15], v[52:55]
    buffer_load_dwordx4 a[168:171], v187, s[20:23], s71 offen offset:0 sc1
    ds_read_b128 a[72:75], v14 offset:61440
    v_mov_b32 v170, 0x3eb8aa3b
    v_mfma_f32_16x16x32_bf16 v[56:59], a[104:107], a[0:3], v[56:59]
    v_mul_f32 v171, 0xbeb8aa3b, v171
    v_fma_f32 v208, v208, v164, v165
    v_mfma_f32_16x16x32_bf16 v[60:63], a[104:107], a[4:7], v[60:63]
    ds_read_b128 a[76:79], v14 offset:63488
    v_fma_f32 v209, v209, v164, v165
    v_fma_f32 v210, v210, v164, v165
    v_mfma_f32_16x16x32_bf16 v[64:67], a[104:107], a[8:11], v[64:67]
    buffer_load_dwordx4 a[164:167], v186, s[20:23], s71 offen offset:1024 sc1
    ds_read_b128 a[80:83], v15 offset:57344
    v_fma_f32 v211, v211, v164, v165
    v_fma_f32 v212, v212, v164, v165
    v_mfma_f32_16x16x32_bf16 v[68:71], a[104:107], a[12:15], v[68:71]
    ds_read_b128 a[84:87], v15 offset:59392
    v_fma_f32 v213, v213, v164, v165
    s_waitcnt lgkmcnt(6)
    v_mfma_f32_16x16x32_bf16 v[40:43], a[100:103], a[16:19], v[40:43]
    v_fma_f32 v214, v214, v164, v165
    v_fma_f32 v215, v215, v164, v165
    v_mfma_f32_16x16x32_bf16 v[44:47], a[100:103], a[20:23], v[44:47]
    buffer_load_dwordx4 a[172:175], v187, s[20:23], s71 offen offset:1024 sc1
    ds_read_b128 a[88:91], v15 offset:61440
    v_fma_f32 v216, v216, v166, v167
    v_fma_f32 v217, v217, v166, v167
    v_mfma_f32_16x16x32_bf16 v[48:51], a[100:103], a[24:27], v[48:51]
    ds_read_b128 a[92:95], v15 offset:63488
    v_fma_f32 v218, v218, v166, v167
    v_fma_f32 v219, v219, v166, v167
    v_mfma_f32_16x16x32_bf16 v[52:55], a[100:103], a[28:31], v[52:55]
    v_fma_f32 v220, v220, v166, v167
    v_mfma_f32_16x16x32_bf16 v[56:59], a[108:111], a[16:19], v[56:59]
    s_add_u32 m0, s62, 16384
    s_add_u32 s51, s75, 2
    s_and_b32 s51, s51, 7
    s_lshl_b32 s51, s51, 7
    s_add_u32 s51, s51, 2048
    buffer_load_dwordx4 v24, s[24:27], s51 offen offset:1024 lds
    v_fma_f32 v221, v221, v166, v167
    v_fma_f32 v222, v222, v166, v167
    v_mfma_f32_16x16x32_bf16 v[60:63], a[108:111], a[20:23], v[60:63]
    v_fma_f32 v223, v223, v166, v167
    v_fma_f32 v224, v224, v168, v169
    v_mfma_f32_16x16x32_bf16 v[64:67], a[108:111], a[24:27], v[64:67]
    v_fma_f32 v225, v225, v168, v169
    v_fma_f32 v226, v226, v168, v169
    v_mfma_f32_16x16x32_bf16 v[68:71], a[108:111], a[28:31], v[68:71]
    v_fma_f32 v227, v227, v168, v169
    s_waitcnt lgkmcnt(0)
    s_barrier
    s_waitcnt vmcnt(17)
    v_mfma_f32_16x16x32_bf16 v[40:43], a[112:115], a[64:67], v[40:43]
    s_add_u32 s71, s75, 3
    s_and_b32 s71, s71, 7
    s_lshl_b32 s71, s71, 11
    s_add_u32 s71, s71, 16384
    buffer_load_dwordx4 a[176:179], v186, s[20:23], s71 offen offset:0 sc1
    v_fma_f32 v228, v228, v168, v169
    v_fma_f32 v229, v229, v168, v169
    v_mfma_f32_16x16x32_bf16 v[44:47], a[112:115], a[68:71], v[44:47]
    ds_read_b128 a[0:3], v25 offset:0
    v_fma_f32 v230, v230, v168, v169
    v_fma_f32 v231, v231, v168, v169
    v_mfma_f32_16x16x32_bf16 v[48:51], a[112:115], a[72:75], v[48:51]
    buffer_load_dwordx4 a[184:187], v187, s[20:23], s71 offen offset:0 sc1
    ds_read_b128 a[4:7], v25 offset:2048
    v_fma_f32 v232, v232, v170, v171
    v_fma_f32 v233, v233, v170, v171
    v_mfma_f32_16x16x32_bf16 v[52:55], a[112:115], a[76:79], v[52:55]
    v_fma_f32 v234, v234, v170, v171
    v_mfma_f32_16x16x32_bf16 v[56:59], a[120:123], a[64:67], v[56:59]
    ds_read_b128 a[8:11], v25 offset:4096
    v_fma_f32 v235, v235, v170, v171
    v_fma_f32 v236, v236, v170, v171
    v_mfma_f32_16x16x32_bf16 v[60:63], a[120:123], a[68:71], v[60:63]
    s_add_u32 m0, s62, 24576
    s_add_u32 s51, s75, 3
    s_and_b32 s51, s51, 7
    s_lshl_b32 s51, s51, 7
    s_add_u32 s51, s51, 2048
    buffer_load_dwordx4 v24, s[24:27], s51 offen offset:1024 lds
    v_fma_f32 v237, v237, v170, v171
    v_fma_f32 v238, v238, v170, v171
    v_mfma_f32_16x16x32_bf16 v[64:67], a[120:123], a[72:75], v[64:67]
    ds_read_b128 a[12:15], v25 offset:6144
    v_fma_f32 v239, v239, v170, v171
    v_exp_f32 v208, v208
    v_mfma_f32_16x16x32_bf16 v[68:71], a[120:123], a[76:79], v[68:71]
    v_mfma_f32_16x16x32_bf16 v[40:43], a[116:119], a[80:83], v[40:43]
    buffer_load_dwordx4 a[180:183], v186, s[20:23], s71 offen offset:1024 sc1
    ds_read_b128 a[16:19], v26 offset:0
    v_exp_f32 v209, v209
    v_mfma_f32_16x16x32_bf16 v[44:47], a[116:119], a[84:87], v[44:47]
    ds_read_b128 a[20:23], v26 offset:2048
    v_exp_f32 v210, v210
    v_mfma_f32_16x16x32_bf16 v[48:51], a[116:119], a[88:91], v[48:51]
    buffer_load_dwordx4 a[188:191], v187, s[20:23], s71 offen offset:1024 sc1
    v_exp_f32 v211, v211
    v_mfma_f32_16x16x32_bf16 v[52:55], a[116:119], a[92:95], v[52:55]
    ds_read_b128 a[24:27], v26 offset:4096
    v_exp_f32 v212, v212
    v_mfma_f32_16x16x32_bf16 v[56:59], a[124:127], a[80:83], v[56:59]
    v_exp_f32 v213, v213
    v_mfma_f32_16x16x32_bf16 v[60:63], a[124:127], a[84:87], v[60:63]
    s_add_u32 m0, s62, 24576
    s_add_u32 s51, s75, 3
    s_and_b32 s51, s51, 7
    s_lshl_b32 s51, s51, 7
    s_add_u32 s51, s51, 2048
    buffer_load_dwordx4 v23, s[24:27], s51 offen offset:0 lds
    ds_read_b128 a[28:31], v26 offset:6144
    v_exp_f32 v214, v214
    v_mfma_f32_16x16x32_bf16 v[64:67], a[124:127], a[88:91], v[64:67]
    v_exp_f32 v215, v215
    v_mfma_f32_16x16x32_bf16 v[68:71], a[124:127], a[92:95], v[68:71]
    s_waitcnt lgkmcnt(4)
    s_waitcnt vmcnt(18)
    v_mfma_f32_16x16x32_bf16 v[40:43], a[128:131], a[0:3], v[40:43]
    s_add_u32 s71, s75, 4
    s_and_b32 s71, s71, 7
    s_lshl_b32 s71, s71, 11
    s_add_u32 s71, s71, 16384
    buffer_load_dwordx4 a[32:35], v186, s[20:23], s71 offen offset:0 sc1
    v_exp_f32 v216, v216
    v_mfma_f32_16x16x32_bf16 v[44:47], a[128:131], a[4:7], v[44:47]
    ds_read_b128 a[64:67], v25 offset:8192
    v_exp_f32 v217, v217
    v_mfma_f32_16x16x32_bf16 v[48:51], a[128:131], a[8:11], v[48:51]
    ds_read_b128 a[68:71], v25 offset:10240
    v_exp_f32 v218, v218
    v_mfma_f32_16x16x32_bf16 v[52:55], a[128:131], a[12:15], v[52:55]
    buffer_load_dwordx4 a[40:43], v187, s[20:23], s71 offen offset:0 sc1
    v_exp_f32 v219, v219
    v_mfma_f32_16x16x32_bf16 v[56:59], a[136:139], a[0:3], v[56:59]
    ds_read_b128 a[72:75], v25 offset:12288
    v_exp_f32 v220, v220
    v_mfma_f32_16x16x32_bf16 v[60:63], a[136:139], a[4:7], v[60:63]
    v_exp_f32 v221, v221
    v_mfma_f32_16x16x32_bf16 v[64:67], a[136:139], a[8:11], v[64:67]
    buffer_load_dwordx4 a[36:39], v186, s[20:23], s71 offen offset:1024 sc1
    ds_read_b128 a[76:79], v25 offset:14336
    v_exp_f32 v222, v222
    v_mfma_f32_16x16x32_bf16 v[68:71], a[136:139], a[12:15], v[68:71]
    s_waitcnt lgkmcnt(4)
    v_mfma_f32_16x16x32_bf16 v[40:43], a[132:135], a[16:19], v[40:43]
    ds_read_b128 a[80:83], v26 offset:8192
    v_exp_f32 v223, v223
    v_mfma_f32_16x16x32_bf16 v[44:47], a[132:135], a[20:23], v[44:47]
    buffer_load_dwordx4 a[44:47], v187, s[20:23], s71 offen offset:1024 sc1
    ds_read_b128 a[84:87], v26 offset:10240
    v_exp_f32 v224, v224
    v_mfma_f32_16x16x32_bf16 v[48:51], a[132:135], a[24:27], v[48:51]
    v_exp_f32 v225, v225
    v_mfma_f32_16x16x32_bf16 v[52:55], a[132:135], a[28:31], v[52:55]
    ds_read_b128 a[88:91], v26 offset:12288
    v_exp_f32 v226, v226
    v_mfma_f32_16x16x32_bf16 v[56:59], a[140:143], a[16:19], v[56:59]
    s_add_u32 m0, s62, 32768
    s_add_u32 s51, s75, 4
    s_and_b32 s51, s51, 7
    s_lshl_b32 s51, s51, 7
    s_add_u32 s51, s51, 2048
    buffer_load_dwordx4 v23, s[24:27], s51 offen offset:0 lds
    v_exp_f32 v227, v227
    v_mfma_f32_16x16x32_bf16 v[60:63], a[140:143], a[20:23], v[60:63]
    ds_read_b128 a[92:95], v26 offset:14336
    v_exp_f32 v228, v228
    v_mfma_f32_16x16x32_bf16 v[64:67], a[140:143], a[24:27], v[64:67]
    v_exp_f32 v229, v229
    v_mfma_f32_16x16x32_bf16 v[68:71], a[140:143], a[28:31], v[68:71]
    s_waitcnt lgkmcnt(4)
    s_waitcnt vmcnt(17)
    v_mfma_f32_16x16x32_bf16 v[40:43], a[144:147], a[64:67], v[40:43]
    s_add_u32 s71, s75, 5
    s_and_b32 s71, s71, 7
    s_lshl_b32 s71, s71, 11
    s_add_u32 s71, s71, 16384
    buffer_load_dwordx4 a[48:51], v186, s[20:23], s71 offen offset:0 sc1
    v_exp_f32 v230, v230
    v_mfma_f32_16x16x32_bf16 v[44:47], a[144:147], a[68:71], v[44:47]
    ds_read_b128 a[0:3], v25 offset:16384
    v_exp_f32 v231, v231
    v_mfma_f32_16x16x32_bf16 v[48:51], a[144:147], a[72:75], v[48:51]
    buffer_load_dwordx4 a[56:59], v187, s[20:23], s71 offen offset:0 sc1
    ds_read_b128 a[4:7], v25 offset:18432
    v_exp_f32 v232, v232
    v_mfma_f32_16x16x32_bf16 v[52:55], a[144:147], a[76:79], v[52:55]
    v_exp_f32 v233, v233
    v_mfma_f32_16x16x32_bf16 v[56:59], a[152:155], a[64:67], v[56:59]
    ds_read_b128 a[8:11], v25 offset:20480
    v_exp_f32 v234, v234
    v_mfma_f32_16x16x32_bf16 v[60:63], a[152:155], a[68:71], v[60:63]
    s_add_u32 m0, s62, 40960
    s_add_u32 s51, s75, 5
    s_and_b32 s51, s51, 7
    s_lshl_b32 s51, s51, 7
    s_add_u32 s51, s51, 2048
    buffer_load_dwordx4 v23, s[24:27], s51 offen offset:0 lds
    v_exp_f32 v235, v235
    v_mfma_f32_16x16x32_bf16 v[64:67], a[152:155], a[72:75], v[64:67]
    ds_read_b128 a[12:15], v25 offset:22528
    v_exp_f32 v236, v236
    v_mfma_f32_16x16x32_bf16 v[68:71], a[152:155], a[76:79], v[68:71]
    s_waitcnt lgkmcnt(4)
    v_mfma_f32_16x16x32_bf16 v[40:43], a[148:151], a[80:83], v[40:43]
    buffer_load_dwordx4 a[52:55], v186, s[20:23], s71 offen offset:1024 sc1
    ds_read_b128 a[16:19], v26 offset:16384
    v_exp_f32 v237, v237
    v_mfma_f32_16x16x32_bf16 v[44:47], a[148:151], a[84:87], v[44:47]
    ds_read_b128 a[20:23], v26 offset:18432
    v_exp_f32 v238, v238
    v_mfma_f32_16x16x32_bf16 v[48:51], a[148:151], a[88:91], v[48:51]
    buffer_load_dwordx4 a[60:63], v187, s[20:23], s71 offen offset:1024 sc1
    v_exp_f32 v239, v239
    v_mfma_f32_16x16x32_bf16 v[52:55], a[148:151], a[92:95], v[52:55]
    ds_read_b128 a[24:27], v26 offset:20480
    v_cvt_pk_bf16_f32 v208, v208, v209
    v_mfma_f32_16x16x32_bf16 v[56:59], a[156:159], a[80:83], v[56:59]
    v_cvt_pk_bf16_f32 v209, v210, v211
    v_cvt_pk_bf16_f32 v210, v212, v213
    v_mfma_f32_16x16x32_bf16 v[60:63], a[156:159], a[84:87], v[60:63]
    s_add_u32 m0, s62, 32768
    s_add_u32 s51, s75, 4
    s_and_b32 s51, s51, 7
    s_lshl_b32 s51, s51, 7
    s_add_u32 s51, s51, 2048
    buffer_load_dwordx4 v24, s[24:27], s51 offen offset:1024 lds
    ds_read_b128 a[28:31], v26 offset:22528
    v_cvt_pk_bf16_f32 v211, v214, v215
    v_cvt_pk_bf16_f32 v216, v216, v217
    v_mfma_f32_16x16x32_bf16 v[64:67], a[156:159], a[88:91], v[64:67]
    v_cvt_pk_bf16_f32 v217, v218, v219
    v_cvt_pk_bf16_f32 v218, v220, v221
    v_mfma_f32_16x16x32_bf16 v[68:71], a[156:159], a[92:95], v[68:71]
    v_cvt_pk_bf16_f32 v219, v222, v223
    s_waitcnt lgkmcnt(4)
    s_waitcnt vmcnt(18)
    v_mfma_f32_16x16x32_bf16 v[40:43], a[160:163], a[0:3], v[40:43]
    s_add_u32 s71, s75, 6
    s_and_b32 s71, s71, 7
    s_lshl_b32 s71, s71, 11
    s_add_u32 s71, s71, 16384
    buffer_load_dwordx4 a[96:99], v186, s[20:23], s71 offen offset:0 sc1
    v_cvt_pk_bf16_f32 v224, v224, v225
    v_cvt_pk_bf16_f32 v225, v226, v227
    v_mfma_f32_16x16x32_bf16 v[44:47], a[160:163], a[4:7], v[44:47]
    ds_read_b128 a[64:67], v25 offset:24576
    v_cvt_pk_bf16_f32 v226, v228, v229
    v_cvt_pk_bf16_f32 v227, v230, v231
    v_mfma_f32_16x16x32_bf16 v[48:51], a[160:163], a[8:11], v[48:51]
    ds_read_b128 a[68:71], v25 offset:26624
    v_cvt_pk_bf16_f32 v232, v232, v233
    v_cvt_pk_bf16_f32 v233, v234, v235
    v_mfma_f32_16x16x32_bf16 v[52:55], a[160:163], a[12:15], v[52:55]
    buffer_load_dwordx4 a[104:107], v187, s[20:23], s71 offen offset:0 sc1
    ds_read_b128 a[72:75], v25 offset:28672
    v_cvt_pk_bf16_f32 v234, v236, v237
    v_mfma_f32_16x16x32_bf16 v[56:59], a[168:171], a[0:3], v[56:59]
    v_cvt_pk_bf16_f32 v235, v238, v239
    v_mfma_f32_16x16x32_bf16 v[108:111], v[16:19], v[208:211], 0
    v_mfma_f32_16x16x32_bf16 v[60:63], a[168:171], a[4:7], v[60:63]
    ds_read_b128 a[76:79], v25 offset:30720
    v_mfma_f32_16x16x32_bf16 v[64:67], a[168:171], a[8:11], v[64:67]
    buffer_load_dwordx4 a[100:103], v186, s[20:23], s71 offen offset:1024 sc1
    ds_read_b128 a[80:83], v26 offset:24576
    v_mfma_f32_16x16x32_bf16 v[124:127], v[240:243], v[208:211], 0
    v_mfma_f32_16x16x32_bf16 v[68:71], a[168:171], a[12:15], v[68:71]
    ds_read_b128 a[84:87], v26 offset:26624
    s_waitcnt lgkmcnt(6)
    v_mfma_f32_16x16x32_bf16 v[40:43], a[164:167], a[16:19], v[40:43]
    v_mfma_f32_16x16x32_bf16 v[44:47], a[164:167], a[20:23], v[44:47]
    buffer_load_dwordx4 a[108:111], v187, s[20:23], s71 offen offset:1024 sc1
    ds_read_b128 a[88:91], v26 offset:28672
    v_mfma_f32_16x16x32_bf16 v[112:115], v[18:21], v[216:219], 0
    v_mfma_f32_16x16x32_bf16 v[48:51], a[164:167], a[24:27], v[48:51]
    ds_read_b128 a[92:95], v26 offset:30720
    v_mfma_f32_16x16x32_bf16 v[52:55], a[164:167], a[28:31], v[52:55]
    v_mfma_f32_16x16x32_bf16 v[128:131], v[240:243], v[216:219], 0
    v_mfma_f32_16x16x32_bf16 v[56:59], a[172:175], a[16:19], v[56:59]
    s_add_u32 m0, s62, 40960
    s_add_u32 s51, s75, 5
    s_and_b32 s51, s51, 7
    s_lshl_b32 s51, s51, 7
    s_add_u32 s51, s51, 2048
    buffer_load_dwordx4 v24, s[24:27], s51 offen offset:1024 lds
    v_mfma_f32_16x16x32_bf16 v[60:63], a[172:175], a[20:23], v[60:63]
    v_mfma_f32_16x16x32_bf16 v[116:119], v[28:31], v[224:227], 0
    v_mfma_f32_16x16x32_bf16 v[64:67], a[172:175], a[24:27], v[64:67]
    v_mfma_f32_16x16x32_bf16 v[68:71], a[172:175], a[28:31], v[68:71]
    s_waitcnt lgkmcnt(0)
    s_barrier
    s_waitcnt vmcnt(17)
    v_mfma_f32_16x16x32_bf16 v[40:43], a[176:179], a[64:67], v[40:43]
    s_add_u32 s71, s75, 7
    s_and_b32 s71, s71, 7
    s_lshl_b32 s71, s71, 11
    s_add_u32 s71, s71, 16384
    buffer_load_dwordx4 a[112:115], v186, s[20:23], s71 offen offset:0 sc1
    v_mfma_f32_16x16x32_bf16 v[132:135], v[240:243], v[224:227], 0
    v_mfma_f32_16x16x32_bf16 v[44:47], a[176:179], a[68:71], v[44:47]
    ds_read_b128 a[0:3], v25 offset:32768
    v_mfma_f32_16x16x32_bf16 v[48:51], a[176:179], a[72:75], v[48:51]
    buffer_load_dwordx4 a[120:123], v187, s[20:23], s71 offen offset:0 sc1
    ds_read_b128 a[4:7], v25 offset:34816
    v_mfma_f32_16x16x32_bf16 v[120:123], v[30:33], v[232:235], 0
    v_mfma_f32_16x16x32_bf16 v[52:55], a[176:179], a[76:79], v[52:55]
    v_mfma_f32_16x16x32_bf16 v[56:59], a[184:187], a[64:67], v[56:59]
    ds_read_b128 a[8:11], v25 offset:36864
    v_mfma_f32_16x16x32_bf16 v[136:139], v[240:243], v[232:235], 0
    v_mfma_f32_16x16x32_bf16 v[60:63], a[184:187], a[68:71], v[60:63]
    s_add_u32 m0, s62, 49152
    s_add_u32 s51, s75, 6
    s_and_b32 s51, s51, 7
    s_lshl_b32 s51, s51, 7
    s_add_u32 s51, s51, 2048
    buffer_load_dwordx4 v24, s[24:27], s51 offen offset:1024 lds
    v_mfma_f32_16x16x32_bf16 v[64:67], a[184:187], a[72:75], v[64:67]
    ds_read_b128 a[12:15], v25 offset:38912
    s_lshr_b32 s48, s3, 1
    s_lshl_b32 s48, s48, 10
    s_and_b32 s50, s3, 1
    s_lshl_b32 s50, s50, 3
    s_add_u32 s48, s48, s50
    s_add_u32 s48, s48, 151552
    v_add_u32 v205, s48, v34
    s_add_u32 s48, s62, 151552
    v_add_u32 v206, s48, v34
    v_mfma_f32_16x16x32_bf16 v[68:71], a[184:187], a[76:79], v[68:71]
    v_mfma_f32_16x16x32_bf16 v[40:43], a[180:183], a[80:83], v[40:43]
    buffer_load_dwordx4 a[116:119], v186, s[20:23], s71 offen offset:1024 sc1
    ds_read_b128 a[16:19], v26 offset:32768
    v_mfma_f32_16x16x32_bf16 v[44:47], a[180:183], a[84:87], v[44:47]
    ds_read_b128 a[20:23], v26 offset:34816
    v_mfma_f32_16x16x32_bf16 v[48:51], a[180:183], a[88:91], v[48:51]
    buffer_load_dwordx4 a[124:127], v187, s[20:23], s71 offen offset:1024 sc1
    v_mfma_f32_16x16x32_bf16 v[52:55], a[180:183], a[92:95], v[52:55]
    ds_read_b128 a[24:27], v26 offset:36864
    v_rcp_f32 v124, v124
    v_mfma_f32_16x16x32_bf16 v[56:59], a[188:191], a[80:83], v[56:59]
    v_rcp_f32 v128, v128
    v_mfma_f32_16x16x32_bf16 v[60:63], a[188:191], a[84:87], v[60:63]
    s_add_u32 m0, s62, 49152
    s_add_u32 s51, s75, 6
    s_and_b32 s51, s51, 7
    s_lshl_b32 s51, s51, 7
    s_add_u32 s51, s51, 2048
    buffer_load_dwordx4 v23, s[24:27], s51 offen offset:0 lds
    ds_read_b128 a[28:31], v26 offset:38912
    v_rcp_f32 v132, v132
    v_mfma_f32_16x16x32_bf16 v[64:67], a[188:191], a[88:91], v[64:67]
    v_rcp_f32 v136, v136
    v_mfma_f32_16x16x32_bf16 v[68:71], a[188:191], a[92:95], v[68:71]
    s_waitcnt lgkmcnt(4)
    s_waitcnt vmcnt(18)
    v_mfma_f32_16x16x32_bf16 v[40:43], a[32:35], a[0:3], v[40:43]
    s_add_u32 s71, s75, 0
    s_and_b32 s71, s71, 7
    s_lshl_b32 s71, s71, 11
    s_add_u32 s71, s71, 32768
    buffer_load_dwordx4 a[128:131], v186, s[20:23], s71 offen offset:0 sc1
    v_mul_f32 v108, v108, v124
    v_mul_f32 v109, v109, v124
    v_mfma_f32_16x16x32_bf16 v[44:47], a[32:35], a[4:7], v[44:47]
    ds_read_b128 a[64:67], v25 offset:40960
    v_mul_f32 v110, v110, v124
    v_mul_f32 v111, v111, v124
    v_mfma_f32_16x16x32_bf16 v[48:51], a[32:35], a[8:11], v[48:51]
    ds_read_b128 a[68:71], v25 offset:43008
    v_mul_f32 v112, v112, v128
    v_mul_f32 v113, v113, v128
    v_mfma_f32_16x16x32_bf16 v[52:55], a[32:35], a[12:15], v[52:55]
    buffer_load_dwordx4 a[136:139], v187, s[20:23], s71 offen offset:0 sc1
    v_mul_f32 v114, v114, v128
    v_mul_f32 v115, v115, v128
    v_mfma_f32_16x16x32_bf16 v[56:59], a[40:43], a[0:3], v[56:59]
    ds_read_b128 a[72:75], v25 offset:45056
    v_mul_f32 v116, v116, v132
    v_mul_f32 v117, v117, v132
    v_mfma_f32_16x16x32_bf16 v[60:63], a[40:43], a[4:7], v[60:63]
    v_mul_f32 v118, v118, v132
    v_mfma_f32_16x16x32_bf16 v[64:67], a[40:43], a[8:11], v[64:67]
    buffer_load_dwordx4 a[132:135], v186, s[20:23], s71 offen offset:1024 sc1
    ds_read_b128 a[76:79], v25 offset:47104
    v_mul_f32 v119, v119, v132
    v_mul_f32 v120, v120, v136
    v_mfma_f32_16x16x32_bf16 v[68:71], a[40:43], a[12:15], v[68:71]
    v_mul_f32 v121, v121, v136
    v_mul_f32 v122, v122, v136
    s_waitcnt lgkmcnt(4)
    v_mfma_f32_16x16x32_bf16 v[40:43], a[36:39], a[16:19], v[40:43]
    ds_read_b128 a[80:83], v26 offset:40960
    v_mul_f32 v123, v123, v136
    v_cvt_pk_bf16_f32 v108, v108, v109
    v_mfma_f32_16x16x32_bf16 v[44:47], a[36:39], a[20:23], v[44:47]
    buffer_load_dwordx4 a[140:143], v187, s[20:23], s71 offen offset:1024 sc1
    ds_read_b128 a[84:87], v26 offset:43008
    v_cvt_pk_bf16_f32 v109, v110, v111
    v_cvt_pk_bf16_f32 v112, v112, v113
    v_mfma_f32_16x16x32_bf16 v[48:51], a[36:39], a[24:27], v[48:51]
    v_cvt_pk_bf16_f32 v113, v114, v115
    v_mfma_f32_16x16x32_bf16 v[52:55], a[36:39], a[28:31], v[52:55]
    ds_read_b128 a[88:91], v26 offset:45056
    v_cvt_pk_bf16_f32 v116, v116, v117
    v_cvt_pk_bf16_f32 v117, v118, v119
    v_mfma_f32_16x16x32_bf16 v[56:59], a[44:47], a[16:19], v[56:59]
    s_add_u32 m0, s62, 57344
    s_add_u32 s51, s75, 7
    s_and_b32 s51, s51, 7
    s_lshl_b32 s51, s51, 7
    s_add_u32 s51, s51, 2048
    buffer_load_dwordx4 v23, s[24:27], s51 offen offset:0 lds
    v_cvt_pk_bf16_f32 v120, v120, v121
    v_cvt_pk_bf16_f32 v121, v122, v123
    v_mfma_f32_16x16x32_bf16 v[60:63], a[44:47], a[20:23], v[60:63]
    ds_read_b128 a[92:95], v26 offset:47104
    ds_write_b64 v205, v[108:109] offset:0
    v_mfma_f32_16x16x32_bf16 v[64:67], a[44:47], a[24:27], v[64:67]
    ds_write_b64 v205, v[112:113] offset:2048
    v_mfma_f32_16x16x32_bf16 v[68:71], a[44:47], a[28:31], v[68:71]
    s_waitcnt lgkmcnt(6)
    s_waitcnt vmcnt(17)
    v_mfma_f32_16x16x32_bf16 v[40:43], a[48:51], a[64:67], v[40:43]
    s_add_u32 s71, s75, 1
    s_and_b32 s71, s71, 7
    s_lshl_b32 s71, s71, 11
    s_add_u32 s71, s71, 32768
    buffer_load_dwordx4 a[144:147], v186, s[20:23], s71 offen offset:0 sc1
    ds_write_b64 v205, v[116:117] offset:4096
    v_mfma_f32_16x16x32_bf16 v[44:47], a[48:51], a[68:71], v[44:47]
    ds_read_b128 a[0:3], v25 offset:49152
    ds_write_b64 v205, v[120:121] offset:6144
    v_mfma_f32_16x16x32_bf16 v[48:51], a[48:51], a[72:75], v[48:51]
    buffer_load_dwordx4 a[152:155], v187, s[20:23], s71 offen offset:0 sc1
    ds_read_b128 a[4:7], v25 offset:51200
L_h5:
    s_cbranch_execz L_h9
    v_mul_f32 v176, 0xbfb8aa3b, v104
    v_mfma_f32_16x16x32_bf16 v[52:55], a[48:51], a[76:79], v[52:55]
    v_exp_f32 v176, v176
    v_mfma_f32_16x16x32_bf16 v[56:59], a[56:59], a[64:67], v[56:59]
    ds_read_b128 a[8:11], v25 offset:53248
    v_add_f32 v176, 1.0, v176
    v_mfma_f32_16x16x32_bf16 v[60:63], a[56:59], a[68:71], v[60:63]
    buffer_load_dwordx4 a[148:151], v186, s[20:23], s71 offen offset:1024 sc1
    v_rcp_f32 v176, v176
    v_mfma_f32_16x16x32_bf16 v[64:67], a[56:59], a[72:75], v[64:67]
    ds_read_b128 a[12:15], v25 offset:55296
    s_lshl_b32 s48, s3, 6
    s_add_u32 s48, s48, 162816
    v_lshl_add_u32 v207, v2, 2, s48
    v_mfma_f32_16x16x32_bf16 v[68:71], a[56:59], a[76:79], v[68:71]
    s_waitcnt lgkmcnt(8)
    v_mfma_f32_16x16x32_bf16 v[40:43], a[52:55], a[80:83], v[40:43]
    buffer_load_dwordx4 a[156:159], v187, s[20:23], s71 offen offset:1024 sc1
    ds_read_b128 a[16:19], v26 offset:49152
    ds_write_b32 v207, v176
    v_mfma_f32_16x16x32_bf16 v[44:47], a[52:55], a[84:87], v[44:47]
    ds_read_b128 a[20:23], v26 offset:51200
    v_xor_b32 v207, 64, v207
    v_mfma_f32_16x16x32_bf16 v[48:51], a[52:55], a[88:91], v[48:51]
    s_add_u32 m0, s62, 57344
    s_add_u32 s51, s75, 7
    s_and_b32 s51, s51, 7
    s_lshl_b32 s51, s51, 7
    s_add_u32 s51, s51, 2048
    buffer_load_dwordx4 v24, s[24:27], s51 offen offset:1024 lds
    v_and_b32 v182, 0xffff0000, v180
    v_mfma_f32_16x16x32_bf16 v[52:55], a[52:55], a[92:95], v[52:55]
    ds_read_b128 a[24:27], v26 offset:53248
    v_and_b32 v183, 0xffff0000, v181
    v_lshlrev_b32 v180, 16, v180
    v_mfma_f32_16x16x32_bf16 v[56:59], a[60:63], a[80:83], v[56:59]
    v_lshlrev_b32 v181, 16, v181
    v_mfma_f32_16x16x32_bf16 v[60:63], a[60:63], a[84:87], v[60:63]
    s_add_u32 m0, s65, 131072
    s_mov_b32 s52, 524288
    buffer_load_dwordx4 v36, s[32:35], s52 offen lds
    ds_read_b128 a[28:31], v26 offset:55296
    v_mul_f32 v216, v72, v72
    v_mul_f32 v217, v73, v73
    v_mfma_f32_16x16x32_bf16 v[64:67], a[60:63], a[88:91], v[64:67]
    v_mul_f32 v218, v74, v74
    v_mul_f32 v219, v75, v75
    v_mfma_f32_16x16x32_bf16 v[68:71], a[60:63], a[92:95], v[68:71]
    v_mul_f32 v220, v76, v76
    s_waitcnt lgkmcnt(5)
    s_waitcnt vmcnt(18)
    v_mfma_f32_16x16x32_bf16 v[40:43], a[96:99], a[0:3], v[40:43]
    s_add_u32 s71, s75, 2
    s_and_b32 s71, s71, 7
    s_lshl_b32 s71, s71, 11
    s_add_u32 s71, s71, 32768
    buffer_load_dwordx4 a[160:163], v186, s[20:23], s71 offen offset:0 sc1
    v_mul_f32 v221, v77, v77
    v_mul_f32 v222, v78, v78
    v_mfma_f32_16x16x32_bf16 v[44:47], a[96:99], a[4:7], v[44:47]
    ds_read_b128 a[64:67], v25 offset:57344
    v_mul_f32 v223, v79, v79
    v_fma_f32 v216, v216, v184, s69
    v_mfma_f32_16x16x32_bf16 v[48:51], a[96:99], a[8:11], v[48:51]
    ds_read_b128 a[68:71], v25 offset:59392
    v_fma_f32 v217, v217, v184, s69
    v_fma_f32 v218, v218, v184, s69
    v_mfma_f32_16x16x32_bf16 v[52:55], a[96:99], a[12:15], v[52:55]
    buffer_load_dwordx4 a[168:171], v187, s[20:23], s71 offen offset:0 sc1
    ds_read_b128 a[72:75], v25 offset:61440
    v_fma_f32 v219, v219, v184, s69
    v_fma_f32 v220, v220, v184, s69
    v_mfma_f32_16x16x32_bf16 v[56:59], a[104:107], a[0:3], v[56:59]
    v_fma_f32 v221, v221, v184, s69
    v_fma_f32 v222, v222, v184, s69
    v_mfma_f32_16x16x32_bf16 v[60:63], a[104:107], a[4:7], v[60:63]
    ds_read_b128 a[76:79], v25 offset:63488
    v_fma_f32 v223, v223, v184, s69
    v_mfma_f32_16x16x32_bf16 v[64:67], a[104:107], a[8:11], v[64:67]
    buffer_load_dwordx4 a[164:167], v186, s[20:23], s71 offen offset:1024 sc1
    ds_read_b128 a[80:83], v26 offset:57344
    v_mul_f32 v216, v216, v72
    v_mul_f32 v217, v217, v73
    v_mfma_f32_16x16x32_bf16 v[68:71], a[104:107], a[12:15], v[68:71]
    ds_read_b128 a[84:87], v26 offset:59392
    v_mul_f32 v218, v218, v74
    v_mul_f32 v219, v219, v75
    s_waitcnt lgkmcnt(6)
    v_mfma_f32_16x16x32_bf16 v[40:43], a[100:103], a[16:19], v[40:43]
    v_mul_f32 v220, v220, v76
    v_mul_f32 v221, v221, v77
    v_mfma_f32_16x16x32_bf16 v[44:47], a[100:103], a[20:23], v[44:47]
    buffer_load_dwordx4 a[172:175], v187, s[20:23], s71 offen offset:1024 sc1
    ds_read_b128 a[88:91], v26 offset:61440
    v_mul_f32 v222, v222, v78
    v_mul_f32 v223, v223, v79
    v_mfma_f32_16x16x32_bf16 v[48:51], a[100:103], a[24:27], v[48:51]
    ds_read_b128 a[92:95], v26 offset:63488
    v_exp_f32 v216, v216
    v_mfma_f32_16x16x32_bf16 v[52:55], a[100:103], a[28:31], v[52:55]
    v_exp_f32 v217, v217
    v_mfma_f32_16x16x32_bf16 v[56:59], a[108:111], a[16:19], v[56:59]
    s_add_u32 m0, s65, 135168
    s_mov_b32 s52, 557056
    buffer_load_dwordx4 v36, s[32:35], s52 offen lds
    v_exp_f32 v218, v218
    v_mfma_f32_16x16x32_bf16 v[60:63], a[108:111], a[20:23], v[60:63]
    v_exp_f32 v219, v219
    v_mfma_f32_16x16x32_bf16 v[64:67], a[108:111], a[24:27], v[64:67]
    v_exp_f32 v220, v220
    v_mfma_f32_16x16x32_bf16 v[68:71], a[108:111], a[28:31], v[68:71]
    s_waitcnt lgkmcnt(0)
    s_barrier
    s_waitcnt vmcnt(17)
    v_mfma_f32_16x16x32_bf16 v[40:43], a[112:115], a[64:67], v[40:43]
    s_add_u32 s71, s75, 3
    s_and_b32 s71, s71, 7
    s_lshl_b32 s71, s71, 11
    s_add_u32 s71, s71, 32768
    buffer_load_dwordx4 a[176:179], v186, s[20:23], s71 offen offset:0 sc1
    ds_read_b32 v178, v207
    ds_read_b128 v[208:211], v206 offset:0
    v_mfma_f32_16x16x32_bf16 v[44:47], a[112:115], a[68:71], v[44:47]
    ds_read_b128 a[0:3], v14 offset:0
    ds_read_b128 v[212:215], v206 offset:1024
    v_exp_f32 v221, v221
    v_mfma_f32_16x16x32_bf16 v[48:51], a[112:115], a[72:75], v[48:51]
    buffer_load_dwordx4 a[184:187], v187, s[20:23], s71 offen offset:0 sc1
    ds_read_b128 a[4:7], v14 offset:2048
    v_exp_f32 v222, v222
    v_mfma_f32_16x16x32_bf16 v[52:55], a[112:115], a[76:79], v[52:55]
    v_exp_f32 v223, v223
    v_mfma_f32_16x16x32_bf16 v[56:59], a[120:123], a[64:67], v[56:59]
    ds_read_b128 a[8:11], v14 offset:4096
    v_add_f32 v216, 1.0, v216
    v_mfma_f32_16x16x32_bf16 v[60:63], a[120:123], a[68:71], v[60:63]
    buffer_load_dwordx4 a[180:183], v186, s[20:23], s71 offen offset:1024 sc1
    v_add_f32 v217, 1.0, v217
    v_mfma_f32_16x16x32_bf16 v[64:67], a[120:123], a[72:75], v[64:67]
    ds_read_b128 a[12:15], v14 offset:6144
    v_add_f32 v218, 1.0, v218
    v_add_f32 v219, 1.0, v219
    v_mfma_f32_16x16x32_bf16 v[68:71], a[120:123], a[76:79], v[68:71]
    v_add_f32 v220, 1.0, v220
    v_add_f32 v221, 1.0, v221
    v_mfma_f32_16x16x32_bf16 v[40:43], a[116:119], a[80:83], v[40:43]
    buffer_load_dwordx4 a[188:191], v187, s[20:23], s71 offen offset:1024 sc1
    ds_read_b128 a[16:19], v15 offset:0
    v_add_f32 v222, 1.0, v222
    v_add_f32 v223, 1.0, v223
    v_mfma_f32_16x16x32_bf16 v[44:47], a[116:119], a[84:87], v[44:47]
    ds_read_b128 a[20:23], v15 offset:2048
    v_rcp_f32 v216, v216
    v_mfma_f32_16x16x32_bf16 v[48:51], a[116:119], a[88:91], v[48:51]
    s_add_u32 m0, s65, 139264
    s_mov_b32 s52, 589824
    buffer_load_dwordx4 v36, s[32:35], s52 offen lds
    v_rcp_f32 v217, v217
    v_mfma_f32_16x16x32_bf16 v[52:55], a[116:119], a[92:95], v[52:55]
    ds_read_b128 a[24:27], v15 offset:4096
    v_rcp_f32 v218, v218
    v_mfma_f32_16x16x32_bf16 v[56:59], a[124:127], a[80:83], v[56:59]
    v_rcp_f32 v219, v219
    v_mfma_f32_16x16x32_bf16 v[60:63], a[124:127], a[84:87], v[60:63]
    s_add_u32 m0, s65, 143360
    s_mov_b32 s52, 622592
    buffer_load_dwordx4 v36, s[32:35], s52 offen lds
    ds_read_b128 a[28:31], v15 offset:6144
    v_rcp_f32 v220, v220
    v_mfma_f32_16x16x32_bf16 v[64:67], a[124:127], a[88:91], v[64:67]
    v_rcp_f32 v221, v221
    v_mfma_f32_16x16x32_bf16 v[68:71], a[124:127], a[92:95], v[68:71]
    s_waitcnt lgkmcnt(4)
    s_waitcnt vmcnt(18)
    v_mfma_f32_16x16x32_bf16 v[40:43], a[128:131], a[0:3], v[40:43]
    s_add_u32 s71, s75, 4
    s_and_b32 s71, s71, 7
    s_lshl_b32 s71, s71, 11
    s_add_u32 s71, s71, 32768
    buffer_load_dwordx4 a[32:35], v186, s[20:23], s71 offen offset:0 sc1
    s_lshl_b32 s48, s45, 11
    s_add_u32 s48, s48, s67
    buffer_store_dwordx4 v[208:211], v34, s[20:23], s48 offen offset:0 sc1
    buffer_store_dwordx4 v[212:215], v34, s[20:23], s48 offen offset:1024 sc1
    v_mfma_f32_16x16x32_bf16 v[44:47], a[128:131], a[4:7], v[44:47]
    ds_read_b128 a[64:67], v14 offset:8192
    v_mfma_f32_16x16x32_bf16 v[48:51], a[128:131], a[8:11], v[48:51]
    ds_read_b128 a[68:71], v14 offset:10240
    v_mfma_f32_16x16x32_bf16 v[52:55], a[128:131], a[12:15], v[52:55]
    buffer_load_dwordx4 a[40:43], v187, s[20:23], s71 offen offset:0 sc1
    v_mfma_f32_16x16x32_bf16 v[56:59], a[136:139], a[0:3], v[56:59]
    ds_read_b128 a[72:75], v14 offset:12288
    v_rcp_f32 v222, v222
    v_mfma_f32_16x16x32_bf16 v[60:63], a[136:139], a[4:7], v[60:63]
    v_rcp_f32 v223, v223
    v_mfma_f32_16x16x32_bf16 v[64:67], a[136:139], a[8:11], v[64:67]
    buffer_load_dwordx4 a[36:39], v186, s[20:23], s71 offen offset:1024 sc1
    ds_read_b128 a[76:79], v14 offset:14336
    v_mul_f32 v72, v72, v216
    v_mfma_f32_16x16x32_bf16 v[68:71], a[136:139], a[12:15], v[68:71]
    v_mul_f32 v73, v73, v217
    s_waitcnt lgkmcnt(4)
    v_mfma_f32_16x16x32_bf16 v[40:43], a[132:135], a[16:19], v[40:43]
    ds_read_b128 a[80:83], v15 offset:8192
    v_mul_f32 v74, v74, v218
    v_mul_f32 v75, v75, v219
    v_mfma_f32_16x16x32_bf16 v[44:47], a[132:135], a[20:23], v[44:47]
    buffer_load_dwordx4 a[44:47], v187, s[20:23], s71 offen offset:1024 sc1
    ds_read_b128 a[84:87], v15 offset:10240
    v_mul_f32 v76, v76, v220
    v_mul_f32 v77, v77, v221
    v_mfma_f32_16x16x32_bf16 v[48:51], a[132:135], a[24:27], v[48:51]
    v_mul_f32 v78, v78, v222
    v_mul_f32 v79, v79, v223
    v_mfma_f32_16x16x32_bf16 v[52:55], a[132:135], a[28:31], v[52:55]
    ds_read_b128 a[88:91], v15 offset:12288
    v_mul_f32 v216, v80, v80
    v_mfma_f32_16x16x32_bf16 v[56:59], a[140:143], a[16:19], v[56:59]
    s_add_u32 m0, s65, 147456
    s_mov_b32 s52, 655360
    buffer_load_dwordx4 v36, s[32:35], s52 offen lds
    v_mul_f32 v217, v81, v81
    v_mul_f32 v218, v82, v82
    v_mfma_f32_16x16x32_bf16 v[60:63], a[140:143], a[20:23], v[60:63]
    ds_read_b128 a[92:95], v15 offset:14336
    v_mul_f32 v219, v83, v83
    v_mul_f32 v220, v84, v84
    v_mfma_f32_16x16x32_bf16 v[64:67], a[140:143], a[24:27], v[64:67]
    v_mul_f32 v221, v85, v85
    v_mul_f32 v222, v86, v86
    v_mfma_f32_16x16x32_bf16 v[68:71], a[140:143], a[28:31], v[68:71]
    v_mul_f32 v223, v87, v87
    s_waitcnt lgkmcnt(4)
    s_waitcnt vmcnt(20)
    v_mfma_f32_16x16x32_bf16 v[40:43], a[144:147], a[64:67], v[40:43]
    s_add_u32 s71, s75, 5
    s_and_b32 s71, s71, 7
    s_lshl_b32 s71, s71, 11
    s_add_u32 s71, s71, 32768
    buffer_load_dwordx4 a[48:51], v186, s[20:23], s71 offen offset:0 sc1
    v_fma_f32 v216, v216, v184, s69
    v_fma_f32 v217, v217, v184, s69
    v_mfma_f32_16x16x32_bf16 v[44:47], a[144:147], a[68:71], v[44:47]
    ds_read_b128 a[0:3], v14 offset:16384
    v_fma_f32 v218, v218, v184, s69
    v_fma_f32 v219, v219, v184, s69
    v_mfma_f32_16x16x32_bf16 v[48:51], a[144:147], a[72:75], v[48:51]
    buffer_load_dwordx4 a[56:59], v187, s[20:23], s71 offen offset:0 sc1
    ds_read_b128 a[4:7], v14 offset:18432
    v_fma_f32 v220, v220, v184, s69
    v_fma_f32 v221, v221, v184, s69
    v_mfma_f32_16x16x32_bf16 v[52:55], a[144:147], a[76:79], v[52:55]
    v_fma_f32 v222, v222, v184, s69
    v_mfma_f32_16x16x32_bf16 v[56:59], a[152:155], a[64:67], v[56:59]
    ds_read_b128 a[8:11], v14 offset:20480
    v_fma_f32 v223, v223, v184, s69
    v_mul_f32 v216, v216, v80
    v_mfma_f32_16x16x32_bf16 v[60:63], a[152:155], a[68:71], v[60:63]
    buffer_load_dwordx4 a[52:55], v186, s[20:23], s71 offen offset:1024 sc1
    v_mul_f32 v217, v217, v81
    v_mul_f32 v218, v218, v82
    v_mfma_f32_16x16x32_bf16 v[64:67], a[152:155], a[72:75], v[64:67]
    ds_read_b128 a[12:15], v14 offset:22528
    v_mul_f32 v219, v219, v83
    v_mul_f32 v220, v220, v84
    v_mfma_f32_16x16x32_bf16 v[68:71], a[152:155], a[76:79], v[68:71]
    v_mul_f32 v221, v221, v85
    s_waitcnt lgkmcnt(4)
    v_mfma_f32_16x16x32_bf16 v[40:43], a[148:151], a[80:83], v[40:43]
    buffer_load_dwordx4 a[60:63], v187, s[20:23], s71 offen offset:1024 sc1
    ds_read_b128 a[16:19], v15 offset:16384
    v_mul_f32 v222, v222, v86
    v_mul_f32 v223, v223, v87
    v_mfma_f32_16x16x32_bf16 v[44:47], a[148:151], a[84:87], v[44:47]
    ds_read_b128 a[20:23], v15 offset:18432
    v_exp_f32 v216, v216
    v_mfma_f32_16x16x32_bf16 v[48:51], a[148:151], a[88:91], v[48:51]
    s_add_u32 m0, s65, 65536
    s_mov_b32 s52, 0
    buffer_load_dwordx4 v36, s[28:31], s52 offen lds
    v_exp_f32 v217, v217
    v_mfma_f32_16x16x32_bf16 v[52:55], a[148:151], a[92:95], v[52:55]
    ds_read_b128 a[24:27], v15 offset:20480
    v_exp_f32 v218, v218
    v_mfma_f32_16x16x32_bf16 v[56:59], a[156:159], a[80:83], v[56:59]
    v_exp_f32 v219, v219
    v_mfma_f32_16x16x32_bf16 v[60:63], a[156:159], a[84:87], v[60:63]
    s_add_u32 m0, s65, 69632
    s_mov_b32 s52, 32768
    buffer_load_dwordx4 v36, s[28:31], s52 offen lds
    ds_read_b128 a[28:31], v15 offset:22528
    v_exp_f32 v220, v220
    v_mfma_f32_16x16x32_bf16 v[64:67], a[156:159], a[88:91], v[64:67]
    v_exp_f32 v221, v221
    v_mfma_f32_16x16x32_bf16 v[68:71], a[156:159], a[92:95], v[68:71]
    s_waitcnt lgkmcnt(4)
    s_waitcnt vmcnt(20)
    v_mfma_f32_16x16x32_bf16 v[40:43], a[160:163], a[0:3], v[40:43]
    s_add_u32 s71, s75, 6
    s_and_b32 s71, s71, 7
    s_lshl_b32 s71, s71, 11
    s_add_u32 s71, s71, 32768
    buffer_load_dwordx4 a[96:99], v186, s[20:23], s71 offen offset:0 sc1
    v_exp_f32 v222, v222
    v_mfma_f32_16x16x32_bf16 v[44:47], a[160:163], a[4:7], v[44:47]
    ds_read_b128 a[64:67], v14 offset:24576
    v_exp_f32 v223, v223
    v_mfma_f32_16x16x32_bf16 v[48:51], a[160:163], a[8:11], v[48:51]
    ds_read_b128 a[68:71], v14 offset:26624
    v_add_f32 v216, 1.0, v216
    v_add_f32 v217, 1.0, v217
    v_mfma_f32_16x16x32_bf16 v[52:55], a[160:163], a[12:15], v[52:55]
    buffer_load_dwordx4 a[104:107], v187, s[20:23], s71 offen offset:0 sc1
    ds_read_b128 a[72:75], v14 offset:28672
    v_add_f32 v218, 1.0, v218
    v_mfma_f32_16x16x32_bf16 v[56:59], a[168:171], a[0:3], v[56:59]
    v_add_f32 v219, 1.0, v219
    v_add_f32 v220, 1.0, v220
    v_mfma_f32_16x16x32_bf16 v[60:63], a[168:171], a[4:7], v[60:63]
    ds_read_b128 a[76:79], v14 offset:30720
    v_add_f32 v221, 1.0, v221
    v_add_f32 v222, 1.0, v222
    v_mfma_f32_16x16x32_bf16 v[64:67], a[168:171], a[8:11], v[64:67]
    buffer_load_dwordx4 a[100:103], v186, s[20:23], s71 offen offset:1024 sc1
    ds_read_b128 a[80:83], v15 offset:24576
    v_add_f32 v223, 1.0, v223
    v_rcp_f32 v216, v216
    v_mfma_f32_16x16x32_bf16 v[68:71], a[168:171], a[12:15], v[68:71]
    ds_read_b128 a[84:87], v15 offset:26624
    s_waitcnt lgkmcnt(6)
    v_mfma_f32_16x16x32_bf16 v[40:43], a[164:167], a[16:19], v[40:43]
    v_rcp_f32 v217, v217
    v_mfma_f32_16x16x32_bf16 v[44:47], a[164:167], a[20:23], v[44:47]
    buffer_load_dwordx4 a[108:111], v187, s[20:23], s71 offen offset:1024 sc1
    ds_read_b128 a[88:91], v15 offset:28672
    v_rcp_f32 v218, v218
    v_mfma_f32_16x16x32_bf16 v[48:51], a[164:167], a[24:27], v[48:51]
    ds_read_b128 a[92:95], v15 offset:30720
    v_rcp_f32 v219, v219
    v_mfma_f32_16x16x32_bf16 v[52:55], a[164:167], a[28:31], v[52:55]
    v_rcp_f32 v220, v220
    v_mfma_f32_16x16x32_bf16 v[56:59], a[172:175], a[16:19], v[56:59]
    s_add_u32 m0, s65, 73728
    s_mov_b32 s52, 65536
    buffer_load_dwordx4 v36, s[28:31], s52 offen lds
    v_rcp_f32 v221, v221
    v_mfma_f32_16x16x32_bf16 v[60:63], a[172:175], a[20:23], v[60:63]
    v_rcp_f32 v222, v222
    v_mfma_f32_16x16x32_bf16 v[64:67], a[172:175], a[24:27], v[64:67]
    v_rcp_f32 v223, v223
    v_mfma_f32_16x16x32_bf16 v[68:71], a[172:175], a[28:31], v[68:71]
    s_waitcnt lgkmcnt(0)
    s_barrier
    s_waitcnt vmcnt(20)
    v_mfma_f32_16x16x32_bf16 v[40:43], a[176:179], a[64:67], v[40:43]
    s_add_u32 s71, s75, 7
    s_and_b32 s71, s71, 7
    s_lshl_b32 s71, s71, 11
    s_add_u32 s71, s71, 32768
    buffer_load_dwordx4 a[112:115], v186, s[20:23], s71 offen offset:0 sc1
    v_mul_f32 v80, v80, v216
    v_mul_f32 v81, v81, v217
    v_mfma_f32_16x16x32_bf16 v[44:47], a[176:179], a[68:71], v[44:47]
    ds_read_b128 a[0:3], v14 offset:32768
    v_mul_f32 v82, v82, v218
    v_mfma_f32_16x16x32_bf16 v[48:51], a[176:179], a[72:75], v[48:51]
    ds_read_b128 a[4:7], v14 offset:34816
    v_mul_f32 v83, v83, v219
    v_mfma_f32_16x16x32_bf16 v[52:55], a[176:179], a[76:79], v[52:55]
    buffer_load_dwordx4 a[120:123], v187, s[20:23], s71 offen offset:0 sc1
    ds_write_b128 v245, a[192:195] offset:0
    v_mul_f32 v84, v84, v220
    v_mfma_f32_16x16x32_bf16 v[56:59], a[184:187], a[64:67], v[56:59]
    ds_read_b128 a[8:11], v14 offset:36864
    v_mul_f32 v85, v85, v221
    v_mul_f32 v86, v86, v222
    v_mfma_f32_16x16x32_bf16 v[60:63], a[184:187], a[68:71], v[60:63]
    v_mul_f32 v87, v87, v223
    v_mfma_f32_16x16x32_bf16 v[64:67], a[184:187], a[72:75], v[64:67]
    buffer_load_dwordx4 a[116:119], v186, s[20:23], s71 offen offset:1024 sc1
    ds_read_b128 a[12:15], v14 offset:38912
    v_mul_f32 v216, v88, v88
    v_mfma_f32_16x16x32_bf16 v[68:71], a[184:187], a[76:79], v[68:71]
    v_mul_f32 v217, v89, v89
    v_mfma_f32_16x16x32_bf16 v[40:43], a[180:183], a[80:83], v[40:43]
    ds_read_b128 a[16:19], v15 offset:32768
    ds_write_b128 v245, a[196:199] offset:1024
    v_mul_f32 v218, v90, v90
    v_mul_f32 v219, v91, v91
    v_mfma_f32_16x16x32_bf16 v[44:47], a[180:183], a[84:87], v[44:47]
    buffer_load_dwordx4 a[124:127], v187, s[20:23], s71 offen offset:1024 sc1
    ds_read_b128 a[20:23], v15 offset:34816
    v_mul_f32 v220, v92, v92
    v_mfma_f32_16x16x32_bf16 v[48:51], a[180:183], a[88:91], v[48:51]
    v_mul_f32 v221, v93, v93
    v_mfma_f32_16x16x32_bf16 v[52:55], a[180:183], a[92:95], v[52:55]
    ds_read_b128 a[24:27], v15 offset:36864
    v_mul_f32 v222, v94, v94
    v_mfma_f32_16x16x32_bf16 v[56:59], a[188:191], a[80:83], v[56:59]
    s_add_u32 m0, s65, 77824
    s_mov_b32 s52, 98304
    buffer_load_dwordx4 v36, s[28:31], s52 offen lds
    v_mul_f32 v223, v95, v95
    v_fma_f32 v216, v216, v184, s69
    v_mfma_f32_16x16x32_bf16 v[60:63], a[188:191], a[84:87], v[60:63]
    ds_read_b128 a[28:31], v15 offset:38912
    v_fma_f32 v217, v217, v184, s69
    v_mfma_f32_16x16x32_bf16 v[64:67], a[188:191], a[88:91], v[64:67]
    v_fma_f32 v218, v218, v184, s69
    v_mfma_f32_16x16x32_bf16 v[68:71], a[188:191], a[92:95], v[68:71]
    v_fma_f32 v219, v219, v184, s69
    s_waitcnt lgkmcnt(5)
    s_waitcnt vmcnt(17)
    v_mfma_f32_16x16x32_bf16 v[40:43], a[32:35], a[0:3], v[40:43]
    s_add_u32 s71, s75, 0
    s_and_b32 s71, s71, 7
    s_lshl_b32 s71, s71, 11
    s_add_u32 s71, s71, 49152
    buffer_load_dwordx4 a[128:131], v186, s[20:23], s71 offen offset:0 sc1
    s_lshl_b32 s48, s44, 9
    s_lshl_b32 s50, s3, 7
    s_add_u32 s48, s48, s50
    s_lshl_b32 s50, s45, 4
    s_add_u32 s48, s48, s50
    s_add_u32 s48, s48, 655360
    v_lshlrev_b32 v10, 3, v1
    s_mov_b64 exec, 1
    buffer_store_dwordx2 v[172:173], v10, s[20:23], s48 offen sc1
    s_mov_b64 exec, -1
    v_mfma_f32_16x16x32_bf16 v[44:47], a[32:35], a[4:7], v[44:47]
    ds_read_b128 a[64:67], v14 offset:40960
    v_mfma_f32_16x16x32_bf16 v[48:51], a[32:35], a[8:11], v[48:51]
    ds_read_b128 a[68:71], v14 offset:43008
    v_mfma_f32_16x16x32_bf16 v[52:55], a[32:35], a[12:15], v[52:55]
    buffer_load_dwordx4 a[136:139], v187, s[20:23], s71 offen offset:0 sc1
    ds_write_b128 v245, a[200:203] offset:8192
    v_mfma_f32_16x16x32_bf16 v[56:59], a[40:43], a[0:3], v[56:59]
    ds_read_b128 a[72:75], v14 offset:45056
    v_mfma_f32_16x16x32_bf16 v[60:63], a[40:43], a[4:7], v[60:63]
    v_mfma_f32_16x16x32_bf16 v[64:67], a[40:43], a[8:11], v[64:67]
    buffer_load_dwordx4 a[132:135], v186, s[20:23], s71 offen offset:1024 sc1
    ds_read_b128 a[76:79], v14 offset:47104
    v_mfma_f32_16x16x32_bf16 v[68:71], a[40:43], a[12:15], v[68:71]
    s_waitcnt lgkmcnt(5)
    v_mfma_f32_16x16x32_bf16 v[40:43], a[36:39], a[16:19], v[40:43]
    ds_read_b128 a[80:83], v15 offset:40960
    ds_write_b128 v245, a[204:207] offset:9216
    v_mfma_f32_16x16x32_bf16 v[44:47], a[36:39], a[20:23], v[44:47]
    buffer_load_dwordx4 a[140:143], v187, s[20:23], s71 offen offset:1024 sc1
    ds_read_b128 a[84:87], v15 offset:43008
    v_fma_f32 v220, v220, v184, s69
    v_mfma_f32_16x16x32_bf16 v[48:51], a[36:39], a[24:27], v[48:51]
    v_fma_f32 v221, v221, v184, s69
    v_mfma_f32_16x16x32_bf16 v[52:55], a[36:39], a[28:31], v[52:55]
    ds_read_b128 a[88:91], v15 offset:45056
    v_fma_f32 v222, v222, v184, s69
    v_mfma_f32_16x16x32_bf16 v[56:59], a[44:47], a[16:19], v[56:59]
    s_add_u32 m0, s65, 81920
    s_mov_b32 s52, 131072
    buffer_load_dwordx4 v36, s[28:31], s52 offen lds
    v_fma_f32 v223, v223, v184, s69
    v_mul_f32 v216, v216, v88
    v_mfma_f32_16x16x32_bf16 v[60:63], a[44:47], a[20:23], v[60:63]
    ds_read_b128 a[92:95], v15 offset:47104
    v_mul_f32 v217, v217, v89
    v_mfma_f32_16x16x32_bf16 v[64:67], a[44:47], a[24:27], v[64:67]
    v_mul_f32 v218, v218, v90
    v_mfma_f32_16x16x32_bf16 v[68:71], a[44:47], a[28:31], v[68:71]
    v_mul_f32 v219, v219, v91
    s_waitcnt lgkmcnt(5)
    s_waitcnt vmcnt(18)
    v_mfma_f32_16x16x32_bf16 v[40:43], a[48:51], a[64:67], v[40:43]
    s_add_u32 s71, s75, 1
    s_and_b32 s71, s71, 7
    s_lshl_b32 s71, s71, 11
    s_add_u32 s71, s71, 49152
    buffer_load_dwordx4 a[144:147], v186, s[20:23], s71 offen offset:0 sc1
    v_mul_f32 v220, v220, v92
    v_mul_f32 v221, v221, v93
    v_mfma_f32_16x16x32_bf16 v[44:47], a[48:51], a[68:71], v[44:47]
    ds_read_b128 a[0:3], v14 offset:49152
    v_mul_f32 v222, v222, v94
    v_mfma_f32_16x16x32_bf16 v[48:51], a[48:51], a[72:75], v[48:51]
    ds_read_b128 a[4:7], v14 offset:51200
    v_mul_f32 v223, v223, v95
    v_mfma_f32_16x16x32_bf16 v[52:55], a[48:51], a[76:79], v[52:55]
    buffer_load_dwordx4 a[152:155], v187, s[20:23], s71 offen offset:0 sc1
    ds_write_b128 v245, a[208:211] offset:16384
    v_exp_f32 v216, v216
    v_mfma_f32_16x16x32_bf16 v[56:59], a[56:59], a[64:67], v[56:59]
    ds_read_b128 a[8:11], v14 offset:53248
    v_exp_f32 v217, v217
    v_mfma_f32_16x16x32_bf16 v[60:63], a[56:59], a[68:71], v[60:63]
    v_mfma_f32_16x16x32_bf16 v[64:67], a[56:59], a[72:75], v[64:67]
    buffer_load_dwordx4 a[148:151], v186, s[20:23], s71 offen offset:1024 sc1
    ds_read_b128 a[12:15], v14 offset:55296
    v_exp_f32 v218, v218
    v_mfma_f32_16x16x32_bf16 v[68:71], a[56:59], a[76:79], v[68:71]
    s_waitcnt lgkmcnt(5)
    v_mfma_f32_16x16x32_bf16 v[40:43], a[52:55], a[80:83], v[40:43]
    ds_read_b128 a[16:19], v15 offset:49152
    ds_write_b128 v245, a[212:215] offset:17408
    v_exp_f32 v219, v219
    v_mfma_f32_16x16x32_bf16 v[44:47], a[52:55], a[84:87], v[44:47]
    buffer_load_dwordx4 a[156:159], v187, s[20:23], s71 offen offset:1024 sc1
    ds_read_b128 a[20:23], v15 offset:51200
    v_exp_f32 v220, v220
    v_mfma_f32_16x16x32_bf16 v[48:51], a[52:55], a[88:91], v[48:51]
    v_mfma_f32_16x16x32_bf16 v[52:55], a[52:55], a[92:95], v[52:55]
    ds_read_b128 a[24:27], v15 offset:53248
    v_exp_f32 v221, v221
    v_mfma_f32_16x16x32_bf16 v[56:59], a[60:63], a[80:83], v[56:59]
    s_add_u32 m0, s65, 86016
    s_mov_b32 s52, 163840
    buffer_load_dwordx4 v36, s[28:31], s52 offen lds
    v_exp_f32 v222, v222
    v_mfma_f32_16x16x32_bf16 v[60:63], a[60:63], a[84:87], v[60:63]
    ds_read_b128 a[28:31], v15 offset:55296
    v_mfma_f32_16x16x32_bf16 v[64:67], a[60:63], a[88:91], v[64:67]
    v_exp_f32 v223, v223
    v_mfma_f32_16x16x32_bf16 v[68:71], a[60:63], a[92:95], v[68:71]
    s_waitcnt lgkmcnt(5)
    s_waitcnt vmcnt(17)
    v_mfma_f32_16x16x32_bf16 v[40:43], a[96:99], a[0:3], v[40:43]
    s_add_u32 s71, s75, 2
    s_and_b32 s71, s71, 7
    s_lshl_b32 s71, s71, 11
    s_add_u32 s71, s71, 49152
    buffer_load_dwordx4 a[160:163], v186, s[20:23], s71 offen offset:0 sc1
    v_add_f32 v216, 1.0, v216
    v_add_f32 v217, 1.0, v217
    v_mfma_f32_16x16x32_bf16 v[44:47], a[96:99], a[4:7], v[44:47]
    ds_read_b128 a[64:67], v14 offset:57344
    v_add_f32 v218, 1.0, v218
    v_mfma_f32_16x16x32_bf16 v[48:51], a[96:99], a[8:11], v[48:51]
    ds_read_b128 a[68:71], v14 offset:59392
    v_add_f32 v219, 1.0, v219
    v_mfma_f32_16x16x32_bf16 v[52:55], a[96:99], a[12:15], v[52:55]
    buffer_load_dwordx4 a[168:171], v187, s[20:23], s71 offen offset:0 sc1
    ds_read_b128 a[72:75], v14 offset:61440
    ds_write_b128 v245, a[216:219] offset:24576
    v_add_f32 v220, 1.0, v220
    v_mfma_f32_16x16x32_bf16 v[56:59], a[104:107], a[0:3], v[56:59]
    v_add_f32 v221, 1.0, v221
    v_add_f32 v222, 1.0, v222
    v_mfma_f32_16x16x32_bf16 v[60:63], a[104:107], a[4:7], v[60:63]
    ds_read_b128 a[76:79], v14 offset:63488
    v_add_f32 v223, 1.0, v223
    v_mfma_f32_16x16x32_bf16 v[64:67], a[104:107], a[8:11], v[64:67]
    buffer_load_dwordx4 a[164:167], v186, s[20:23], s71 offen offset:1024 sc1
    ds_read_b128 a[80:83], v15 offset:57344
    v_rcp_f32 v216, v216
    v_mfma_f32_16x16x32_bf16 v[68:71], a[104:107], a[12:15], v[68:71]
    ds_read_b128 a[84:87], v15 offset:59392
    s_waitcnt lgkmcnt(7)
    v_mfma_f32_16x16x32_bf16 v[40:43], a[100:103], a[16:19], v[40:43]
    ds_write_b128 v245, a[220:223] offset:25600
    v_rcp_f32 v217, v217
    v_mfma_f32_16x16x32_bf16 v[44:47], a[100:103], a[20:23], v[44:47]
    buffer_load_dwordx4 a[172:175], v187, s[20:23], s71 offen offset:1024 sc1
    ds_read_b128 a[88:91], v15 offset:61440
    v_rcp_f32 v218, v218
    v_mfma_f32_16x16x32_bf16 v[48:51], a[100:103], a[24:27], v[48:51]
    ds_read_b128 a[92:95], v15 offset:63488
    v_mfma_f32_16x16x32_bf16 v[52:55], a[100:103], a[28:31], v[52:55]
    v_rcp_f32 v219, v219
    v_mfma_f32_16x16x32_bf16 v[56:59], a[108:111], a[16:19], v[56:59]
    s_add_u32 m0, s65, 90112
    s_mov_b32 s52, 196608
    buffer_load_dwordx4 v36, s[28:31], s52 offen lds
    v_rcp_f32 v220, v220
    v_mfma_f32_16x16x32_bf16 v[60:63], a[108:111], a[20:23], v[60:63]
    v_mfma_f32_16x16x32_bf16 v[64:67], a[108:111], a[24:27], v[64:67]
    v_rcp_f32 v221, v221
    v_mfma_f32_16x16x32_bf16 v[68:71], a[108:111], a[28:31], v[68:71]
    s_waitcnt lgkmcnt(0)
    s_barrier
    s_waitcnt vmcnt(17)
    v_mfma_f32_16x16x32_bf16 v[40:43], a[112:115], a[64:67], v[40:43]
    s_add_u32 s71, s75, 3
    s_and_b32 s71, s71, 7
    s_lshl_b32 s71, s71, 11
    s_add_u32 s71, s71, 49152
    buffer_load_dwordx4 a[176:179], v186, s[20:23], s71 offen offset:0 sc1
    v_rcp_f32 v222, v222
    v_mfma_f32_16x16x32_bf16 v[44:47], a[112:115], a[68:71], v[44:47]
    ds_read_b128 a[0:3], v14 offset:0
    v_rcp_f32 v223, v223
    v_mfma_f32_16x16x32_bf16 v[48:51], a[112:115], a[72:75], v[48:51]
    ds_read_b128 a[4:7], v14 offset:2048
    v_mfma_f32_16x16x32_bf16 v[52:55], a[112:115], a[76:79], v[52:55]
    buffer_load_dwordx4 a[184:187], v187, s[20:23], s71 offen offset:0 sc1
    ds_write_b128 v245, a[224:227] offset:32768
    v_mul_f32 v88, v88, v216
    v_mfma_f32_16x16x32_bf16 v[56:59], a[120:123], a[64:67], v[56:59]
    ds_read_b128 a[8:11], v14 offset:4096
    v_mul_f32 v89, v89, v217
    v_mul_f32 v90, v90, v218
    v_mfma_f32_16x16x32_bf16 v[60:63], a[120:123], a[68:71], v[60:63]
    v_mul_f32 v91, v91, v219
    v_mfma_f32_16x16x32_bf16 v[64:67], a[120:123], a[72:75], v[64:67]
    buffer_load_dwordx4 a[180:183], v186, s[20:23], s71 offen offset:1024 sc1
    ds_read_b128 a[12:15], v14 offset:6144
    v_mul_f32 v92, v92, v220
    v_mfma_f32_16x16x32_bf16 v[68:71], a[120:123], a[76:79], v[68:71]
    v_mul_f32 v93, v93, v221
    v_mfma_f32_16x16x32_bf16 v[40:43], a[116:119], a[80:83], v[40:43]
    ds_read_b128 a[16:19], v15 offset:0
    ds_write_b128 v245, a[228:231] offset:33792
    v_mul_f32 v94, v94, v222
    v_mul_f32 v95, v95, v223
    v_mfma_f32_16x16x32_bf16 v[44:47], a[116:119], a[84:87], v[44:47]
    buffer_load_dwordx4 a[188:191], v187, s[20:23], s71 offen offset:1024 sc1
    ds_read_b128 a[20:23], v15 offset:2048
    v_mul_f32 v216, v96, v96
    v_mfma_f32_16x16x32_bf16 v[48:51], a[116:119], a[88:91], v[48:51]
    v_mul_f32 v217, v97, v97
    v_mfma_f32_16x16x32_bf16 v[52:55], a[116:119], a[92:95], v[52:55]
    ds_read_b128 a[24:27], v15 offset:4096
    v_mul_f32 v218, v98, v98
    v_mfma_f32_16x16x32_bf16 v[56:59], a[124:127], a[80:83], v[56:59]
    s_add_u32 m0, s65, 94208
    s_mov_b32 s52, 229376
    buffer_load_dwordx4 v36, s[28:31], s52 offen lds
    v_mul_f32 v219, v99, v99
    v_mul_f32 v220, v100, v100
    v_mfma_f32_16x16x32_bf16 v[60:63], a[124:127], a[84:87], v[60:63]
L_h6:
    s_cbranch_execz L_h10
    ds_read_b128 a[28:31], v15 offset:6144
    v_mul_f32 v221, v101, v101
    v_mfma_f32_16x16x32_bf16 v[64:67], a[124:127], a[88:91], v[64:67]
    v_mul_f32 v222, v102, v102
    v_mfma_f32_16x16x32_bf16 v[68:71], a[124:127], a[92:95], v[68:71]
    v_mul_f32 v223, v103, v103
    s_waitcnt lgkmcnt(5)
    s_waitcnt vmcnt(16)
    v_mfma_f32_16x16x32_bf16 v[40:43], a[128:131], a[0:3], v[40:43]
    s_add_u32 s71, s75, 4
    s_and_b32 s71, s71, 7
    s_lshl_b32 s71, s71, 11
    s_add_u32 s71, s71, 49152
    buffer_load_dwordx4 a[32:35], v186, s[20:23], s71 offen offset:0 sc1
    v_fma_f32 v216, v216, v184, s69
    v_fma_f32 v217, v217, v184, s69
    v_mfma_f32_16x16x32_bf16 v[44:47], a[128:131], a[4:7], v[44:47]
    ds_read_b128 a[64:67], v14 offset:8192
    v_fma_f32 v218, v218, v184, s69
    v_mfma_f32_16x16x32_bf16 v[48:51], a[128:131], a[8:11], v[48:51]
    buffer_load_dwordx4 a[40:43], v187, s[20:23], s71 offen offset:0 sc1
    ds_read_b128 a[68:71], v14 offset:10240
    v_fma_f32 v219, v219, v184, s69
    v_mfma_f32_16x16x32_bf16 v[52:55], a[128:131], a[12:15], v[52:55]
    ds_write_b128 v245, a[232:235] offset:40960
    v_fma_f32 v220, v220, v184, s69
    v_mfma_f32_16x16x32_bf16 v[56:59], a[136:139], a[0:3], v[56:59]
    ds_read_b128 a[72:75], v14 offset:12288
    v_fma_f32 v221, v221, v184, s69
    v_fma_f32 v222, v222, v184, s69
    v_mfma_f32_16x16x32_bf16 v[60:63], a[136:139], a[4:7], v[60:63]
    buffer_load_dwordx4 a[36:39], v186, s[20:23], s71 offen offset:1024 sc1
    v_fma_f32 v223, v223, v184, s69
    v_mfma_f32_16x16x32_bf16 v[64:67], a[136:139], a[8:11], v[64:67]
    ds_read_b128 a[76:79], v14 offset:14336
    v_mul_f32 v216, v216, v96
    v_mfma_f32_16x16x32_bf16 v[68:71], a[136:139], a[12:15], v[68:71]
    v_mul_f32 v217, v217, v97
    s_waitcnt lgkmcnt(5)
    v_mfma_f32_16x16x32_bf16 v[40:43], a[132:135], a[16:19], v[40:43]
    buffer_load_dwordx4 a[44:47], v187, s[20:23], s71 offen offset:1024 sc1
    ds_read_b128 a[80:83], v15 offset:8192
    ds_write_b128 v245, a[236:239] offset:41984
    v_mul_f32 v218, v218, v98
    v_mul_f32 v219, v219, v99
    v_mfma_f32_16x16x32_bf16 v[44:47], a[132:135], a[20:23], v[44:47]
    ds_read_b128 a[84:87], v15 offset:10240
    v_mul_f32 v220, v220, v100
    v_mfma_f32_16x16x32_bf16 v[48:51], a[132:135], a[24:27], v[48:51]
    s_add_u32 m0, s65, 98304
    s_mov_b32 s52, 262144
    buffer_load_dwordx4 v36, s[28:31], s52 offen lds
    v_mul_f32 v221, v221, v101
    v_mfma_f32_16x16x32_bf16 v[52:55], a[132:135], a[28:31], v[52:55]
    ds_read_b128 a[88:91], v15 offset:12288
    v_mul_f32 v222, v222, v102
    v_mfma_f32_16x16x32_bf16 v[56:59], a[140:143], a[16:19], v[56:59]
    v_mul_f32 v223, v223, v103
    v_exp_f32 v216, v216
    v_mfma_f32_16x16x32_bf16 v[60:63], a[140:143], a[20:23], v[60:63]
    v_min_u32 v185, 31, v1
    v_lshlrev_b32 v185, 4, v185
    s_lshl_b32 s72, s44, 9
    s_add_u32 s72, s72, 655360
    buffer_load_dwordx2 v[174:175], v185, s[20:23], s72 offen sc1
    ds_read_b128 a[92:95], v15 offset:14336
    v_mfma_f32_16x16x32_bf16 v[64:67], a[140:143], a[24:27], v[64:67]
    v_exp_f32 v217, v217
    v_mfma_f32_16x16x32_bf16 v[68:71], a[140:143], a[28:31], v[68:71]
    s_waitcnt lgkmcnt(5)
    s_waitcnt vmcnt(17)
    v_mfma_f32_16x16x32_bf16 v[40:43], a[144:147], a[64:67], v[40:43]
    s_add_u32 s71, s75, 5
    s_and_b32 s71, s71, 7
    s_lshl_b32 s71, s71, 11
    s_add_u32 s71, s71, 49152
    buffer_load_dwordx4 a[48:51], v186, s[20:23], s71 offen offset:0 sc1
    v_exp_f32 v218, v218
    v_mfma_f32_16x16x32_bf16 v[44:47], a[144:147], a[68:71], v[44:47]
    ds_read_b128 a[0:3], v14 offset:16384
    v_exp_f32 v219, v219
    v_mfma_f32_16x16x32_bf16 v[48:51], a[144:147], a[72:75], v[48:51]
    ds_read_b128 a[4:7], v14 offset:18432
    v_mfma_f32_16x16x32_bf16 v[52:55], a[144:147], a[76:79], v[52:55]
    buffer_load_dwordx4 a[56:59], v187, s[20:23], s71 offen offset:0 sc1
    ds_write_b128 v245, a[240:243] offset:49152
    v_exp_f32 v220, v220
    v_mfma_f32_16x16x32_bf16 v[56:59], a[152:155], a[64:67], v[56:59]
    ds_read_b128 a[8:11], v14 offset:20480
    v_exp_f32 v221, v221
    v_mfma_f32_16x16x32_bf16 v[60:63], a[152:155], a[68:71], v[60:63]
    v_mfma_f32_16x16x32_bf16 v[64:67], a[152:155], a[72:75], v[64:67]
    buffer_load_dwordx4 a[52:55], v186, s[20:23], s71 offen offset:1024 sc1
    ds_read_b128 a[12:15], v14 offset:22528
    v_exp_f32 v222, v222
    v_mfma_f32_16x16x32_bf16 v[68:71], a[152:155], a[76:79], v[68:71]
    s_waitcnt lgkmcnt(5)
    v_mfma_f32_16x16x32_bf16 v[40:43], a[148:151], a[80:83], v[40:43]
    ds_read_b128 a[16:19], v15 offset:16384
    ds_write_b128 v245, a[244:247] offset:50176
    v_exp_f32 v223, v223
    v_mfma_f32_16x16x32_bf16 v[44:47], a[148:151], a[84:87], v[44:47]
    buffer_load_dwordx4 a[60:63], v187, s[20:23], s71 offen offset:1024 sc1
    ds_read_b128 a[20:23], v15 offset:18432
    v_add_f32 v216, 1.0, v216
    v_mfma_f32_16x16x32_bf16 v[48:51], a[148:151], a[88:91], v[48:51]
    v_add_f32 v217, 1.0, v217
    v_mfma_f32_16x16x32_bf16 v[52:55], a[148:151], a[92:95], v[52:55]
    ds_read_b128 a[24:27], v15 offset:20480
    v_add_f32 v218, 1.0, v218
    v_mfma_f32_16x16x32_bf16 v[56:59], a[156:159], a[80:83], v[56:59]
    s_add_u32 m0, s65, 102400
    s_mov_b32 s52, 294912
    buffer_load_dwordx4 v36, s[28:31], s52 offen lds
    v_add_f32 v219, 1.0, v219
    v_add_f32 v220, 1.0, v220
    v_mfma_f32_16x16x32_bf16 v[60:63], a[156:159], a[84:87], v[60:63]
    ds_read_b128 a[28:31], v15 offset:22528
    v_add_f32 v221, 1.0, v221
    v_mfma_f32_16x16x32_bf16 v[64:67], a[156:159], a[88:91], v[64:67]
    v_add_f32 v222, 1.0, v222
    v_mfma_f32_16x16x32_bf16 v[68:71], a[156:159], a[92:95], v[68:71]
    v_add_f32 v223, 1.0, v223
    s_waitcnt lgkmcnt(5)
    s_waitcnt vmcnt(17)
    v_mfma_f32_16x16x32_bf16 v[40:43], a[160:163], a[0:3], v[40:43]
    s_add_u32 s71, s75, 6
    s_and_b32 s71, s71, 7
    s_lshl_b32 s71, s71, 11
    s_add_u32 s71, s71, 49152
    buffer_load_dwordx4 a[96:99], v186, s[20:23], s71 offen offset:0 sc1
    v_rcp_f32 v216, v216
    v_mfma_f32_16x16x32_bf16 v[44:47], a[160:163], a[4:7], v[44:47]
    ds_read_b128 a[64:67], v14 offset:24576
    v_rcp_f32 v217, v217
    v_mfma_f32_16x16x32_bf16 v[48:51], a[160:163], a[8:11], v[48:51]
    ds_read_b128 a[68:71], v14 offset:26624
    v_mfma_f32_16x16x32_bf16 v[52:55], a[160:163], a[12:15], v[52:55]
    buffer_load_dwordx4 a[104:107], v187, s[20:23], s71 offen offset:0 sc1
    ds_read_b128 a[72:75], v14 offset:28672
    ds_write_b128 v245, a[248:251] offset:57344
    v_rcp_f32 v218, v218
    v_mfma_f32_16x16x32_bf16 v[56:59], a[168:171], a[0:3], v[56:59]
    v_rcp_f32 v219, v219
    v_mfma_f32_16x16x32_bf16 v[60:63], a[168:171], a[4:7], v[60:63]
    ds_read_b128 a[76:79], v14 offset:30720
    v_mfma_f32_16x16x32_bf16 v[64:67], a[168:171], a[8:11], v[64:67]
    buffer_load_dwordx4 a[100:103], v186, s[20:23], s71 offen offset:1024 sc1
    ds_read_b128 a[80:83], v15 offset:24576
    v_rcp_f32 v220, v220
    v_mfma_f32_16x16x32_bf16 v[68:71], a[168:171], a[12:15], v[68:71]
    ds_read_b128 a[84:87], v15 offset:26624
    s_waitcnt lgkmcnt(7)
    v_mfma_f32_16x16x32_bf16 v[40:43], a[164:167], a[16:19], v[40:43]
    ds_write_b128 v245, a[252:255] offset:58368
    v_rcp_f32 v221, v221
    v_mfma_f32_16x16x32_bf16 v[44:47], a[164:167], a[20:23], v[44:47]
    buffer_load_dwordx4 a[108:111], v187, s[20:23], s71 offen offset:1024 sc1
    ds_read_b128 a[88:91], v15 offset:28672
    v_rcp_f32 v222, v222
    v_mfma_f32_16x16x32_bf16 v[48:51], a[164:167], a[24:27], v[48:51]
    ds_read_b128 a[92:95], v15 offset:30720
    v_mfma_f32_16x16x32_bf16 v[52:55], a[164:167], a[28:31], v[52:55]
    v_rcp_f32 v223, v223
    v_mfma_f32_16x16x32_bf16 v[56:59], a[172:175], a[16:19], v[56:59]
    s_add_u32 m0, s65, 106496
    s_mov_b32 s52, 327680
    buffer_load_dwordx4 v36, s[28:31], s52 offen lds
    v_mul_f32 v96, v96, v216
    v_mfma_f32_16x16x32_bf16 v[60:63], a[172:175], a[20:23], v[60:63]
    v_mul_f32 v97, v97, v217
    v_mfma_f32_16x16x32_bf16 v[64:67], a[172:175], a[24:27], v[64:67]
    v_mul_f32 v98, v98, v218
    v_mfma_f32_16x16x32_bf16 v[68:71], a[172:175], a[28:31], v[68:71]
    v_mul_f32 v99, v99, v219
    s_waitcnt lgkmcnt(0)
    s_barrier
    s_waitcnt vmcnt(10)
    s_mov_b32 s58, 0x40000
L_poll2:
    v_cmp_ne_u64 vcc, s[56:57], v[174:175]
    s_nop 4
    s_cbranch_vccz L_polld2
    s_sub_u32 s58, s58, 1
    s_cbranch_scc1 L_polld2
    s_sleep 1
    v_min_u32 v185, 31, v1
    v_lshlrev_b32 v185, 4, v185
    s_lshl_b32 s72, s44, 9
    s_add_u32 s72, s72, 655360
    buffer_load_dwordx2 v[174:175], v185, s[20:23], s72 offen sc1
    s_waitcnt vmcnt(0)
    s_branch L_poll2
L_polld2:
    v_mfma_f32_16x16x32_bf16 v[40:43], a[176:179], a[64:67], v[40:43]
    s_add_u32 s71, s75, 7
    s_and_b32 s71, s71, 7
    s_lshl_b32 s71, s71, 11
    s_add_u32 s71, s71, 49152
    buffer_load_dwordx4 a[112:115], v186, s[20:23], s71 offen offset:0 sc1
    v_mul_f32 v100, v100, v220
    v_mfma_f32_16x16x32_bf16 v[44:47], a[176:179], a[68:71], v[44:47]
    buffer_load_dwordx4 a[120:123], v187, s[20:23], s71 offen offset:0 sc1
    ds_read_b128 a[0:3], v14 offset:32768
    v_mfma_f32_16x16x32_bf16 v[48:51], a[176:179], a[72:75], v[48:51]
    ds_read_b128 a[4:7], v14 offset:34816
    v_mfma_f32_16x16x32_bf16 v[52:55], a[176:179], a[76:79], v[52:55]
    buffer_load_dwordx4 a[116:119], v186, s[20:23], s71 offen offset:1024 sc1
    v_mfma_f32_16x16x32_bf16 v[56:59], a[184:187], a[64:67], v[56:59]
    ds_read_b128 a[8:11], v14 offset:36864
    v_mul_f32 v101, v101, v221
    v_mfma_f32_16x16x32_bf16 v[60:63], a[184:187], a[68:71], v[60:63]
    buffer_load_dwordx4 a[124:127], v187, s[20:23], s71 offen offset:1024 sc1
    v_mfma_f32_16x16x32_bf16 v[64:67], a[184:187], a[72:75], v[64:67]
    ds_read_b128 a[12:15], v14 offset:38912
    v_mfma_f32_16x16x32_bf16 v[68:71], a[184:187], a[76:79], v[68:71]
    s_add_u32 m0, s65, 110592
    s_mov_b32 s52, 360448
    buffer_load_dwordx4 v36, s[28:31], s52 offen lds
    v_mfma_f32_16x16x32_bf16 v[40:43], a[180:183], a[80:83], v[40:43]
    s_add_u32 m0, s65, 114688
    s_mov_b32 s52, 393216
    buffer_load_dwordx4 v36, s[28:31], s52 offen lds
    ds_read_b128 a[16:19], v15 offset:32768
    v_mul_f32 v102, v102, v222
    v_mfma_f32_16x16x32_bf16 v[44:47], a[180:183], a[84:87], v[44:47]
    ds_read_b128 a[20:23], v15 offset:34816
    v_mfma_f32_16x16x32_bf16 v[48:51], a[180:183], a[88:91], v[48:51]
    s_add_u32 m0, s65, 118784
    s_mov_b32 s52, 425984
    buffer_load_dwordx4 v36, s[28:31], s52 offen lds
    v_mfma_f32_16x16x32_bf16 v[52:55], a[180:183], a[92:95], v[52:55]
    ds_read_b128 a[24:27], v15 offset:36864
    v_mfma_f32_16x16x32_bf16 v[56:59], a[188:191], a[80:83], v[56:59]
    s_add_u32 m0, s65, 122880
    s_mov_b32 s52, 458752
    buffer_load_dwordx4 v36, s[28:31], s52 offen lds
    v_mul_f32 v103, v103, v223
    v_mfma_f32_16x16x32_bf16 v[60:63], a[188:191], a[84:87], v[60:63]
    ds_read_b128 a[28:31], v15 offset:38912
    v_mfma_f32_16x16x32_bf16 v[64:67], a[188:191], a[88:91], v[64:67]
    s_add_u32 m0, s65, 126976
    s_mov_b32 s52, 491520
    buffer_load_dwordx4 v36, s[28:31], s52 offen lds
    v_mfma_f32_16x16x32_bf16 v[68:71], a[188:191], a[92:95], v[68:71]
    s_waitcnt lgkmcnt(4)
    v_mfma_f32_16x16x32_bf16 v[40:43], a[32:35], a[0:3], v[40:43]
    s_add_u32 m0, s65, 151552
    s_mov_b32 s52, 688128
    buffer_load_dwordx4 v36, s[32:35], s52 offen lds
    v_mfma_f32_16x16x32_bf16 v[44:47], a[32:35], a[4:7], v[44:47]
    ds_read_b128 a[64:67], v14 offset:40960
    v_mfma_f32_16x16x32_bf16 v[48:51], a[32:35], a[8:11], v[48:51]
    ds_read_b128 a[68:71], v14 offset:43008
    v_mfma_f32_16x16x32_bf16 v[52:55], a[32:35], a[12:15], v[52:55]
    s_add_u32 m0, s65, 155648
    s_mov_b32 s52, 720896
    buffer_load_dwordx4 v36, s[32:35], s52 offen lds
    v_mfma_f32_16x16x32_bf16 v[56:59], a[40:43], a[0:3], v[56:59]
    ds_read_b128 a[72:75], v14 offset:45056
    v_mfma_f32_16x16x32_bf16 v[60:63], a[40:43], a[4:7], v[60:63]
    v_mfma_f32_16x16x32_bf16 v[64:67], a[40:43], a[8:11], v[64:67]
    s_add_u32 m0, s65, 159744
    s_mov_b32 s52, 753664
    buffer_load_dwordx4 v36, s[32:35], s52 offen lds
    ds_read_b128 a[76:79], v14 offset:47104
    v_mfma_f32_16x16x32_bf16 v[68:71], a[40:43], a[12:15], v[68:71]
    s_waitcnt lgkmcnt(4)
    v_mfma_f32_16x16x32_bf16 v[40:43], a[36:39], a[16:19], v[40:43]
    ds_read_b128 a[80:83], v15 offset:40960
    v_mfma_f32_16x16x32_bf16 v[44:47], a[36:39], a[20:23], v[44:47]
    s_add_u32 s78, s67, 0
    buffer_load_dwordx4 a[192:195], v204, s[20:23], s78 offen offset:0 sc1
    ds_read_b128 a[84:87], v15 offset:43008
    v_mfma_f32_16x16x32_bf16 v[48:51], a[36:39], a[24:27], v[48:51]
    v_mfma_f32_16x16x32_bf16 v[52:55], a[36:39], a[28:31], v[52:55]
    ds_read_b128 a[88:91], v15 offset:45056
    v_mfma_f32_16x16x32_bf16 v[56:59], a[44:47], a[16:19], v[56:59]
    s_add_u32 s79, s77, 0
    buffer_load_dwordx4 a[196:199], v204, s[20:23], s79 offen offset:0 sc1
    v_mfma_f32_16x16x32_bf16 v[60:63], a[44:47], a[20:23], v[60:63]
    ds_read_b128 a[92:95], v15 offset:47104
    v_mfma_f32_16x16x32_bf16 v[64:67], a[44:47], a[24:27], v[64:67]
    v_mfma_f32_16x16x32_bf16 v[68:71], a[44:47], a[28:31], v[68:71]
    s_waitcnt lgkmcnt(4)
    s_waitcnt vmcnt(20)
    v_mfma_f32_16x16x32_bf16 v[40:43], a[48:51], a[64:67], v[40:43]
    buffer_load_dwordx4 a[200:203], v204, s[20:23], s78 offen offset:2048 sc1
    v_mfma_f32_16x16x32_bf16 v[44:47], a[48:51], a[68:71], v[44:47]
    ds_read_b128 a[0:3], v14 offset:49152
    v_mfma_f32_16x16x32_bf16 v[48:51], a[48:51], a[72:75], v[48:51]
    ds_read_b128 a[4:7], v14 offset:51200
    ds_read_b128 a[8:11], v14 offset:53248
    v_mfma_f32_16x16x32_bf16 v[52:55], a[48:51], a[76:79], v[52:55]
    buffer_load_dwordx4 a[204:207], v204, s[20:23], s79 offen offset:2048 sc1
    ds_read_b128 a[12:15], v14 offset:55296
    v_mfma_f32_16x16x32_bf16 v[56:59], a[56:59], a[64:67], v[56:59]
    ds_read_b128 a[16:19], v15 offset:49152
    v_mfma_f32_16x16x32_bf16 v[60:63], a[56:59], a[68:71], v[60:63]
    ds_read_b128 a[20:23], v15 offset:51200
    v_mfma_f32_16x16x32_bf16 v[64:67], a[56:59], a[72:75], v[64:67]
    s_add_u32 s78, s67, 4096
    buffer_load_dwordx4 a[208:211], v204, s[20:23], s78 offen offset:0 sc1
    ds_read_b128 a[24:27], v15 offset:53248
    v_mfma_f32_16x16x32_bf16 v[68:71], a[56:59], a[76:79], v[68:71]
    ds_read_b128 a[28:31], v15 offset:55296
    s_waitcnt lgkmcnt(8)
    v_mfma_f32_16x16x32_bf16 v[40:43], a[52:55], a[80:83], v[40:43]
    ds_read_b64_tr_b16 a[128:129], v246 offset:0
    v_mfma_f32_16x16x32_bf16 v[44:47], a[52:55], a[84:87], v[44:47]
    s_add_u32 s79, s77, 4096
    buffer_load_dwordx4 a[212:215], v204, s[20:23], s79 offen offset:0 sc1
    ds_read_b64_tr_b16 a[130:131], v246 offset:2048
    ds_read_b64_tr_b16 a[132:133], v247 offset:0
    v_mfma_f32_16x16x32_bf16 v[48:51], a[52:55], a[88:91], v[48:51]
    ds_read_b64_tr_b16 a[134:135], v247 offset:2048
    v_mfma_f32_16x16x32_bf16 v[52:55], a[52:55], a[92:95], v[52:55]
    ds_read_b64_tr_b16 a[136:137], v248 offset:0
    v_mfma_f32_16x16x32_bf16 v[56:59], a[60:63], a[80:83], v[56:59]
    buffer_load_dwordx4 a[216:219], v204, s[20:23], s78 offen offset:2048 sc1
    ds_read_b64_tr_b16 a[138:139], v248 offset:2048
    v_mfma_f32_16x16x32_bf16 v[60:63], a[60:63], a[84:87], v[60:63]
    ds_read_b64_tr_b16 a[140:141], v249 offset:0
    v_mfma_f32_16x16x32_bf16 v[64:67], a[60:63], a[88:91], v[64:67]
    ds_read_b64_tr_b16 a[142:143], v249 offset:2048
    v_mfma_f32_16x16x32_bf16 v[68:71], a[60:63], a[92:95], v[68:71]
    s_waitcnt lgkmcnt(12)
    s_waitcnt vmcnt(20)
    v_mfma_f32_16x16x32_bf16 v[40:43], a[96:99], a[0:3], v[40:43]
    buffer_load_dwordx4 a[220:223], v204, s[20:23], s79 offen offset:2048 sc1
    v_mfma_f32_16x16x32_bf16 v[44:47], a[96:99], a[4:7], v[44:47]
    ds_read_b128 a[64:67], v14 offset:57344
    ds_read_b128 a[68:71], v14 offset:59392
    v_mfma_f32_16x16x32_bf16 v[48:51], a[96:99], a[8:11], v[48:51]
    ds_read_b128 a[72:75], v14 offset:61440
    v_mfma_f32_16x16x32_bf16 v[52:55], a[96:99], a[12:15], v[52:55]
    s_add_u32 s78, s67, 8192
    buffer_load_dwordx4 a[224:227], v204, s[20:23], s78 offen offset:0 sc1
    ds_read_b128 a[76:79], v14 offset:63488
    ds_read_b128 a[80:83], v15 offset:57344
    v_mfma_f32_16x16x32_bf16 v[56:59], a[104:107], a[0:3], v[56:59]
    ds_read_b128 a[84:87], v15 offset:59392
    v_mfma_f32_16x16x32_bf16 v[60:63], a[104:107], a[4:7], v[60:63]
    ds_read_b128 a[88:91], v15 offset:61440
    ds_read_b128 a[92:95], v15 offset:63488
    v_mfma_f32_16x16x32_bf16 v[64:67], a[104:107], a[8:11], v[64:67]
    s_add_u32 s79, s77, 8192
    buffer_load_dwordx4 a[228:231], v204, s[20:23], s79 offen offset:0 sc1
    ds_read_b64_tr_b16 a[144:145], v246 offset:8192
    v_mfma_f32_16x16x32_bf16 v[68:71], a[104:107], a[12:15], v[68:71]
    ds_read_b64_tr_b16 a[146:147], v246 offset:10240
    ds_read_b64_tr_b16 a[148:149], v247 offset:8192
    s_waitcnt lgkmcnt(15)
    v_mfma_f32_16x16x32_bf16 v[40:43], a[100:103], a[16:19], v[40:43]
    ds_read_b64_tr_b16 a[150:151], v247 offset:10240
    v_mfma_f32_16x16x32_bf16 v[44:47], a[100:103], a[20:23], v[44:47]
    buffer_load_dwordx4 a[232:235], v204, s[20:23], s78 offen offset:2048 sc1
    ds_read_b64_tr_b16 a[152:153], v248 offset:8192
    ds_read_b64_tr_b16 a[154:155], v248 offset:10240
    v_mfma_f32_16x16x32_bf16 v[48:51], a[100:103], a[24:27], v[48:51]
    ds_read_b64_tr_b16 a[156:157], v249 offset:8192
    v_mfma_f32_16x16x32_bf16 v[52:55], a[100:103], a[28:31], v[52:55]
    ds_read_b64_tr_b16 a[158:159], v249 offset:10240
    v_mfma_f32_16x16x32_bf16 v[56:59], a[108:111], a[16:19], v[56:59]
    buffer_load_dwordx4 a[236:239], v204, s[20:23], s79 offen offset:2048 sc1
    v_mfma_f32_16x16x32_bf16 v[60:63], a[108:111], a[20:23], v[60:63]
    v_mfma_f32_16x16x32_bf16 v[64:67], a[108:111], a[24:27], v[64:67]
    v_mfma_f32_16x16x32_bf16 v[68:71], a[108:111], a[28:31], v[68:71]
    s_waitcnt lgkmcnt(0)
    s_waitcnt vmcnt(12)
    s_barrier
    v_mfma_f32_16x16x32_bf16 v[40:43], a[112:115], a[64:67], v[40:43]
    s_add_u32 s78, s67, 12288
    buffer_load_dwordx4 a[240:243], v204, s[20:23], s78 offen offset:0 sc1
    v_mfma_f32_16x16x32_bf16 v[44:47], a[112:115], a[68:71], v[44:47]
    v_mfma_f32_16x16x32_bf16 v[48:51], a[112:115], a[72:75], v[48:51]
    v_mfma_f32_16x16x32_bf16 v[52:55], a[112:115], a[76:79], v[52:55]
    v_mfma_f32_16x16x32_bf16 v[56:59], a[120:123], a[64:67], v[56:59]
    s_add_u32 s79, s77, 12288
    buffer_load_dwordx4 a[244:247], v204, s[20:23], s79 offen offset:0 sc1
    v_mfma_f32_16x16x32_bf16 v[60:63], a[120:123], a[68:71], v[60:63]
    v_mfma_f32_16x16x32_bf16 v[64:67], a[120:123], a[72:75], v[64:67]
    v_mfma_f32_16x16x32_bf16 v[68:71], a[120:123], a[76:79], v[68:71]
    v_mfma_f32_16x16x32_bf16 v[40:43], a[116:119], a[80:83], v[40:43]
    buffer_load_dwordx4 a[248:251], v204, s[20:23], s78 offen offset:2048 sc1
    v_mfma_f32_16x16x32_bf16 v[44:47], a[116:119], a[84:87], v[44:47]
    v_mfma_f32_16x16x32_bf16 v[48:51], a[116:119], a[88:91], v[48:51]
    v_mfma_f32_16x16x32_bf16 v[52:55], a[116:119], a[92:95], v[52:55]
    v_mfma_f32_16x16x32_bf16 v[56:59], a[124:127], a[80:83], v[56:59]
    buffer_load_dwordx4 a[252:255], v204, s[20:23], s79 offen offset:2048 sc1
    v_mfma_f32_16x16x32_bf16 v[60:63], a[124:127], a[84:87], v[60:63]
    v_mfma_f32_16x16x32_bf16 v[64:67], a[124:127], a[88:91], v[64:67]
    v_mfma_f32_16x16x32_bf16 v[68:71], a[124:127], a[92:95], v[68:71]
    v_pk_add_f32 v[40:41], v[40:41], v[180:181] op_sel:[0,0] op_sel_hi:[1,0]
    v_pk_add_f32 v[42:43], v[42:43], v[180:181] op_sel:[0,0] op_sel_hi:[1,0]
    s_nop 1
    v_pk_add_f32 v[56:57], v[56:57], v[180:181] op_sel:[0,0] op_sel_hi:[1,0]
    v_pk_add_f32 v[58:59], v[58:59], v[180:181] op_sel:[0,0] op_sel_hi:[1,0]
    v_pk_mul_f32 v[40:41], v[40:41], v[72:73]
    v_pk_mul_f32 v[42:43], v[42:43], v[74:75]
    v_pk_mul_f32 v[56:57], v[56:57], v[88:89]
    v_pk_mul_f32 v[58:59], v[58:59], v[90:91]
    s_add_u32 s48, s74, 0
    v_cvt_pk_bf16_f32 v188, v40, v41
    v_cvt_pk_bf16_f32 v189, v42, v43
    v_cvt_pk_bf16_f32 v190, v56, v57
    v_cvt_pk_bf16_f32 v191, v58, v59
    buffer_store_dwordx4 v[188:191], v34, s[20:23], s48 offen sc1
    v_pk_add_f32 v[44:45], v[44:45], v[180:181] op_sel:[0,1] op_sel_hi:[1,1]
    v_pk_add_f32 v[46:47], v[46:47], v[180:181] op_sel:[0,1] op_sel_hi:[1,1]
    v_pk_add_f32 v[60:61], v[60:61], v[180:181] op_sel:[0,1] op_sel_hi:[1,1]
    v_pk_add_f32 v[62:63], v[62:63], v[180:181] op_sel:[0,1] op_sel_hi:[1,1]
    v_pk_mul_f32 v[44:45], v[44:45], v[76:77]
    v_pk_mul_f32 v[46:47], v[46:47], v[78:79]
    v_pk_mul_f32 v[60:61], v[60:61], v[92:93]
    v_pk_mul_f32 v[62:63], v[62:63], v[94:95]
    s_add_u32 s48, s74, 28672
    v_cvt_pk_bf16_f32 v192, v44, v45
    v_cvt_pk_bf16_f32 v193, v46, v47
    v_cvt_pk_bf16_f32 v194, v60, v61
    v_cvt_pk_bf16_f32 v195, v62, v63
    buffer_store_dwordx4 v[192:195], v34, s[20:23], s48 offen sc1
    v_pk_add_f32 v[48:49], v[48:49], v[182:183] op_sel:[0,0] op_sel_hi:[1,0]
    v_pk_add_f32 v[50:51], v[50:51], v[182:183] op_sel:[0,0] op_sel_hi:[1,0]
    v_pk_add_f32 v[64:65], v[64:65], v[182:183] op_sel:[0,0] op_sel_hi:[1,0]
    v_pk_add_f32 v[66:67], v[66:67], v[182:183] op_sel:[0,0] op_sel_hi:[1,0]
    v_pk_mul_f32 v[48:49], v[48:49], v[80:81]
    v_pk_mul_f32 v[50:51], v[50:51], v[82:83]
    v_pk_mul_f32 v[64:65], v[64:65], v[96:97]
    v_pk_mul_f32 v[66:67], v[66:67], v[98:99]
    s_add_u32 s48, s74, 57344
    v_cvt_pk_bf16_f32 v196, v48, v49
    v_cvt_pk_bf16_f32 v197, v50, v51
    v_cvt_pk_bf16_f32 v198, v64, v65
    v_cvt_pk_bf16_f32 v199, v66, v67
    buffer_store_dwordx4 v[196:199], v34, s[20:23], s48 offen sc1
    v_pk_add_f32 v[52:53], v[52:53], v[182:183] op_sel:[0,1] op_sel_hi:[1,1]
    v_pk_add_f32 v[54:55], v[54:55], v[182:183] op_sel:[0,1] op_sel_hi:[1,1]
    v_pk_add_f32 v[68:69], v[68:69], v[182:183] op_sel:[0,1] op_sel_hi:[1,1]
    v_pk_add_f32 v[70:71], v[70:71], v[182:183] op_sel:[0,1] op_sel_hi:[1,1]
    v_pk_mul_f32 v[52:53], v[52:53], v[84:85]
    v_pk_mul_f32 v[54:55], v[54:55], v[86:87]
    v_pk_mul_f32 v[68:69], v[68:69], v[100:101]
    v_pk_mul_f32 v[70:71], v[70:71], v[102:103]
    s_add_u32 s48, s74, 86016
    v_cvt_pk_bf16_f32 v200, v52, v53
    v_cvt_pk_bf16_f32 v201, v54, v55
    v_cvt_pk_bf16_f32 v202, v68, v69
    v_cvt_pk_bf16_f32 v203, v70, v71
    buffer_store_dwordx4 v[200:203], v34, s[20:23], s48 offen sc1
L_join:
    s_nop 1
    s_or_b32 s48, s2, s3
    s_cmp_lg_u32 s48, 0
    s_cbranch_scc1 L_nogl
    v_min_u32 v8, 31, v1
    v_and_b32 v9, 4, v8
    v_xor_b32 v9, 7, v9
    v_lshl_add_u32 v8, v8, 5, v9
    v_lshlrev_b32 v14, 4, v8
    s_mov_b32 s72, 655360
    buffer_load_dwordx2 v[12:13], v14, s[20:23], s72 offen sc1
L_nogl:
    s_waitcnt vmcnt(16)
    v_mfma_f32_16x16x32_bf16 v[144:147], a[128:131], a[192:195], 0
    s_add_u32 m0, s65, 0
    s_mov_b32 s52, 0
    buffer_load_dwordx4 v36, s[32:35], s52 offen lds
    ds_read_b64_tr_b16 a[160:161], v246 offset:16384
    v_add_u32 v19, 65536, v246
    v_subrev_u32 v15, 65536, v246
    v_mfma_f32_16x16x32_bf16 v[160:163], a[128:131], a[196:199], 0
    ds_read_b64_tr_b16 a[162:163], v246 offset:18432
    v_add_u32 v20, 65536, v247
    v_mfma_f32_16x16x32_bf16 v[148:151], a[132:135], a[192:195], 0
    s_add_u32 m0, s65, 4096
    s_mov_b32 s52, 32768
    buffer_load_dwordx4 v36, s[32:35], s52 offen lds
    ds_read_b64_tr_b16 a[164:165], v247 offset:16384
    v_subrev_u32 v16, 65536, v247
    v_add_u32 v21, 65536, v248
    v_mfma_f32_16x16x32_bf16 v[180:183], a[132:135], a[196:199], 0
    ds_read_b64_tr_b16 a[166:167], v247 offset:18432
    v_subrev_u32 v17, 65536, v248
    v_mfma_f32_16x16x32_bf16 v[152:155], a[136:139], a[192:195], 0
    ds_read_b64_tr_b16 a[168:169], v248 offset:16384
    v_add_u32 v22, 65536, v249
    v_subrev_u32 v18, 65536, v249
    v_mfma_f32_16x16x32_bf16 v[208:211], a[136:139], a[196:199], 0
    s_add_u32 m0, s65, 8192
    s_mov_b32 s52, 65536
    buffer_load_dwordx4 v36, s[32:35], s52 offen lds
    ds_read_b64_tr_b16 a[170:171], v248 offset:18432
    v_sub_f32 v179, 1.0, v178
    v_mfma_f32_16x16x32_bf16 v[156:159], a[140:143], a[192:195], 0
    ds_read_b64_tr_b16 a[172:173], v249 offset:16384
    s_mul_i32 s49, s3, 28672
    s_xor_b32 s50, s3, 1
    v_mfma_f32_16x16x32_bf16 v[212:215], a[140:143], a[196:199], 0
    ds_read_b64_tr_b16 a[174:175], v249 offset:18432
    s_mul_i32 s50, s50, 28672
    s_waitcnt vmcnt(17)
    v_mfma_f32_16x16x32_bf16 v[144:147], a[144:147], a[200:203], v[144:147]
    s_add_u32 m0, s65, 12288
    s_mov_b32 s52, 98304
    buffer_load_dwordx4 v36, s[32:35], s52 offen lds
    ds_read_b64_tr_b16 a[128:129], v246 offset:24576
    s_add_u32 s80, s50, s70
    s_add_u32 s70, s49, s70
    v_mfma_f32_16x16x32_bf16 v[160:163], a[144:147], a[204:207], v[160:163]
    ds_read_b64_tr_b16 a[130:131], v246 offset:26624
    s_sub_u32 s48, s80, s70
    v_mfma_f32_16x16x32_bf16 v[148:151], a[148:151], a[200:203], v[148:151]
    s_add_u32 m0, s65, 16384
    s_mov_b32 s52, 131072
    buffer_load_dwordx4 v36, s[32:35], s52 offen lds
    ds_read_b64_tr_b16 a[132:133], v247 offset:24576
    v_min_u32 v8, 13, v2
    v_lshlrev_b32 v8, 11, v8
    v_mfma_f32_16x16x32_bf16 v[180:183], a[148:151], a[204:207], v[180:183]
    ds_read_b64_tr_b16 a[134:135], v247 offset:26624
    v_and_b32 v9, 1, v3
    v_mfma_f32_16x16x32_bf16 v[152:155], a[152:155], a[200:203], v[152:155]
    ds_read_b64_tr_b16 a[136:137], v248 offset:24576
    v_mul_lo_u32 v9, v9, s48
    s_lshl_b32 s48, s76, 10
    v_mfma_f32_16x16x32_bf16 v[208:211], a[152:155], a[204:207], v[208:211]
    s_add_u32 m0, s65, 20480
    s_mov_b32 s52, 163840
    buffer_load_dwordx4 v36, s[32:35], s52 offen lds
    ds_read_b64_tr_b16 a[138:139], v248 offset:26624
    s_add_u32 s48, s48, s70
    v_mfma_f32_16x16x32_bf16 v[156:159], a[156:159], a[200:203], v[156:159]
    ds_read_b64_tr_b16 a[140:141], v249 offset:24576
    s_add_u32 s48, s48, 1020
    v_add3_u32 v185, v8, v9, s48
    v_mfma_f32_16x16x32_bf16 v[212:215], a[156:159], a[204:207], v[212:215]
    ds_read_b64_tr_b16 a[142:143], v249 offset:26624
    v_mov_b32 v174, 0
    s_waitcnt lgkmcnt(8)
    s_waitcnt vmcnt(18)
    v_mfma_f32_16x16x32_bf16 v[144:147], a[160:163], a[208:211], v[144:147]
    s_add_u32 m0, s65, 24576
    s_mov_b32 s52, 196608
    buffer_load_dwordx4 v36, s[32:35], s52 offen lds
    ds_read_b64_tr_b16 a[144:145], v246 offset:32768
    v_mov_b32 v175, 0
    s_lshl_b32 s48, s3, 1
    v_mfma_f32_16x16x32_bf16 v[160:163], a[160:163], a[212:215], v[160:163]
    ds_read_b64_tr_b16 a[146:147], v246 offset:34816
    s_add_u32 s48, s48, s76
    v_mfma_f32_16x16x32_bf16 v[148:151], a[164:167], a[208:211], v[148:151]
    s_add_u32 m0, s65, 28672
    s_mov_b32 s52, 229376
    buffer_load_dwordx4 v36, s[32:35], s52 offen lds
    ds_read_b64_tr_b16 a[148:149], v247 offset:32768
    s_xor_b32 s49, s48, 2
    s_mul_i32 s48, s48, 4352
    v_mfma_f32_16x16x32_bf16 v[180:183], a[164:167], a[212:215], v[180:183]
    ds_read_b64_tr_b16 a[150:151], v247 offset:34816
    s_mul_i32 s49, s49, 4352
    v_mfma_f32_16x16x32_bf16 v[152:155], a[168:171], a[208:211], v[152:155]
    ds_read_b64_tr_b16 a[152:153], v248 offset:32768
    v_mul_u32_u24 v8, 272, v2
    v_lshl_add_u32 v8, v3, 4, v8
    v_mfma_f32_16x16x32_bf16 v[208:211], a[168:171], a[212:215], v[208:211]
    s_add_u32 m0, s65, 32768
    s_mov_b32 s52, 262144
    buffer_load_dwordx4 v36, s[32:35], s52 offen lds
    ds_read_b64_tr_b16 a[154:155], v248 offset:34816
    v_add_u32 v8, 81920, v8
    v_mfma_f32_16x16x32_bf16 v[156:159], a[172:175], a[208:211], v[156:159]
    ds_read_b64_tr_b16 a[156:157], v249 offset:32768
    v_add_u32 v184, s48, v8
    v_add_u32 v23, s49, v8
    v_mfma_f32_16x16x32_bf16 v[212:215], a[172:175], a[212:215], v[212:215]
    ds_read_b64_tr_b16 a[158:159], v249 offset:34816
    s_mul_i32 s48, s3, 8704
    s_waitcnt lgkmcnt(8)
    s_waitcnt vmcnt(19)
L_h7:
    s_cbranch_execz L_hret
    v_mfma_f32_16x16x32_bf16 v[144:147], a[128:131], a[216:219], v[144:147]
    s_add_u32 m0, s65, 36864
    s_mov_b32 s52, 294912
    buffer_load_dwordx4 v36, s[32:35], s52 offen lds
    ds_read_b64_tr_b16 a[160:161], v246 offset:40960
    s_add_u32 s48, s48, 81920
    v_mul_u32_u24 v8, 272, v6
    v_mfma_f32_16x16x32_bf16 v[160:163], a[128:131], a[220:223], v[160:163]
    ds_read_b64_tr_b16 a[162:163], v246 offset:43008
    v_lshl_add_u32 v8, v7, 5, v8
    v_mfma_f32_16x16x32_bf16 v[148:151], a[132:135], a[216:219], v[148:151]
    s_add_u32 m0, s65, 40960
    s_mov_b32 s52, 327680
    buffer_load_dwordx4 v36, s[32:35], s52 offen lds
    ds_read_b64_tr_b16 a[164:165], v247 offset:40960
    v_add_u32 v39, s48, v8
    v_mfma_f32_16x16x32_bf16 v[180:183], a[132:135], a[220:223], v[180:183]
    ds_read_b64_tr_b16 a[166:167], v247 offset:43008
    s_lshl_b32 s73, s59, 10
    v_mfma_f32_16x16x32_bf16 v[152:155], a[136:139], a[216:219], v[152:155]
    ds_read_b64_tr_b16 a[168:169], v248 offset:40960
    s_lshl_b32 s49, s45, 7
    s_add_u32 s73, s73, s49
    v_mfma_f32_16x16x32_bf16 v[208:211], a[136:139], a[220:223], v[208:211]
    s_add_u32 m0, s65, 45056
    s_mov_b32 s52, 360448
    buffer_load_dwordx4 v36, s[32:35], s52 offen lds
    ds_read_b64_tr_b16 a[170:171], v248 offset:43008
    v_lshlrev_b32 v8, 4, v7
    v_mfma_f32_16x16x32_bf16 v[156:159], a[140:143], a[216:219], v[156:159]
    ds_read_b64_tr_b16 a[172:173], v249 offset:40960
    v_lshl_add_u32 v38, v6, 11, v8
    v_mfma_f32_16x16x32_bf16 v[212:215], a[140:143], a[220:223], v[212:215]
    ds_read_b64_tr_b16 a[174:175], v249 offset:43008
    v_sub_f32 v177, 1.0, v176
    s_waitcnt lgkmcnt(8)
    s_waitcnt vmcnt(20)
    v_mfma_f32_16x16x32_bf16 v[144:147], a[144:147], a[224:227], v[144:147]
    s_add_u32 m0, s65, 49152
    s_mov_b32 s52, 393216
    buffer_load_dwordx4 v36, s[32:35], s52 offen lds
    ds_read_b64_tr_b16 a[128:129], v246 offset:49152
    v_mfma_f32_16x16x32_bf16 v[160:163], a[144:147], a[228:231], v[160:163]
    ds_read_b64_tr_b16 a[130:131], v246 offset:51200
    v_mfma_f32_16x16x32_bf16 v[148:151], a[148:151], a[224:227], v[148:151]
    s_add_u32 m0, s65, 53248
    s_mov_b32 s52, 425984
    buffer_load_dwordx4 v36, s[32:35], s52 offen lds
    ds_read_b64_tr_b16 a[132:133], v247 offset:49152
    v_mfma_f32_16x16x32_bf16 v[180:183], a[148:151], a[228:231], v[180:183]
    ds_read_b64_tr_b16 a[134:135], v247 offset:51200
    v_mfma_f32_16x16x32_bf16 v[152:155], a[152:155], a[224:227], v[152:155]
    ds_read_b64_tr_b16 a[136:137], v248 offset:49152
    v_mfma_f32_16x16x32_bf16 v[208:211], a[152:155], a[228:231], v[208:211]
    s_add_u32 m0, s65, 57344
    s_mov_b32 s52, 458752
    buffer_load_dwordx4 v36, s[32:35], s52 offen lds
    ds_read_b64_tr_b16 a[138:139], v248 offset:51200
    v_mfma_f32_16x16x32_bf16 v[156:159], a[156:159], a[224:227], v[156:159]
    ds_read_b64_tr_b16 a[140:141], v249 offset:49152
    v_mfma_f32_16x16x32_bf16 v[212:215], a[156:159], a[228:231], v[212:215]
    ds_read_b64_tr_b16 a[142:143], v249 offset:51200
    s_waitcnt lgkmcnt(8)
    s_waitcnt vmcnt(21)
    v_mfma_f32_16x16x32_bf16 v[144:147], a[160:163], a[232:235], v[144:147]
    s_add_u32 m0, s65, 61440
    s_mov_b32 s52, 491520
    buffer_load_dwordx4 v36, s[32:35], s52 offen lds
    ds_read_b64_tr_b16 a[144:145], v246 offset:57344
    v_mfma_f32_16x16x32_bf16 v[160:163], a[160:163], a[236:239], v[160:163]
    ds_read_b64_tr_b16 a[146:147], v246 offset:59392
    v_mfma_f32_16x16x32_bf16 v[148:151], a[164:167], a[232:235], v[148:151]
    s_add_u32 m0, s65, 65536
    s_mov_b32 s52, 786432
    buffer_load_dwordx4 v36, s[32:35], s52 offen lds
    ds_read_b64_tr_b16 a[148:149], v247 offset:57344
    v_mfma_f32_16x16x32_bf16 v[180:183], a[164:167], a[236:239], v[180:183]
    ds_read_b64_tr_b16 a[150:151], v247 offset:59392
    v_mfma_f32_16x16x32_bf16 v[152:155], a[168:171], a[232:235], v[152:155]
    ds_read_b64_tr_b16 a[152:153], v248 offset:57344
    v_mfma_f32_16x16x32_bf16 v[208:211], a[168:171], a[236:239], v[208:211]
    s_add_u32 m0, s65, 69632
    s_mov_b32 s52, 819200
    buffer_load_dwordx4 v36, s[32:35], s52 offen lds
    ds_read_b64_tr_b16 a[154:155], v248 offset:59392
    v_mfma_f32_16x16x32_bf16 v[156:159], a[172:175], a[232:235], v[156:159]
    ds_read_b64_tr_b16 a[156:157], v249 offset:57344
    v_mfma_f32_16x16x32_bf16 v[212:215], a[172:175], a[236:239], v[212:215]
    ds_read_b64_tr_b16 a[158:159], v249 offset:59392
    s_waitcnt lgkmcnt(8)
    s_waitcnt vmcnt(22)
    v_mfma_f32_16x16x32_bf16 v[144:147], a[128:131], a[240:243], v[144:147]
    s_mov_b64 exec, 0x3fff3fff
    buffer_load_dword v174, v185, s[20:23], 0 offen sc1
    s_mov_b64 exec, -1
    ds_read_b64_tr_b16 a[160:161], v19 offset:0
    v_mfma_f32_16x16x32_bf16 v[160:163], a[128:131], a[244:247], v[160:163]
    ds_read_b64_tr_b16 a[162:163], v19 offset:2048
    v_mfma_f32_16x16x32_bf16 v[148:151], a[132:135], a[240:243], v[148:151]
    s_add_u32 m0, s65, 73728
    s_mov_b32 s52, 851968
    buffer_load_dwordx4 v36, s[32:35], s52 offen lds
    ds_read_b64_tr_b16 a[164:165], v20 offset:0
    v_mfma_f32_16x16x32_bf16 v[180:183], a[132:135], a[244:247], v[180:183]
    ds_read_b64_tr_b16 a[166:167], v20 offset:2048
    v_mfma_f32_16x16x32_bf16 v[152:155], a[136:139], a[240:243], v[152:155]
    ds_read_b64_tr_b16 a[168:169], v21 offset:0
    v_mfma_f32_16x16x32_bf16 v[208:211], a[136:139], a[244:247], v[208:211]
    s_add_u32 m0, s65, 77824
    s_mov_b32 s52, 884736
    buffer_load_dwordx4 v36, s[32:35], s52 offen lds
    ds_read_b64_tr_b16 a[170:171], v21 offset:2048
    v_mfma_f32_16x16x32_bf16 v[156:159], a[140:143], a[240:243], v[156:159]
    ds_read_b64_tr_b16 a[172:173], v22 offset:0
    v_mfma_f32_16x16x32_bf16 v[212:215], a[140:143], a[244:247], v[212:215]
    ds_read_b64_tr_b16 a[174:175], v22 offset:2048
    s_waitcnt lgkmcnt(8)
    s_waitcnt vmcnt(23)
    v_mfma_f32_16x16x32_bf16 v[144:147], a[144:147], a[248:251], v[144:147]
    ds_read_b64_tr_b16 a[128:129], v19 offset:8192
    v_mfma_f32_16x16x32_bf16 v[160:163], a[144:147], a[252:255], v[160:163]
    ds_read_b64_tr_b16 a[130:131], v19 offset:10240
    v_mfma_f32_16x16x32_bf16 v[148:151], a[148:151], a[248:251], v[148:151]
    ds_read_b64_tr_b16 a[132:133], v20 offset:8192
    v_mfma_f32_16x16x32_bf16 v[180:183], a[148:151], a[252:255], v[180:183]
    ds_read_b64_tr_b16 a[134:135], v20 offset:10240
    v_mfma_f32_16x16x32_bf16 v[152:155], a[152:155], a[248:251], v[152:155]
    ds_read_b64_tr_b16 a[136:137], v21 offset:8192
    v_mfma_f32_16x16x32_bf16 v[208:211], a[152:155], a[252:255], v[208:211]
    ds_read_b64_tr_b16 a[138:139], v21 offset:10240
    v_mfma_f32_16x16x32_bf16 v[156:159], a[156:159], a[248:251], v[156:159]
    ds_read_b64_tr_b16 a[140:141], v22 offset:8192
    v_mfma_f32_16x16x32_bf16 v[212:215], a[156:159], a[252:255], v[212:215]
    ds_read_b64_tr_b16 a[142:143], v22 offset:10240
    s_waitcnt vmcnt(2)
    s_mov_b32 s58, 0x40000
    v_cmp_eq_u32 vcc, -1, v174
    s_nop 4
    s_cbranch_vccz L_upolld
L_upoll:
    s_sleep 6
    s_mov_b64 exec, 0x3fff3fff
    buffer_load_dword v174, v185, s[20:23], 0 offen sc1
    s_mov_b64 exec, -1
    s_waitcnt vmcnt(0)
    v_cmp_eq_u32 vcc, -1, v174
    s_sub_u32 s58, s58, 1
    s_cbranch_scc1 L_upolld
    s_nop 2
    s_cbranch_vccnz L_upoll
L_upolld:
    s_add_u32 s78, s70, 16384
    buffer_load_dwordx4 v[24:27], v204, s[20:23], s78 offen offset:0 sc1
    s_add_u32 s79, s80, 16384
    buffer_load_dwordx4 v[28:31], v204, s[20:23], s79 offen offset:0 sc1
    buffer_load_dwordx4 v[40:43], v204, s[20:23], s78 offen offset:2048 sc1
    buffer_load_dwordx4 v[44:47], v204, s[20:23], s79 offen offset:2048 sc1
    s_add_u32 s78, s70, 20480
    buffer_load_dwordx4 v[48:51], v204, s[20:23], s78 offen offset:0 sc1
    s_add_u32 s79, s80, 20480
    buffer_load_dwordx4 v[52:55], v204, s[20:23], s79 offen offset:0 sc1
    buffer_load_dwordx4 v[56:59], v204, s[20:23], s78 offen offset:2048 sc1
    buffer_load_dwordx4 v[60:63], v204, s[20:23], s79 offen offset:2048 sc1
    s_add_u32 s78, s70, 0
    buffer_load_dwordx4 v[64:67], v204, s[20:23], s78 offen offset:0 sc1
    s_add_u32 s79, s80, 0
    buffer_load_dwordx4 v[68:71], v204, s[20:23], s79 offen offset:0 sc1
    v_pk_mul_f32 v[144:145], v[144:145], v[176:177] op_sel_hi:[1,0]
    v_pk_mul_f32 v[146:147], v[146:147], v[176:177] op_sel_hi:[1,0]
    v_pk_mul_f32 v[148:149], v[148:149], v[176:177] op_sel_hi:[1,0]
    v_pk_mul_f32 v[150:151], v[150:151], v[176:177] op_sel_hi:[1,0]
    v_pk_mul_f32 v[152:153], v[152:153], v[176:177] op_sel_hi:[1,0]
    v_pk_mul_f32 v[154:155], v[154:155], v[176:177] op_sel_hi:[1,0]
    v_pk_mul_f32 v[156:157], v[156:157], v[176:177] op_sel_hi:[1,0]
    v_pk_mul_f32 v[158:159], v[158:159], v[176:177] op_sel_hi:[1,0]
    v_pk_mul_f32 v[160:161], v[160:161], v[178:179] op_sel_hi:[1,0]
    v_pk_mul_f32 v[162:163], v[162:163], v[178:179] op_sel_hi:[1,0]
    v_pk_mul_f32 v[180:181], v[180:181], v[178:179] op_sel_hi:[1,0]
    v_pk_mul_f32 v[182:183], v[182:183], v[178:179] op_sel_hi:[1,0]
    v_pk_mul_f32 v[208:209], v[208:209], v[178:179] op_sel_hi:[1,0]
    v_pk_mul_f32 v[210:211], v[210:211], v[178:179] op_sel_hi:[1,0]
    v_pk_mul_f32 v[212:213], v[212:213], v[178:179] op_sel_hi:[1,0]
    v_pk_mul_f32 v[214:215], v[214:215], v[178:179] op_sel_hi:[1,0]
    s_waitcnt vmcnt(10)
    s_barrier
    s_waitcnt lgkmcnt(8)
    s_waitcnt vmcnt(8)
    v_mfma_f32_16x16x32_bf16 v[216:219], a[160:163], v[24:27], 0
    buffer_load_dwordx4 v[72:75], v204, s[20:23], s78 offen offset:2048 sc1
    ds_read_b64_tr_b16 a[144:145], v19 offset:16384
    v_max3_u32 v10, v24, v25, v26
    v_mfma_f32_16x16x32_bf16 v[232:235], a[160:163], v[28:31], 0
    ds_read_b64_tr_b16 a[146:147], v19 offset:18432
    v_mfma_f32_16x16x32_bf16 v[220:223], a[164:167], v[24:27], 0
    ds_read_b64_tr_b16 a[148:149], v20 offset:16384
    v_max3_u32 v10, v26, v27, v10
    v_mfma_f32_16x16x32_bf16 v[236:239], a[164:167], v[28:31], 0
    ds_read_b64_tr_b16 a[150:151], v20 offset:18432
    v_mfma_f32_16x16x32_bf16 v[224:227], a[168:171], v[24:27], 0
    buffer_load_dwordx4 v[76:79], v204, s[20:23], s79 offen offset:2048 sc1
    ds_read_b64_tr_b16 a[152:153], v21 offset:16384
    v_max3_u32 v10, v28, v29, v10
    v_mfma_f32_16x16x32_bf16 v[240:243], a[168:171], v[28:31], 0
    ds_read_b64_tr_b16 a[154:155], v21 offset:18432
    v_mfma_f32_16x16x32_bf16 v[228:231], a[172:175], v[24:27], 0
    ds_read_b64_tr_b16 a[156:157], v22 offset:16384
    v_max3_u32 v10, v30, v31, v10
    v_mfma_f32_16x16x32_bf16 v[252:255], a[172:175], v[28:31], 0
    ds_read_b64_tr_b16 a[158:159], v22 offset:18432
    s_waitcnt lgkmcnt(8)
    s_waitcnt vmcnt(8)
    v_mfma_f32_16x16x32_bf16 v[216:219], a[128:131], v[40:43], v[216:219]
    s_add_u32 s78, s70, 4096
    buffer_load_dwordx4 v[80:83], v204, s[20:23], s78 offen offset:0 sc1
    ds_read_b64_tr_b16 a[160:161], v19 offset:24576
    v_max3_u32 v10, v40, v41, v10
    v_mfma_f32_16x16x32_bf16 v[232:235], a[128:131], v[44:47], v[232:235]
    ds_read_b64_tr_b16 a[162:163], v19 offset:26624
    v_mfma_f32_16x16x32_bf16 v[220:223], a[132:135], v[40:43], v[220:223]
    ds_read_b64_tr_b16 a[164:165], v20 offset:24576
    v_max3_u32 v10, v42, v43, v10
    v_mfma_f32_16x16x32_bf16 v[236:239], a[132:135], v[44:47], v[236:239]
    ds_read_b64_tr_b16 a[166:167], v20 offset:26624
    v_mfma_f32_16x16x32_bf16 v[224:227], a[136:139], v[40:43], v[224:227]
    s_add_u32 s79, s80, 4096
    buffer_load_dwordx4 v[84:87], v204, s[20:23], s79 offen offset:0 sc1
    ds_read_b64_tr_b16 a[168:169], v21 offset:24576
    v_max3_u32 v10, v44, v45, v10
    v_mfma_f32_16x16x32_bf16 v[240:243], a[136:139], v[44:47], v[240:243]
    ds_read_b64_tr_b16 a[170:171], v21 offset:26624
    v_mfma_f32_16x16x32_bf16 v[228:231], a[140:143], v[40:43], v[228:231]
    ds_read_b64_tr_b16 a[172:173], v22 offset:24576
    v_max3_u32 v10, v46, v47, v10
    v_mfma_f32_16x16x32_bf16 v[252:255], a[140:143], v[44:47], v[252:255]
    ds_read_b64_tr_b16 a[174:175], v22 offset:26624
    s_waitcnt lgkmcnt(8)
    s_waitcnt vmcnt(8)
    v_mfma_f32_16x16x32_bf16 v[216:219], a[144:147], v[48:51], v[216:219]
    buffer_load_dwordx4 v[88:91], v204, s[20:23], s78 offen offset:2048 sc1
    ds_read_b64_tr_b16 a[128:129], v15 offset:0
    v_max3_u32 v10, v48, v49, v10
    v_mfma_f32_16x16x32_bf16 v[232:235], a[144:147], v[52:55], v[232:235]
    ds_read_b64_tr_b16 a[130:131], v15 offset:2048
    v_mfma_f32_16x16x32_bf16 v[220:223], a[148:151], v[48:51], v[220:223]
    ds_read_b64_tr_b16 a[132:133], v16 offset:0
    v_max3_u32 v10, v50, v51, v10
    v_mfma_f32_16x16x32_bf16 v[236:239], a[148:151], v[52:55], v[236:239]
    ds_read_b64_tr_b16 a[134:135], v16 offset:2048
    v_mfma_f32_16x16x32_bf16 v[224:227], a[152:155], v[48:51], v[224:227]
    buffer_load_dwordx4 v[92:95], v204, s[20:23], s79 offen offset:2048 sc1
    ds_read_b64_tr_b16 a[136:137], v17 offset:0
    v_max3_u32 v10, v52, v53, v10
    v_mfma_f32_16x16x32_bf16 v[240:243], a[152:155], v[52:55], v[240:243]
    ds_read_b64_tr_b16 a[138:139], v17 offset:2048
    v_mfma_f32_16x16x32_bf16 v[228:231], a[156:159], v[48:51], v[228:231]
    ds_read_b64_tr_b16 a[140:141], v18 offset:0
    v_max3_u32 v10, v54, v55, v10
    v_mfma_f32_16x16x32_bf16 v[252:255], a[156:159], v[52:55], v[252:255]
    ds_read_b64_tr_b16 a[142:143], v18 offset:2048
    s_waitcnt lgkmcnt(8)
    s_waitcnt vmcnt(8)
    v_mfma_f32_16x16x32_bf16 v[216:219], a[160:163], v[56:59], v[216:219]
    s_add_u32 s78, s70, 8192
    buffer_load_dwordx4 v[96:99], v204, s[20:23], s78 offen offset:0 sc1
    ds_read_b64_tr_b16 a[144:145], v15 offset:8192
    v_max3_u32 v10, v56, v57, v10
    v_mfma_f32_16x16x32_bf16 v[232:235], a[160:163], v[60:63], v[232:235]
    ds_read_b64_tr_b16 a[146:147], v15 offset:10240
    v_mfma_f32_16x16x32_bf16 v[220:223], a[164:167], v[56:59], v[220:223]
    ds_read_b64_tr_b16 a[148:149], v16 offset:8192
    v_max3_u32 v10, v58, v59, v10
    v_mfma_f32_16x16x32_bf16 v[236:239], a[164:167], v[60:63], v[236:239]
    ds_read_b64_tr_b16 a[150:151], v16 offset:10240
    v_mfma_f32_16x16x32_bf16 v[224:227], a[168:171], v[56:59], v[224:227]
    s_add_u32 s79, s80, 8192
    buffer_load_dwordx4 v[100:103], v204, s[20:23], s79 offen offset:0 sc1
    ds_read_b64_tr_b16 a[152:153], v17 offset:8192
    v_max3_u32 v10, v60, v61, v10
    v_mfma_f32_16x16x32_bf16 v[240:243], a[168:171], v[60:63], v[240:243]
    ds_read_b64_tr_b16 a[154:155], v17 offset:10240
    v_mfma_f32_16x16x32_bf16 v[228:231], a[172:175], v[56:59], v[228:231]
    ds_read_b64_tr_b16 a[156:157], v18 offset:8192
    v_max3_u32 v10, v62, v63, v10
    v_mfma_f32_16x16x32_bf16 v[252:255], a[172:175], v[60:63], v[252:255]
    ds_read_b64_tr_b16 a[158:159], v18 offset:10240
    s_waitcnt lgkmcnt(8)
    s_waitcnt vmcnt(8)
    v_mfma_f32_16x16x32_bf16 v[216:219], a[128:131], v[64:67], v[216:219]
    buffer_load_dwordx4 v[104:107], v204, s[20:23], s78 offen offset:2048 sc1
    ds_read_b64_tr_b16 a[160:161], v15 offset:16384
    v_max3_u32 v10, v64, v65, v10
    v_mfma_f32_16x16x32_bf16 v[232:235], a[128:131], v[68:71], v[232:235]
    ds_read_b64_tr_b16 a[162:163], v15 offset:18432
    v_mfma_f32_16x16x32_bf16 v[220:223], a[132:135], v[64:67], v[220:223]
    ds_read_b64_tr_b16 a[164:165], v16 offset:16384
    v_max3_u32 v10, v66, v67, v10
    v_mfma_f32_16x16x32_bf16 v[236:239], a[132:135], v[68:71], v[236:239]
    ds_read_b64_tr_b16 a[166:167], v16 offset:18432
    v_mfma_f32_16x16x32_bf16 v[224:227], a[136:139], v[64:67], v[224:227]
    buffer_load_dwordx4 v[108:111], v204, s[20:23], s79 offen offset:2048 sc1
    ds_read_b64_tr_b16 a[168:169], v17 offset:16384
    v_max3_u32 v10, v68, v69, v10
    v_mfma_f32_16x16x32_bf16 v[240:243], a[136:139], v[68:71], v[240:243]
    ds_read_b64_tr_b16 a[170:171], v17 offset:18432
    v_mfma_f32_16x16x32_bf16 v[228:231], a[140:143], v[64:67], v[228:231]
    ds_read_b64_tr_b16 a[172:173], v18 offset:16384
    v_max3_u32 v10, v70, v71, v10
    v_mfma_f32_16x16x32_bf16 v[252:255], a[140:143], v[68:71], v[252:255]
    ds_read_b64_tr_b16 a[174:175], v18 offset:18432
    s_waitcnt lgkmcnt(8)
    s_waitcnt vmcnt(8)
    v_mfma_f32_16x16x32_bf16 v[216:219], a[144:147], v[72:75], v[216:219]
    s_add_u32 s78, s70, 12288
    buffer_load_dwordx4 v[112:115], v204, s[20:23], s78 offen offset:0 sc1
    ds_read_b64_tr_b16 a[128:129], v15 offset:24576
    v_max3_u32 v10, v72, v73, v10
    v_mfma_f32_16x16x32_bf16 v[232:235], a[144:147], v[76:79], v[232:235]
    ds_read_b64_tr_b16 a[130:131], v15 offset:26624
    v_mfma_f32_16x16x32_bf16 v[220:223], a[148:151], v[72:75], v[220:223]
    ds_read_b64_tr_b16 a[132:133], v16 offset:24576
    v_max3_u32 v10, v74, v75, v10
    v_mfma_f32_16x16x32_bf16 v[236:239], a[148:151], v[76:79], v[236:239]
    ds_read_b64_tr_b16 a[134:135], v16 offset:26624
    v_mfma_f32_16x16x32_bf16 v[224:227], a[152:155], v[72:75], v[224:227]
    s_add_u32 s79, s80, 12288
    buffer_load_dwordx4 v[116:119], v204, s[20:23], s79 offen offset:0 sc1
    ds_read_b64_tr_b16 a[136:137], v17 offset:24576
    v_max3_u32 v10, v76, v77, v10
    v_mfma_f32_16x16x32_bf16 v[240:243], a[152:155], v[76:79], v[240:243]
    ds_read_b64_tr_b16 a[138:139], v17 offset:26624
    v_mfma_f32_16x16x32_bf16 v[228:231], a[156:159], v[72:75], v[228:231]
    ds_read_b64_tr_b16 a[140:141], v18 offset:24576
    v_max3_u32 v10, v78, v79, v10
    v_mfma_f32_16x16x32_bf16 v[252:255], a[156:159], v[76:79], v[252:255]
    ds_read_b64_tr_b16 a[142:143], v18 offset:26624
    s_waitcnt lgkmcnt(8)
    s_waitcnt vmcnt(8)
    v_mfma_f32_16x16x32_bf16 v[216:219], a[160:163], v[80:83], v[216:219]
    buffer_load_dwordx4 v[120:123], v204, s[20:23], s78 offen offset:2048 sc1
    ds_read_b64_tr_b16 a[144:145], v15 offset:32768
    v_max3_u32 v10, v80, v81, v10
    v_mfma_f32_16x16x32_bf16 v[232:235], a[160:163], v[84:87], v[232:235]
    ds_read_b64_tr_b16 a[146:147], v15 offset:34816
    v_mfma_f32_16x16x32_bf16 v[220:223], a[164:167], v[80:83], v[220:223]
    ds_read_b64_tr_b16 a[148:149], v16 offset:32768
    v_max3_u32 v10, v82, v83, v10
    v_mfma_f32_16x16x32_bf16 v[236:239], a[164:167], v[84:87], v[236:239]
    ds_read_b64_tr_b16 a[150:151], v16 offset:34816
    v_mfma_f32_16x16x32_bf16 v[224:227], a[168:171], v[80:83], v[224:227]
    buffer_load_dwordx4 v[124:127], v204, s[20:23], s79 offen offset:2048 sc1
    ds_read_b64_tr_b16 a[152:153], v17 offset:32768
    v_max3_u32 v10, v84, v85, v10
    v_mfma_f32_16x16x32_bf16 v[240:243], a[168:171], v[84:87], v[240:243]
    ds_read_b64_tr_b16 a[154:155], v17 offset:34816
    v_mfma_f32_16x16x32_bf16 v[228:231], a[172:175], v[80:83], v[228:231]
    ds_read_b64_tr_b16 a[156:157], v18 offset:32768
    v_max3_u32 v10, v86, v87, v10
    v_mfma_f32_16x16x32_bf16 v[252:255], a[172:175], v[84:87], v[252:255]
    ds_read_b64_tr_b16 a[158:159], v18 offset:34816
    s_waitcnt lgkmcnt(8)
    s_waitcnt vmcnt(8)
    v_mfma_f32_16x16x32_bf16 v[216:219], a[128:131], v[88:91], v[216:219]
    s_add_u32 s78, s70, 24576
    buffer_load_dwordx4 v[128:131], v204, s[20:23], s78 offen offset:0 sc1
    ds_read_b64_tr_b16 a[160:161], v15 offset:40960
    v_max3_u32 v10, v88, v89, v10
    v_mfma_f32_16x16x32_bf16 v[232:235], a[128:131], v[92:95], v[232:235]
    ds_read_b64_tr_b16 a[162:163], v15 offset:43008
    v_mfma_f32_16x16x32_bf16 v[220:223], a[132:135], v[88:91], v[220:223]
    ds_read_b64_tr_b16 a[164:165], v16 offset:40960
    v_max3_u32 v10, v90, v91, v10
    v_mfma_f32_16x16x32_bf16 v[236:239], a[132:135], v[92:95], v[236:239]
    ds_read_b64_tr_b16 a[166:167], v16 offset:43008
    v_mfma_f32_16x16x32_bf16 v[224:227], a[136:139], v[88:91], v[224:227]
    s_add_u32 s79, s80, 24576
    buffer_load_dwordx4 v[132:135], v204, s[20:23], s79 offen offset:0 sc1
    ds_read_b64_tr_b16 a[168:169], v17 offset:40960
    v_max3_u32 v10, v92, v93, v10
    v_mfma_f32_16x16x32_bf16 v[240:243], a[136:139], v[92:95], v[240:243]
    ds_read_b64_tr_b16 a[170:171], v17 offset:43008
    v_mfma_f32_16x16x32_bf16 v[228:231], a[140:143], v[88:91], v[228:231]
    ds_read_b64_tr_b16 a[172:173], v18 offset:40960
    v_max3_u32 v10, v94, v95, v10
    v_mfma_f32_16x16x32_bf16 v[252:255], a[140:143], v[92:95], v[252:255]
    ds_read_b64_tr_b16 a[174:175], v18 offset:43008
    s_waitcnt lgkmcnt(8)
    s_waitcnt vmcnt(8)
    v_mfma_f32_16x16x32_bf16 v[216:219], a[144:147], v[96:99], v[216:219]
    buffer_load_dwordx4 v[136:139], v204, s[20:23], s78 offen offset:2048 sc1
    ds_read_b64_tr_b16 a[128:129], v15 offset:49152
    v_max3_u32 v10, v96, v97, v10
    v_mfma_f32_16x16x32_bf16 v[232:235], a[144:147], v[100:103], v[232:235]
    ds_read_b64_tr_b16 a[130:131], v15 offset:51200
    v_mfma_f32_16x16x32_bf16 v[220:223], a[148:151], v[96:99], v[220:223]
    ds_read_b64_tr_b16 a[132:133], v16 offset:49152
    v_max3_u32 v10, v98, v99, v10
    v_mfma_f32_16x16x32_bf16 v[236:239], a[148:151], v[100:103], v[236:239]
    ds_read_b64_tr_b16 a[134:135], v16 offset:51200
    v_mfma_f32_16x16x32_bf16 v[224:227], a[152:155], v[96:99], v[224:227]
    buffer_load_dwordx4 v[140:143], v204, s[20:23], s79 offen offset:2048 sc1
    ds_read_b64_tr_b16 a[136:137], v17 offset:49152
    v_max3_u32 v10, v100, v101, v10
    v_mfma_f32_16x16x32_bf16 v[240:243], a[152:155], v[100:103], v[240:243]
    ds_read_b64_tr_b16 a[138:139], v17 offset:51200
    v_mfma_f32_16x16x32_bf16 v[228:231], a[156:159], v[96:99], v[228:231]
    ds_read_b64_tr_b16 a[140:141], v18 offset:49152
    v_max3_u32 v10, v102, v103, v10
    v_mfma_f32_16x16x32_bf16 v[252:255], a[156:159], v[100:103], v[252:255]
    ds_read_b64_tr_b16 a[142:143], v18 offset:51200
    s_waitcnt lgkmcnt(8)
    s_waitcnt vmcnt(8)
    v_mfma_f32_16x16x32_bf16 v[216:219], a[160:163], v[104:107], v[216:219]
    ds_read_b64_tr_b16 a[144:145], v15 offset:57344
    v_max3_u32 v10, v104, v105, v10
    v_mfma_f32_16x16x32_bf16 v[232:235], a[160:163], v[108:111], v[232:235]
    ds_read_b64_tr_b16 a[146:147], v15 offset:59392
    v_mfma_f32_16x16x32_bf16 v[220:223], a[164:167], v[104:107], v[220:223]
    ds_read_b64_tr_b16 a[148:149], v16 offset:57344
    v_max3_u32 v10, v106, v107, v10
    v_mfma_f32_16x16x32_bf16 v[236:239], a[164:167], v[108:111], v[236:239]
    ds_read_b64_tr_b16 a[150:151], v16 offset:59392
    v_mfma_f32_16x16x32_bf16 v[224:227], a[168:171], v[104:107], v[224:227]
    ds_read_b64_tr_b16 a[152:153], v17 offset:57344
    v_max3_u32 v10, v108, v109, v10
    v_mfma_f32_16x16x32_bf16 v[240:243], a[168:171], v[108:111], v[240:243]
    ds_read_b64_tr_b16 a[154:155], v17 offset:59392
    v_mfma_f32_16x16x32_bf16 v[228:231], a[172:175], v[104:107], v[228:231]
    ds_read_b64_tr_b16 a[156:157], v18 offset:57344
    v_max3_u32 v10, v110, v111, v10
    v_mfma_f32_16x16x32_bf16 v[252:255], a[172:175], v[108:111], v[252:255]
    ds_read_b64_tr_b16 a[158:159], v18 offset:59392
    s_waitcnt lgkmcnt(8)
    s_waitcnt vmcnt(6)
    v_mfma_f32_16x16x32_bf16 v[216:219], a[128:131], v[112:115], v[216:219]
    ds_read_b64_tr_b16 a[160:161], v246 offset:0
    v_max3_u32 v10, v112, v113, v10
    v_mfma_f32_16x16x32_bf16 v[232:235], a[128:131], v[116:119], v[232:235]
    ds_read_b64_tr_b16 a[162:163], v246 offset:2048
    v_mfma_f32_16x16x32_bf16 v[220:223], a[132:135], v[112:115], v[220:223]
    ds_read_b64_tr_b16 a[164:165], v247 offset:0
    v_max3_u32 v10, v114, v115, v10
    v_mfma_f32_16x16x32_bf16 v[236:239], a[132:135], v[116:119], v[236:239]
    ds_read_b64_tr_b16 a[166:167], v247 offset:2048
    v_mfma_f32_16x16x32_bf16 v[224:227], a[136:139], v[112:115], v[224:227]
    ds_read_b64_tr_b16 a[168:169], v248 offset:0
    v_max3_u32 v10, v116, v117, v10
    v_mfma_f32_16x16x32_bf16 v[240:243], a[136:139], v[116:119], v[240:243]
    ds_read_b64_tr_b16 a[170:171], v248 offset:2048
    v_mfma_f32_16x16x32_bf16 v[228:231], a[140:143], v[112:115], v[228:231]
    ds_read_b64_tr_b16 a[172:173], v249 offset:0
    v_max3_u32 v10, v118, v119, v10
    v_mfma_f32_16x16x32_bf16 v[252:255], a[140:143], v[116:119], v[252:255]
    ds_read_b64_tr_b16 a[174:175], v249 offset:2048
    s_waitcnt lgkmcnt(8)
    s_waitcnt vmcnt(4)
    v_mfma_f32_16x16x32_bf16 v[216:219], a[144:147], v[120:123], v[216:219]
    ds_read_b64_tr_b16 a[128:129], v246 offset:8192
    v_max3_u32 v10, v120, v121, v10
    v_mfma_f32_16x16x32_bf16 v[232:235], a[144:147], v[124:127], v[232:235]
    ds_read_b64_tr_b16 a[130:131], v246 offset:10240
    v_mfma_f32_16x16x32_bf16 v[220:223], a[148:151], v[120:123], v[220:223]
    ds_read_b64_tr_b16 a[132:133], v247 offset:8192
    v_max3_u32 v10, v122, v123, v10
    v_mfma_f32_16x16x32_bf16 v[236:239], a[148:151], v[124:127], v[236:239]
    ds_read_b64_tr_b16 a[134:135], v247 offset:10240
    v_mfma_f32_16x16x32_bf16 v[224:227], a[152:155], v[120:123], v[224:227]
    ds_read_b64_tr_b16 a[136:137], v248 offset:8192
    v_max3_u32 v10, v124, v125, v10
    v_mfma_f32_16x16x32_bf16 v[240:243], a[152:155], v[124:127], v[240:243]
    ds_read_b64_tr_b16 a[138:139], v248 offset:10240
    v_mfma_f32_16x16x32_bf16 v[228:231], a[156:159], v[120:123], v[228:231]
    ds_read_b64_tr_b16 a[140:141], v249 offset:8192
    v_max3_u32 v10, v126, v127, v10
    v_mfma_f32_16x16x32_bf16 v[252:255], a[156:159], v[124:127], v[252:255]
    ds_read_b64_tr_b16 a[142:143], v249 offset:10240
    s_waitcnt lgkmcnt(8)
    s_waitcnt vmcnt(2)
    v_mfma_f32_16x16x32_bf16 v[216:219], a[160:163], v[128:131], v[216:219]
    v_max3_u32 v10, v128, v129, v10
    v_mfma_f32_16x16x32_bf16 v[232:235], a[160:163], v[132:135], v[232:235]
    v_mfma_f32_16x16x32_bf16 v[220:223], a[164:167], v[128:131], v[220:223]
    v_max3_u32 v10, v130, v131, v10
    v_mfma_f32_16x16x32_bf16 v[236:239], a[164:167], v[132:135], v[236:239]
    v_mfma_f32_16x16x32_bf16 v[224:227], a[168:171], v[128:131], v[224:227]
    v_max3_u32 v10, v132, v133, v10
    v_mfma_f32_16x16x32_bf16 v[240:243], a[168:171], v[132:135], v[240:243]
    v_mfma_f32_16x16x32_bf16 v[228:231], a[172:175], v[128:131], v[228:231]
    v_max3_u32 v10, v134, v135, v10
    v_mfma_f32_16x16x32_bf16 v[252:255], a[172:175], v[132:135], v[252:255]
    s_waitcnt lgkmcnt(0)
    s_waitcnt vmcnt(0)
    v_mfma_f32_16x16x32_bf16 v[232:235], a[128:131], v[140:143], v[232:235]
    v_max3_u32 v10, v136, v137, v10
    v_mfma_f32_16x16x32_bf16 v[236:239], a[132:135], v[140:143], v[236:239]
    v_mfma_f32_16x16x32_bf16 v[240:243], a[136:139], v[140:143], v[240:243]
    v_max3_u32 v10, v138, v139, v10
    v_mfma_f32_16x16x32_bf16 v[252:255], a[140:143], v[140:143], v[252:255]
    v_mfma_f32_16x16x32_bf16 v[216:219], a[128:131], v[136:139], v[216:219]
    v_max3_u32 v10, v140, v141, v10
    v_mfma_f32_16x16x32_bf16 v[220:223], a[132:135], v[136:139], v[220:223]
    v_mfma_f32_16x16x32_bf16 v[224:227], a[136:139], v[136:139], v[224:227]
    v_max3_u32 v10, v142, v143, v10
    v_mfma_f32_16x16x32_bf16 v[228:231], a[140:143], v[136:139], v[228:231]
    v_cmp_eq_u32 vcc, -1, v10
    s_movk_i32 s58, 4096
    s_nop 3
    s_cbranch_vccnz L_redo
L_fok:
    s_nop 5
    v_pk_fma_f32 v[160:161], v[232:233], v[178:179], v[160:161] op_sel:[0,1,0] op_sel_hi:[1,1,1]
    v_pk_fma_f32 v[162:163], v[234:235], v[178:179], v[162:163] op_sel:[0,1,0] op_sel_hi:[1,1,1]
    ds_write_b128 v23, v[160:163] offset:0
    v_pk_fma_f32 v[180:181], v[236:237], v[178:179], v[180:181] op_sel:[0,1,0] op_sel_hi:[1,1,1]
    v_pk_fma_f32 v[182:183], v[238:239], v[178:179], v[182:183] op_sel:[0,1,0] op_sel_hi:[1,1,1]
    ds_write_b128 v23, v[180:183] offset:64
    v_pk_fma_f32 v[208:209], v[240:241], v[178:179], v[208:209] op_sel:[0,1,0] op_sel_hi:[1,1,1]
    v_pk_fma_f32 v[210:211], v[242:243], v[178:179], v[210:211] op_sel:[0,1,0] op_sel_hi:[1,1,1]
    ds_write_b128 v23, v[208:211] offset:128
    v_pk_fma_f32 v[212:213], v[252:253], v[178:179], v[212:213] op_sel:[0,1,0] op_sel_hi:[1,1,1]
    v_pk_fma_f32 v[214:215], v[254:255], v[178:179], v[214:215] op_sel:[0,1,0] op_sel_hi:[1,1,1]
    ds_write_b128 v23, v[212:215] offset:192
    v_pk_fma_f32 v[144:145], v[216:217], v[176:177], v[144:145] op_sel:[0,1,0] op_sel_hi:[1,1,1]
    v_pk_fma_f32 v[146:147], v[218:219], v[176:177], v[146:147] op_sel:[0,1,0] op_sel_hi:[1,1,1]
    ds_write_b128 v184, v[144:147] offset:0
    v_pk_fma_f32 v[148:149], v[220:221], v[176:177], v[148:149] op_sel:[0,1,0] op_sel_hi:[1,1,1]
    v_pk_fma_f32 v[150:151], v[222:223], v[176:177], v[150:151] op_sel:[0,1,0] op_sel_hi:[1,1,1]
    ds_write_b128 v184, v[148:151] offset:64
    v_pk_fma_f32 v[152:153], v[224:225], v[176:177], v[152:153] op_sel:[0,1,0] op_sel_hi:[1,1,1]
    v_pk_fma_f32 v[154:155], v[226:227], v[176:177], v[154:155] op_sel:[0,1,0] op_sel_hi:[1,1,1]
    ds_write_b128 v184, v[152:155] offset:128
    v_pk_fma_f32 v[156:157], v[228:229], v[176:177], v[156:157] op_sel:[0,1,0] op_sel_hi:[1,1,1]
    v_pk_fma_f32 v[158:159], v[230:231], v[176:177], v[158:159] op_sel:[0,1,0] op_sel_hi:[1,1,1]
    ds_write_b128 v184, v[156:159] offset:192
    s_waitcnt lgkmcnt(0)
    s_barrier
    ds_read_b128 v[216:219], v39 offset:0
    ds_read_b128 v[220:223], v39 offset:16
    ds_read_b128 v[232:235], v39 offset:4352
    ds_read_b128 v[236:239], v39 offset:4368
    ds_read_b128 v[224:227], v39 offset:2176
    ds_read_b128 v[228:231], v39 offset:2192
    ds_read_b128 v[240:243], v39 offset:6528
    ds_read_b128 v[252:255], v39 offset:6544
    s_waitcnt lgkmcnt(4)
    v_pk_add_f32 v[216:217], v[216:217], v[232:233]
    v_pk_add_f32 v[218:219], v[218:219], v[234:235]
    v_pk_add_f32 v[220:221], v[220:221], v[236:237]
    v_pk_add_f32 v[222:223], v[222:223], v[238:239]
L_h8:
    s_cbranch_execz L_hret
    v_cvt_pk_bf16_f32 v188, v216, v217
    v_cvt_pk_bf16_f32 v189, v218, v219
    v_cvt_pk_bf16_f32 v190, v220, v221
    v_cvt_pk_bf16_f32 v191, v222, v223
    buffer_store_dwordx4 v[188:191], v38, s[40:43], s73 offen sc1
    s_waitcnt lgkmcnt(0)
    v_pk_add_f32 v[224:225], v[224:225], v[240:241]
    v_pk_add_f32 v[226:227], v[226:227], v[242:243]
    v_pk_add_f32 v[228:229], v[228:229], v[252:253]
    v_pk_add_f32 v[230:231], v[230:231], v[254:255]
    v_cvt_pk_bf16_f32 v192, v224, v225
    v_cvt_pk_bf16_f32 v193, v226, v227
    v_cvt_pk_bf16_f32 v194, v228, v229
    v_cvt_pk_bf16_f32 v195, v230, v231
    s_add_u32 s73, s73, 16384
    buffer_store_dwordx4 v[192:195], v38, s[40:43], s73 offen sc1
    s_or_b32 s48, s2, s3
    s_cmp_lg_u32 s48, 0
    s_cbranch_scc1 L_nobump
    s_mov_b32 s58, 0x40000
L_poll6:
    v_cmp_ne_u64 vcc, s[56:57], v[12:13]
    s_nop 4
    s_cbranch_vccz L_polld6
    s_sub_u32 s58, s58, 1
    s_cbranch_scc1 L_polld6
    s_sleep 8
    buffer_load_dwordx2 v[12:13], v14, s[20:23], s72 offen sc1
    s_waitcnt vmcnt(0)
    s_branch L_poll6
L_polld6:
    v_mov_b32 v35, 0
    s_mov_b64 exec, 1
    buffer_store_dwordx2 v[172:173], v35, s[20:23], 0 offen
    s_mov_b64 exec, -1
L_nobump:
L_end:
    s_endpgm
L_ghost:
    s_nop 3
    s_and_b32 s48, s2, 7
    s_lshl_b32 s48, s48, 2
    s_and_b32 s49, s53, 3
    s_add_u32 s48, s48, s49
    s_lshl_b32 s48, s48, 18
    s_lshl_b32 s50, s3, 16
    s_add_u32 s48, s48, s50
    v_lshlrev_b32 v8, 12, v6
    v_lshl_add_u32 v8, v7, 7, v8
    v_add_u32 v35, s48, v8
    s_lshl_b32 s48, s49, 2
    s_add_u32 s73, s48, s3
    s_and_b32 s49, s2, 1
    s_lshl_b32 s49, s49, 9
    v_lshrrev_b32 v8, 2, v1
    v_lshlrev_b32 v8, 10, v8
    v_lshl_add_u32 v8, v5, 7, v8
    v_add_u32 v39, s49, v8
    s_add_u32 s51, s47, 2
    s_and_b32 s51, s51, 7
    s_add_u32 m0, s62, 16384
    s_lshl_b32 s51, s51, 7
    buffer_load_dwordx4 v12, s[4:7], s51 offen offset:0 lds
    buffer_load_dwordx4 v13, s[4:7], s51 offen offset:1024 lds
    s_add_u32 s51, s47, 3
    s_and_b32 s51, s51, 7
    s_add_u32 m0, s62, 24576
    s_lshl_b32 s51, s51, 7
    buffer_load_dwordx4 v12, s[4:7], s51 offen offset:0 lds
    buffer_load_dwordx4 v13, s[4:7], s51 offen offset:1024 lds
    s_add_u32 s51, s47, 4
    s_and_b32 s51, s51, 7
    s_add_u32 m0, s62, 32768
    s_lshl_b32 s51, s51, 7
    buffer_load_dwordx4 v12, s[4:7], s51 offen offset:0 lds
    buffer_load_dwordx4 v13, s[4:7], s51 offen offset:1024 lds
    s_add_u32 s51, s47, 5
    s_and_b32 s51, s51, 7
    s_add_u32 m0, s62, 40960
    s_lshl_b32 s51, s51, 7
    buffer_load_dwordx4 v12, s[4:7], s51 offen offset:0 lds
    buffer_load_dwordx4 v13, s[4:7], s51 offen offset:1024 lds
    s_add_u32 s51, s47, 6
    s_and_b32 s51, s51, 7
    s_add_u32 m0, s62, 49152
    s_lshl_b32 s51, s51, 7
    buffer_load_dwordx4 v12, s[4:7], s51 offen offset:0 lds
    buffer_load_dwordx4 v13, s[4:7], s51 offen offset:1024 lds
    s_add_u32 s51, s47, 7
    s_and_b32 s51, s51, 7
    s_add_u32 m0, s62, 57344
    s_lshl_b32 s51, s51, 7
    buffer_load_dwordx4 v12, s[4:7], s51 offen offset:0 lds
    buffer_load_dwordx4 v13, s[4:7], s51 offen offset:1024 lds
    s_mov_b32 s51, 0
    buffer_load_dword v11, v35, s[24:27], s51 offen
    s_mov_b32 s51, 32768
    buffer_load_dword v11, v35, s[24:27], s51 offen
    s_waitcnt vmcnt(2)
    s_barrier
    ds_read_b128 a[24:27], v25 offset:0
    ds_read_b128 a[28:31], v33 offset:0
    ds_read_b128 a[56:59], v26 offset:0
    ds_read_b128 a[60:63], v33 offset:64
    s_waitcnt lgkmcnt(0)
    v_mfma_f32_16x16x32_bf16 v[104:107], a[28:31], a[24:27], 0
    ds_read_b128 a[88:91], v25 offset:8192
    ds_read_b128 a[92:95], v33 offset:128
    v_mfma_f32_16x16x32_bf16 v[104:107], a[60:63], a[56:59], v[104:107]
    ds_read_b128 a[120:123], v26 offset:8192
    ds_read_b128 a[124:127], v33 offset:192
    s_waitcnt lgkmcnt(0)
    v_mfma_f32_16x16x32_bf16 v[104:107], a[92:95], a[88:91], v[104:107]
    ds_read_b128 a[24:27], v25 offset:16384
    ds_read_b128 a[28:31], v33 offset:256
    v_mfma_f32_16x16x32_bf16 v[104:107], a[124:127], a[120:123], v[104:107]
    ds_read_b128 a[56:59], v26 offset:16384
    ds_read_b128 a[60:63], v33 offset:320
    s_waitcnt lgkmcnt(0)
    v_mfma_f32_16x16x32_bf16 v[104:107], a[28:31], a[24:27], v[104:107]
    ds_read_b128 a[88:91], v25 offset:24576
    ds_read_b128 a[92:95], v33 offset:384
    v_mfma_f32_16x16x32_bf16 v[104:107], a[60:63], a[56:59], v[104:107]
    ds_read_b128 a[120:123], v26 offset:24576
    ds_read_b128 a[124:127], v33 offset:448
    s_waitcnt lgkmcnt(0)
    v_mfma_f32_16x16x32_bf16 v[104:107], a[92:95], a[88:91], v[104:107]
    ds_read_b128 a[24:27], v25 offset:32768
    ds_read_b128 a[28:31], v33 offset:512
    v_mfma_f32_16x16x32_bf16 v[104:107], a[124:127], a[120:123], v[104:107]
    ds_read_b128 a[56:59], v26 offset:32768
    ds_read_b128 a[60:63], v33 offset:576
    s_waitcnt lgkmcnt(0)
    v_mfma_f32_16x16x32_bf16 v[104:107], a[28:31], a[24:27], v[104:107]
    ds_read_b128 a[88:91], v25 offset:40960
    ds_read_b128 a[92:95], v33 offset:640
    v_mfma_f32_16x16x32_bf16 v[104:107], a[60:63], a[56:59], v[104:107]
    ds_read_b128 a[120:123], v26 offset:40960
    ds_read_b128 a[124:127], v33 offset:704
    s_waitcnt lgkmcnt(0)
    v_mfma_f32_16x16x32_bf16 v[104:107], a[92:95], a[88:91], v[104:107]
    ds_read_b128 a[24:27], v25 offset:49152
    ds_read_b128 a[28:31], v33 offset:768
    v_mfma_f32_16x16x32_bf16 v[104:107], a[124:127], a[120:123], v[104:107]
    ds_read_b128 a[56:59], v26 offset:49152
    ds_read_b128 a[60:63], v33 offset:832
    s_waitcnt lgkmcnt(0)
    v_mfma_f32_16x16x32_bf16 v[104:107], a[28:31], a[24:27], v[104:107]
    ds_read_b128 a[88:91], v25 offset:57344
    ds_read_b128 a[92:95], v33 offset:896
    v_mfma_f32_16x16x32_bf16 v[104:107], a[60:63], a[56:59], v[104:107]
    ds_read_b128 a[120:123], v26 offset:57344
    ds_read_b128 a[124:127], v33 offset:960
    s_waitcnt lgkmcnt(0)
    v_mfma_f32_16x16x32_bf16 v[104:107], a[92:95], a[88:91], v[104:107]
    v_mfma_f32_16x16x32_bf16 v[104:107], a[124:127], a[120:123], v[104:107]
    s_mov_b32 s51, 1024
    buffer_load_dword v11, v35, s[24:27], s51 offen
    s_mov_b32 s51, 33792
    buffer_load_dword v11, v35, s[24:27], s51 offen
    s_add_u32 s51, s47, 0
    s_and_b32 s51, s51, 7
    s_add_u32 m0, s64, 94208
    s_mul_i32 s52, s51, 196608
    buffer_load_dwordx4 v20, s[12:15], s52 offen offset:0 lds
    buffer_load_dwordx4 v20, s[12:15], s52 offen offset:1024 lds
    buffer_load_dwordx4 v20, s[12:15], s52 offen offset:2048 lds
    s_add_u32 m0, s64, 97280
    s_nop 0
    buffer_load_dwordx4 v21, s[12:15], s52 offen offset:0 lds
    buffer_load_dwordx4 v21, s[12:15], s52 offen offset:1024 lds
    buffer_load_dwordx4 v21, s[12:15], s52 offen offset:2048 lds
    s_add_u32 m0, s65, 118784
    s_add_u32 s51, s66, 0
    s_and_b32 s51, s51, 7
    s_lshl_b32 s51, s51, 7
    buffer_load_dwordx4 v22, s[4:7], s51 offen offset:0 lds
    s_add_u32 s51, s47, 1
    s_and_b32 s51, s51, 7
    s_add_u32 m0, s64, 122880
    s_mul_i32 s52, s51, 196608
    buffer_load_dwordx4 v20, s[12:15], s52 offen offset:0 lds
    buffer_load_dwordx4 v20, s[12:15], s52 offen offset:1024 lds
    buffer_load_dwordx4 v20, s[12:15], s52 offen offset:2048 lds
    s_add_u32 m0, s64, 125952
    s_nop 0
    buffer_load_dwordx4 v21, s[12:15], s52 offen offset:0 lds
    buffer_load_dwordx4 v21, s[12:15], s52 offen offset:1024 lds
    buffer_load_dwordx4 v21, s[12:15], s52 offen offset:2048 lds
    s_add_u32 s51, s47, 2
    s_and_b32 s51, s51, 7
    s_add_u32 m0, s64, 65536
    s_mul_i32 s52, s51, 196608
    buffer_load_dwordx4 v20, s[12:15], s52 offen offset:0 lds
    buffer_load_dwordx4 v20, s[12:15], s52 offen offset:1024 lds
    buffer_load_dwordx4 v20, s[12:15], s52 offen offset:2048 lds
    s_add_u32 m0, s64, 68608
    s_nop 0
    buffer_load_dwordx4 v21, s[12:15], s52 offen offset:0 lds
    buffer_load_dwordx4 v21, s[12:15], s52 offen offset:1024 lds
    buffer_load_dwordx4 v21, s[12:15], s52 offen offset:2048 lds
    s_add_u32 m0, s65, 90112
    s_add_u32 s51, s66, 2
    s_and_b32 s51, s51, 7
    s_lshl_b32 s51, s51, 7
    buffer_load_dwordx4 v22, s[4:7], s51 offen offset:0 lds
    s_waitcnt vmcnt(13)
    s_barrier
    ds_read_b64_tr_b16 a[20:21], v31 offset:28672
    ds_read_b64_tr_b16 a[22:23], v31 offset:29184
    ds_read_b64_tr_b16 a[24:25], v31 offset:29696
    ds_read_b64_tr_b16 a[26:27], v31 offset:30208
    ds_read_b64_tr_b16 a[28:29], v31 offset:30720
    ds_read_b64_tr_b16 a[30:31], v31 offset:31232
    ds_read_b128 a[0:3], v14 offset:0
    ds_read_b128 a[4:7], v14 offset:2048
    ds_read_b128 a[8:11], v14 offset:4096
    ds_read_b128 a[12:15], v14 offset:6144
    ds_read_b128 a[16:19], v27 offset:28672
    ds_read_b64_tr_b16 a[52:53], v31 offset:40960
    ds_read_b64_tr_b16 a[54:55], v31 offset:41472
    ds_read_b64_tr_b16 a[56:57], v31 offset:41984
    ds_read_b64_tr_b16 a[58:59], v31 offset:42496
    ds_read_b64_tr_b16 a[60:61], v31 offset:43008
    ds_read_b64_tr_b16 a[62:63], v31 offset:43520
    ds_read_b128 a[32:35], v15 offset:0
    ds_read_b128 a[36:39], v15 offset:2048
    ds_read_b128 a[40:43], v15 offset:4096
    ds_read_b128 a[44:47], v15 offset:6144
    ds_read_b128 a[48:51], v28 offset:28672
    s_add_u32 s56, s56, 0x7f4a7c15
    s_addc_u32 s57, s57, 0x9e3779b9
    v_mov_b32 v172, s56
    v_mov_b32 v173, s57
    v_mov_b32 v72, -1
    v_mov_b32 v73, -1
    v_mov_b32 v74, -1
    v_mov_b32 v75, -1
    s_mul_i32 s78, s3, 28672
    s_add_u32 s78, s78, s70
    s_waitcnt lgkmcnt(0)
    s_waitcnt vmcnt(7)
    s_barrier
    v_mfma_f32_16x16x32_bf16 v[108:111], a[20:23], a[0:3], 0
    s_add_u32 s51, s47, 3
    s_and_b32 s51, s51, 7
    s_add_u32 m0, s64, 94208
    s_mul_i32 s52, s51, 196608
    buffer_load_dwordx4 v20, s[12:15], s52 offen offset:0 lds
    ds_read_b64_tr_b16 a[84:85], v32 offset:0
    v_mfma_f32_16x16x32_bf16 v[124:127], a[24:27], a[0:3], 0
    ds_read_b64_tr_b16 a[86:87], v32 offset:512
    ds_read_b64_tr_b16 a[88:89], v32 offset:1024
    v_mfma_f32_16x16x32_bf16 v[144:147], a[0:3], a[28:31], 0
    ds_read_b64_tr_b16 a[90:91], v32 offset:1536
    ds_read_b64_tr_b16 a[92:93], v32 offset:2048
    v_mfma_f32_16x16x32_bf16 v[112:115], a[20:23], a[4:7], 0
    ds_read_b64_tr_b16 a[94:95], v32 offset:2560
    ds_read_b128 a[64:67], v14 offset:8192
    v_mfma_f32_16x16x32_bf16 v[128:131], a[24:27], a[4:7], 0
    ds_read_b128 a[68:71], v14 offset:10240
    ds_read_b128 a[72:75], v14 offset:12288
    v_mfma_f32_16x16x32_bf16 v[148:151], a[4:7], a[28:31], 0
    buffer_load_dwordx4 v20, s[12:15], s52 offen offset:1024 lds
    ds_read_b128 a[76:79], v14 offset:14336
    v_mfma_f32_16x16x32_bf16 v[116:119], a[20:23], a[8:11], 0
    ds_read_b128 a[80:83], v27 offset:30720
    ds_read_b64_tr_b16 a[116:117], v32 offset:12288
    v_mfma_f32_16x16x32_bf16 v[132:135], a[24:27], a[8:11], 0
    ds_read_b64_tr_b16 a[118:119], v32 offset:12800
    ds_read_b64_tr_b16 a[120:121], v32 offset:13312
    v_mfma_f32_16x16x32_bf16 v[152:155], a[8:11], a[28:31], 0
    ds_read_b64_tr_b16 a[122:123], v32 offset:13824
    ds_read_b64_tr_b16 a[124:125], v32 offset:14336
    v_mfma_f32_16x16x32_bf16 v[120:123], a[20:23], a[12:15], 0
    ds_read_b64_tr_b16 a[126:127], v32 offset:14848
    ds_read_b128 a[96:99], v15 offset:8192
    v_mfma_f32_16x16x32_bf16 v[136:139], a[24:27], a[12:15], 0
    buffer_load_dwordx4 v20, s[12:15], s52 offen offset:2048 lds
    s_add_u32 m0, s64, 97280
    ds_read_b128 a[100:103], v15 offset:10240
    v_mfma_f32_16x16x32_bf16 v[156:159], a[12:15], a[28:31], 0
    ds_read_b128 a[104:107], v15 offset:12288
    ds_read_b128 a[108:111], v15 offset:14336
    v_mfma_f32_16x16x32_bf16 v[140:143], a[24:27], a[16:19], 0
    ds_read_b128 a[112:115], v28 offset:30720
    v_mfma_f32_16x16x32_bf16 v[160:163], a[16:19], a[28:31], 0
    v_mfma_f32_16x16x32_bf16 v[108:111], a[52:55], a[32:35], v[108:111]
    buffer_load_dwordx4 v21, s[12:15], s52 offen offset:0 lds
    v_mfma_f32_16x16x32_bf16 v[124:127], a[56:59], a[32:35], v[124:127]
    v_mfma_f32_16x16x32_bf16 v[144:147], a[32:35], a[60:63], v[144:147]
    v_mfma_f32_16x16x32_bf16 v[112:115], a[52:55], a[36:39], v[112:115]
    v_mfma_f32_16x16x32_bf16 v[128:131], a[56:59], a[36:39], v[128:131]
    v_mfma_f32_16x16x32_bf16 v[148:151], a[36:39], a[60:63], v[148:151]
    buffer_load_dwordx4 v21, s[12:15], s52 offen offset:1024 lds
    v_mfma_f32_16x16x32_bf16 v[116:119], a[52:55], a[40:43], v[116:119]
    v_mfma_f32_16x16x32_bf16 v[132:135], a[56:59], a[40:43], v[132:135]
    v_mfma_f32_16x16x32_bf16 v[152:155], a[40:43], a[60:63], v[152:155]
    v_mfma_f32_16x16x32_bf16 v[120:123], a[52:55], a[44:47], v[120:123]
    v_mfma_f32_16x16x32_bf16 v[136:139], a[56:59], a[44:47], v[136:139]
    buffer_load_dwordx4 v21, s[12:15], s52 offen offset:2048 lds
    v_mfma_f32_16x16x32_bf16 v[156:159], a[44:47], a[60:63], v[156:159]
    v_mfma_f32_16x16x32_bf16 v[140:143], a[56:59], a[48:51], v[140:143]
    v_mfma_f32_16x16x32_bf16 v[160:163], a[48:51], a[60:63], v[160:163]
    s_waitcnt lgkmcnt(0)
    s_waitcnt vmcnt(6)
    s_barrier
    v_mfma_f32_16x16x32_bf16 v[108:111], a[84:87], a[64:67], v[108:111]
    s_add_u32 s51, s47, 4
    s_and_b32 s51, s51, 7
    s_add_u32 m0, s64, 122880
    s_mul_i32 s52, s51, 196608
    buffer_load_dwordx4 v20, s[12:15], s52 offen offset:0 lds
    ds_read_b64_tr_b16 a[20:21], v31 offset:0
    v_mfma_f32_16x16x32_bf16 v[124:127], a[88:91], a[64:67], v[124:127]
    ds_read_b64_tr_b16 a[22:23], v31 offset:512
    ds_read_b64_tr_b16 a[24:25], v31 offset:1024
    v_mfma_f32_16x16x32_bf16 v[144:147], a[64:67], a[92:95], v[144:147]
    ds_read_b64_tr_b16 a[26:27], v31 offset:1536
    ds_read_b64_tr_b16 a[28:29], v31 offset:2048
    v_mfma_f32_16x16x32_bf16 v[112:115], a[84:87], a[68:71], v[112:115]
    ds_read_b64_tr_b16 a[30:31], v31 offset:2560
    ds_read_b128 a[0:3], v14 offset:16384
    v_mfma_f32_16x16x32_bf16 v[128:131], a[88:91], a[68:71], v[128:131]
    buffer_load_dwordx4 v20, s[12:15], s52 offen offset:1024 lds
    ds_read_b128 a[4:7], v14 offset:18432
    v_mfma_f32_16x16x32_bf16 v[148:151], a[68:71], a[92:95], v[148:151]
    ds_read_b128 a[8:11], v14 offset:20480
    ds_read_b128 a[12:15], v14 offset:22528
    v_mfma_f32_16x16x32_bf16 v[116:119], a[84:87], a[72:75], v[116:119]
    ds_read_b128 a[16:19], v27 offset:0
    ds_read_b64_tr_b16 a[52:53], v31 offset:12288
    v_mfma_f32_16x16x32_bf16 v[132:135], a[88:91], a[72:75], v[132:135]
    ds_read_b64_tr_b16 a[54:55], v31 offset:12800
    ds_read_b64_tr_b16 a[56:57], v31 offset:13312
    v_mfma_f32_16x16x32_bf16 v[152:155], a[72:75], a[92:95], v[152:155]
    buffer_load_dwordx4 v20, s[12:15], s52 offen offset:2048 lds
    s_add_u32 m0, s64, 125952
    ds_read_b64_tr_b16 a[58:59], v31 offset:13824
    v_mfma_f32_16x16x32_bf16 v[120:123], a[84:87], a[76:79], v[120:123]
    ds_read_b64_tr_b16 a[60:61], v31 offset:14336
    ds_read_b64_tr_b16 a[62:63], v31 offset:14848
    v_mfma_f32_16x16x32_bf16 v[136:139], a[88:91], a[76:79], v[136:139]
    ds_read_b128 a[32:35], v15 offset:16384
    ds_read_b128 a[36:39], v15 offset:18432
    v_mfma_f32_16x16x32_bf16 v[156:159], a[76:79], a[92:95], v[156:159]
    ds_read_b128 a[40:43], v15 offset:20480
    ds_read_b128 a[44:47], v15 offset:22528
    v_mfma_f32_16x16x32_bf16 v[140:143], a[88:91], a[80:83], v[140:143]
    buffer_load_dwordx4 v21, s[12:15], s52 offen offset:0 lds
    ds_read_b128 a[48:51], v28 offset:0
    v_mfma_f32_16x16x32_bf16 v[160:163], a[80:83], a[92:95], v[160:163]
    v_mfma_f32_16x16x32_bf16 v[108:111], a[116:119], a[96:99], v[108:111]
    v_mfma_f32_16x16x32_bf16 v[124:127], a[120:123], a[96:99], v[124:127]
    v_mfma_f32_16x16x32_bf16 v[144:147], a[96:99], a[124:127], v[144:147]
    buffer_load_dwordx4 v21, s[12:15], s52 offen offset:1024 lds
    v_mfma_f32_16x16x32_bf16 v[112:115], a[116:119], a[100:103], v[112:115]
    v_mfma_f32_16x16x32_bf16 v[128:131], a[120:123], a[100:103], v[128:131]
    v_mfma_f32_16x16x32_bf16 v[148:151], a[100:103], a[124:127], v[148:151]
    v_mfma_f32_16x16x32_bf16 v[116:119], a[116:119], a[104:107], v[116:119]
    buffer_load_dwordx4 v21, s[12:15], s52 offen offset:2048 lds
    v_mfma_f32_16x16x32_bf16 v[132:135], a[120:123], a[104:107], v[132:135]
    v_mfma_f32_16x16x32_bf16 v[152:155], a[104:107], a[124:127], v[152:155]
    v_mfma_f32_16x16x32_bf16 v[120:123], a[116:119], a[108:111], v[120:123]
    v_mfma_f32_16x16x32_bf16 v[136:139], a[120:123], a[108:111], v[136:139]
    s_add_u32 m0, s65, 147456
    s_add_u32 s51, s66, 4
    s_and_b32 s51, s51, 7
    s_lshl_b32 s51, s51, 7
    buffer_load_dwordx4 v22, s[4:7], s51 offen offset:0 lds
    v_mfma_f32_16x16x32_bf16 v[156:159], a[108:111], a[124:127], v[156:159]
    v_mfma_f32_16x16x32_bf16 v[140:143], a[120:123], a[112:115], v[140:143]
    v_mfma_f32_16x16x32_bf16 v[160:163], a[112:115], a[124:127], v[160:163]
    s_waitcnt lgkmcnt(0)
    s_waitcnt vmcnt(7)
    s_barrier
    v_mfma_f32_16x16x32_bf16 v[108:111], a[20:23], a[0:3], v[108:111]
    s_add_u32 s51, s47, 5
    s_and_b32 s51, s51, 7
    s_add_u32 m0, s64, 65536
    s_mul_i32 s52, s51, 196608
    buffer_load_dwordx4 v20, s[12:15], s52 offen offset:0 lds
    ds_read_b64_tr_b16 a[84:85], v31 offset:28672
    v_mfma_f32_16x16x32_bf16 v[124:127], a[24:27], a[0:3], v[124:127]
    ds_read_b64_tr_b16 a[86:87], v31 offset:29184
    ds_read_b64_tr_b16 a[88:89], v31 offset:29696
    v_mfma_f32_16x16x32_bf16 v[144:147], a[0:3], a[28:31], v[144:147]
    ds_read_b64_tr_b16 a[90:91], v31 offset:30208
    ds_read_b64_tr_b16 a[92:93], v31 offset:30720
    v_mfma_f32_16x16x32_bf16 v[112:115], a[20:23], a[4:7], v[112:115]
    ds_read_b64_tr_b16 a[94:95], v31 offset:31232
    ds_read_b128 a[64:67], v14 offset:24576
    v_mfma_f32_16x16x32_bf16 v[128:131], a[24:27], a[4:7], v[128:131]
    ds_read_b128 a[68:71], v14 offset:26624
    ds_read_b128 a[72:75], v14 offset:28672
    v_mfma_f32_16x16x32_bf16 v[148:151], a[4:7], a[28:31], v[148:151]
    buffer_load_dwordx4 v20, s[12:15], s52 offen offset:1024 lds
    ds_read_b128 a[76:79], v14 offset:30720
    v_mfma_f32_16x16x32_bf16 v[116:119], a[20:23], a[8:11], v[116:119]
    ds_read_b128 a[80:83], v27 offset:2048
    ds_read_b64_tr_b16 a[116:117], v31 offset:40960
    v_mfma_f32_16x16x32_bf16 v[132:135], a[24:27], a[8:11], v[132:135]
    ds_read_b64_tr_b16 a[118:119], v31 offset:41472
    ds_read_b64_tr_b16 a[120:121], v31 offset:41984
    v_mfma_f32_16x16x32_bf16 v[152:155], a[8:11], a[28:31], v[152:155]
    ds_read_b64_tr_b16 a[122:123], v31 offset:42496
    ds_read_b64_tr_b16 a[124:125], v31 offset:43008
    v_mfma_f32_16x16x32_bf16 v[120:123], a[20:23], a[12:15], v[120:123]
    ds_read_b64_tr_b16 a[126:127], v31 offset:43520
    ds_read_b128 a[96:99], v15 offset:24576
    v_mfma_f32_16x16x32_bf16 v[136:139], a[24:27], a[12:15], v[136:139]
    buffer_load_dwordx4 v20, s[12:15], s52 offen offset:2048 lds
    s_add_u32 m0, s64, 68608
    ds_read_b128 a[100:103], v15 offset:26624
    v_mfma_f32_16x16x32_bf16 v[156:159], a[12:15], a[28:31], v[156:159]
    ds_read_b128 a[104:107], v15 offset:28672
    ds_read_b128 a[108:111], v15 offset:30720
    v_mfma_f32_16x16x32_bf16 v[140:143], a[24:27], a[16:19], v[140:143]
    ds_read_b128 a[112:115], v28 offset:2048
    v_mfma_f32_16x16x32_bf16 v[160:163], a[16:19], a[28:31], v[160:163]
    v_mfma_f32_16x16x32_bf16 v[108:111], a[52:55], a[32:35], v[108:111]
    buffer_load_dwordx4 v21, s[12:15], s52 offen offset:0 lds
    v_mfma_f32_16x16x32_bf16 v[124:127], a[56:59], a[32:35], v[124:127]
    v_mfma_f32_16x16x32_bf16 v[144:147], a[32:35], a[60:63], v[144:147]
    v_mfma_f32_16x16x32_bf16 v[112:115], a[52:55], a[36:39], v[112:115]
    v_mfma_f32_16x16x32_bf16 v[128:131], a[56:59], a[36:39], v[128:131]
    v_mfma_f32_16x16x32_bf16 v[148:151], a[36:39], a[60:63], v[148:151]
    buffer_load_dwordx4 v21, s[12:15], s52 offen offset:1024 lds
    v_mfma_f32_16x16x32_bf16 v[116:119], a[52:55], a[40:43], v[116:119]
    v_mfma_f32_16x16x32_bf16 v[132:135], a[56:59], a[40:43], v[132:135]
    v_mfma_f32_16x16x32_bf16 v[152:155], a[40:43], a[60:63], v[152:155]
    v_mfma_f32_16x16x32_bf16 v[120:123], a[52:55], a[44:47], v[120:123]
    v_mfma_f32_16x16x32_bf16 v[136:139], a[56:59], a[44:47], v[136:139]
    buffer_load_dwordx4 v21, s[12:15], s52 offen offset:2048 lds
    v_mfma_f32_16x16x32_bf16 v[156:159], a[44:47], a[60:63], v[156:159]
    v_mfma_f32_16x16x32_bf16 v[140:143], a[56:59], a[48:51], v[140:143]
    v_mfma_f32_16x16x32_bf16 v[160:163], a[48:51], a[60:63], v[160:163]
    s_waitcnt lgkmcnt(0)
    s_waitcnt vmcnt(6)
    s_barrier
    v_mfma_f32_16x16x32_bf16 v[108:111], a[84:87], a[64:67], v[108:111]
    s_add_u32 s51, s47, 6
    s_and_b32 s51, s51, 7
    s_add_u32 m0, s64, 94208
    s_mul_i32 s52, s51, 196608
    buffer_load_dwordx4 v20, s[12:15], s52 offen offset:0 lds
    ds_read_b64_tr_b16 a[20:21], v32 offset:0
    v_mfma_f32_16x16x32_bf16 v[124:127], a[88:91], a[64:67], v[124:127]
    ds_read_b64_tr_b16 a[22:23], v32 offset:512
    ds_read_b64_tr_b16 a[24:25], v32 offset:1024
    v_mfma_f32_16x16x32_bf16 v[144:147], a[64:67], a[92:95], v[144:147]
    ds_read_b64_tr_b16 a[26:27], v32 offset:1536
    ds_read_b64_tr_b16 a[28:29], v32 offset:2048
    v_mfma_f32_16x16x32_bf16 v[112:115], a[84:87], a[68:71], v[112:115]
    ds_read_b64_tr_b16 a[30:31], v32 offset:2560
    ds_read_b128 a[0:3], v14 offset:32768
    v_mfma_f32_16x16x32_bf16 v[128:131], a[88:91], a[68:71], v[128:131]
    buffer_load_dwordx4 v20, s[12:15], s52 offen offset:1024 lds
    ds_read_b128 a[4:7], v14 offset:34816
    v_mfma_f32_16x16x32_bf16 v[148:151], a[68:71], a[92:95], v[148:151]
    ds_read_b128 a[8:11], v14 offset:36864
    ds_read_b128 a[12:15], v14 offset:38912
    v_mfma_f32_16x16x32_bf16 v[116:119], a[84:87], a[72:75], v[116:119]
    ds_read_b128 a[16:19], v27 offset:57344
    ds_read_b64_tr_b16 a[52:53], v32 offset:12288
    v_mfma_f32_16x16x32_bf16 v[132:135], a[88:91], a[72:75], v[132:135]
    ds_read_b64_tr_b16 a[54:55], v32 offset:12800
    ds_read_b64_tr_b16 a[56:57], v32 offset:13312
    v_mfma_f32_16x16x32_bf16 v[152:155], a[72:75], a[92:95], v[152:155]
    buffer_load_dwordx4 v20, s[12:15], s52 offen offset:2048 lds
    s_add_u32 m0, s64, 97280
    ds_read_b64_tr_b16 a[58:59], v32 offset:13824
    v_mfma_f32_16x16x32_bf16 v[120:123], a[84:87], a[76:79], v[120:123]
    ds_read_b64_tr_b16 a[60:61], v32 offset:14336
    ds_read_b64_tr_b16 a[62:63], v32 offset:14848
    v_mfma_f32_16x16x32_bf16 v[136:139], a[88:91], a[76:79], v[136:139]
    ds_read_b128 a[32:35], v15 offset:32768
    ds_read_b128 a[36:39], v15 offset:34816
    v_mfma_f32_16x16x32_bf16 v[156:159], a[76:79], a[92:95], v[156:159]
    ds_read_b128 a[40:43], v15 offset:36864
    ds_read_b128 a[44:47], v15 offset:38912
    v_mfma_f32_16x16x32_bf16 v[140:143], a[88:91], a[80:83], v[140:143]
    buffer_load_dwordx4 v21, s[12:15], s52 offen offset:0 lds
    ds_read_b128 a[48:51], v28 offset:57344
    v_mfma_f32_16x16x32_bf16 v[160:163], a[80:83], a[92:95], v[160:163]
    v_mfma_f32_16x16x32_bf16 v[108:111], a[116:119], a[96:99], v[108:111]
    v_mfma_f32_16x16x32_bf16 v[124:127], a[120:123], a[96:99], v[124:127]
    v_mfma_f32_16x16x32_bf16 v[144:147], a[96:99], a[124:127], v[144:147]
    buffer_load_dwordx4 v21, s[12:15], s52 offen offset:1024 lds
    v_mfma_f32_16x16x32_bf16 v[112:115], a[116:119], a[100:103], v[112:115]
    v_mfma_f32_16x16x32_bf16 v[128:131], a[120:123], a[100:103], v[128:131]
    v_mfma_f32_16x16x32_bf16 v[148:151], a[100:103], a[124:127], v[148:151]
    v_mfma_f32_16x16x32_bf16 v[116:119], a[116:119], a[104:107], v[116:119]
    buffer_load_dwordx4 v21, s[12:15], s52 offen offset:2048 lds
    v_mfma_f32_16x16x32_bf16 v[132:135], a[120:123], a[104:107], v[132:135]
    v_mfma_f32_16x16x32_bf16 v[152:155], a[104:107], a[124:127], v[152:155]
    v_mfma_f32_16x16x32_bf16 v[120:123], a[116:119], a[108:111], v[120:123]
    v_mfma_f32_16x16x32_bf16 v[136:139], a[120:123], a[108:111], v[136:139]
    s_add_u32 m0, s65, 118784
    s_add_u32 s51, s66, 6
    s_and_b32 s51, s51, 7
    s_lshl_b32 s51, s51, 7
    buffer_load_dwordx4 v22, s[4:7], s51 offen offset:0 lds
    v_mfma_f32_16x16x32_bf16 v[156:159], a[108:111], a[124:127], v[156:159]
    v_mfma_f32_16x16x32_bf16 v[140:143], a[120:123], a[112:115], v[140:143]
    v_mfma_f32_16x16x32_bf16 v[160:163], a[112:115], a[124:127], v[160:163]
    s_waitcnt lgkmcnt(0)
    s_waitcnt vmcnt(7)
    s_barrier
    v_mfma_f32_16x16x32_bf16 v[108:111], a[20:23], a[0:3], v[108:111]
    s_add_u32 s51, s47, 7
    s_and_b32 s51, s51, 7
    s_add_u32 m0, s64, 122880
    s_mul_i32 s52, s51, 196608
    buffer_load_dwordx4 v20, s[12:15], s52 offen offset:0 lds
    ds_read_b64_tr_b16 a[84:85], v31 offset:0
    v_mfma_f32_16x16x32_bf16 v[124:127], a[24:27], a[0:3], v[124:127]
    ds_read_b64_tr_b16 a[86:87], v31 offset:512
    ds_read_b64_tr_b16 a[88:89], v31 offset:1024
    v_mfma_f32_16x16x32_bf16 v[144:147], a[0:3], a[28:31], v[144:147]
    ds_read_b64_tr_b16 a[90:91], v31 offset:1536
    ds_read_b64_tr_b16 a[92:93], v31 offset:2048
    v_mfma_f32_16x16x32_bf16 v[112:115], a[20:23], a[4:7], v[112:115]
    ds_read_b64_tr_b16 a[94:95], v31 offset:2560
    ds_read_b128 a[64:67], v14 offset:40960
    v_mfma_f32_16x16x32_bf16 v[128:131], a[24:27], a[4:7], v[128:131]
    ds_read_b128 a[68:71], v14 offset:43008
    ds_read_b128 a[72:75], v14 offset:45056
    v_mfma_f32_16x16x32_bf16 v[148:151], a[4:7], a[28:31], v[148:151]
    buffer_load_dwordx4 v20, s[12:15], s52 offen offset:1024 lds
    ds_read_b128 a[76:79], v14 offset:47104
    v_mfma_f32_16x16x32_bf16 v[116:119], a[20:23], a[8:11], v[116:119]
    ds_read_b128 a[80:83], v27 offset:59392
    ds_read_b64_tr_b16 a[116:117], v31 offset:12288
    v_mfma_f32_16x16x32_bf16 v[132:135], a[24:27], a[8:11], v[132:135]
    ds_read_b64_tr_b16 a[118:119], v31 offset:12800
    ds_read_b64_tr_b16 a[120:121], v31 offset:13312
    v_mfma_f32_16x16x32_bf16 v[152:155], a[8:11], a[28:31], v[152:155]
    ds_read_b64_tr_b16 a[122:123], v31 offset:13824
    ds_read_b64_tr_b16 a[124:125], v31 offset:14336
    v_mfma_f32_16x16x32_bf16 v[120:123], a[20:23], a[12:15], v[120:123]
    ds_read_b64_tr_b16 a[126:127], v31 offset:14848
    ds_read_b128 a[96:99], v15 offset:40960
    v_mfma_f32_16x16x32_bf16 v[136:139], a[24:27], a[12:15], v[136:139]
    buffer_load_dwordx4 v20, s[12:15], s52 offen offset:2048 lds
    s_add_u32 m0, s64, 125952
    ds_read_b128 a[100:103], v15 offset:43008
    v_mfma_f32_16x16x32_bf16 v[156:159], a[12:15], a[28:31], v[156:159]
    ds_read_b128 a[104:107], v15 offset:45056
    ds_read_b128 a[108:111], v15 offset:47104
    v_mfma_f32_16x16x32_bf16 v[140:143], a[24:27], a[16:19], v[140:143]
    ds_read_b128 a[112:115], v28 offset:59392
    v_mfma_f32_16x16x32_bf16 v[160:163], a[16:19], a[28:31], v[160:163]
    v_mfma_f32_16x16x32_bf16 v[108:111], a[52:55], a[32:35], v[108:111]
    buffer_load_dwordx4 v21, s[12:15], s52 offen offset:0 lds
    v_mfma_f32_16x16x32_bf16 v[124:127], a[56:59], a[32:35], v[124:127]
    v_mfma_f32_16x16x32_bf16 v[144:147], a[32:35], a[60:63], v[144:147]
    v_mfma_f32_16x16x32_bf16 v[112:115], a[52:55], a[36:39], v[112:115]
    v_mfma_f32_16x16x32_bf16 v[128:131], a[56:59], a[36:39], v[128:131]
    v_mfma_f32_16x16x32_bf16 v[148:151], a[36:39], a[60:63], v[148:151]
    buffer_load_dwordx4 v21, s[12:15], s52 offen offset:1024 lds
    v_mfma_f32_16x16x32_bf16 v[116:119], a[52:55], a[40:43], v[116:119]
    v_mfma_f32_16x16x32_bf16 v[132:135], a[56:59], a[40:43], v[132:135]
    v_mfma_f32_16x16x32_bf16 v[152:155], a[40:43], a[60:63], v[152:155]
    v_mfma_f32_16x16x32_bf16 v[120:123], a[52:55], a[44:47], v[120:123]
    v_mfma_f32_16x16x32_bf16 v[136:139], a[56:59], a[44:47], v[136:139]
    buffer_load_dwordx4 v21, s[12:15], s52 offen offset:2048 lds
    v_mfma_f32_16x16x32_bf16 v[156:159], a[44:47], a[60:63], v[156:159]
    v_mfma_f32_16x16x32_bf16 v[140:143], a[56:59], a[48:51], v[140:143]
    v_mfma_f32_16x16x32_bf16 v[160:163], a[48:51], a[60:63], v[160:163]
    s_waitcnt lgkmcnt(0)
    s_waitcnt vmcnt(6)
    s_barrier
    v_mfma_f32_16x16x32_bf16 v[108:111], a[84:87], a[64:67], v[108:111]
    s_mov_b32 s51, 2048
    buffer_load_dword v11, v35, s[24:27], s51 offen
    ds_read_b64_tr_b16 a[20:21], v31 offset:28672
L_h9:
    s_cbranch_execz L_hret
    v_mfma_f32_16x16x32_bf16 v[124:127], a[88:91], a[64:67], v[124:127]
    ds_read_b64_tr_b16 a[22:23], v31 offset:29184
    ds_read_b64_tr_b16 a[24:25], v31 offset:29696
    v_mfma_f32_16x16x32_bf16 v[144:147], a[64:67], a[92:95], v[144:147]
    ds_read_b64_tr_b16 a[26:27], v31 offset:30208
    ds_read_b64_tr_b16 a[28:29], v31 offset:30720
    v_mfma_f32_16x16x32_bf16 v[112:115], a[84:87], a[68:71], v[112:115]
    ds_read_b64_tr_b16 a[30:31], v31 offset:31232
    ds_read_b128 a[0:3], v14 offset:49152
    v_mfma_f32_16x16x32_bf16 v[128:131], a[88:91], a[68:71], v[128:131]
    ds_read_b128 a[4:7], v14 offset:51200
    ds_read_b128 a[8:11], v14 offset:53248
    v_mfma_f32_16x16x32_bf16 v[148:151], a[68:71], a[92:95], v[148:151]
    ds_read_b128 a[12:15], v14 offset:55296
    ds_read_b128 a[16:19], v27 offset:28672
    v_mfma_f32_16x16x32_bf16 v[116:119], a[84:87], a[72:75], v[116:119]
    ds_read_b64_tr_b16 a[52:53], v31 offset:40960
    ds_read_b64_tr_b16 a[54:55], v31 offset:41472
    v_mfma_f32_16x16x32_bf16 v[132:135], a[88:91], a[72:75], v[132:135]
    ds_read_b64_tr_b16 a[56:57], v31 offset:41984
    ds_read_b64_tr_b16 a[58:59], v31 offset:42496
    v_mfma_f32_16x16x32_bf16 v[152:155], a[72:75], a[92:95], v[152:155]
    ds_read_b64_tr_b16 a[60:61], v31 offset:43008
    ds_read_b64_tr_b16 a[62:63], v31 offset:43520
    v_mfma_f32_16x16x32_bf16 v[120:123], a[84:87], a[76:79], v[120:123]
    ds_read_b128 a[32:35], v15 offset:49152
    ds_read_b128 a[36:39], v15 offset:51200
    v_mfma_f32_16x16x32_bf16 v[136:139], a[88:91], a[76:79], v[136:139]
    ds_read_b128 a[40:43], v15 offset:53248
    ds_read_b128 a[44:47], v15 offset:55296
    v_mfma_f32_16x16x32_bf16 v[156:159], a[76:79], a[92:95], v[156:159]
    ds_read_b128 a[48:51], v28 offset:28672
    v_mfma_f32_16x16x32_bf16 v[140:143], a[88:91], a[80:83], v[140:143]
    v_mfma_f32_16x16x32_bf16 v[160:163], a[80:83], a[92:95], v[160:163]
    v_mfma_f32_16x16x32_bf16 v[108:111], a[116:119], a[96:99], v[108:111]
    v_mfma_f32_16x16x32_bf16 v[124:127], a[120:123], a[96:99], v[124:127]
    v_mfma_f32_16x16x32_bf16 v[144:147], a[96:99], a[124:127], v[144:147]
    v_mfma_f32_16x16x32_bf16 v[112:115], a[116:119], a[100:103], v[112:115]
    v_mfma_f32_16x16x32_bf16 v[128:131], a[120:123], a[100:103], v[128:131]
    v_mfma_f32_16x16x32_bf16 v[148:151], a[100:103], a[124:127], v[148:151]
    v_mfma_f32_16x16x32_bf16 v[116:119], a[116:119], a[104:107], v[116:119]
    v_mfma_f32_16x16x32_bf16 v[132:135], a[120:123], a[104:107], v[132:135]
    v_mfma_f32_16x16x32_bf16 v[152:155], a[104:107], a[124:127], v[152:155]
    v_mfma_f32_16x16x32_bf16 v[120:123], a[116:119], a[108:111], v[120:123]
    v_mfma_f32_16x16x32_bf16 v[136:139], a[120:123], a[108:111], v[136:139]
    v_mfma_f32_16x16x32_bf16 v[156:159], a[108:111], a[124:127], v[156:159]
    v_mfma_f32_16x16x32_bf16 v[140:143], a[120:123], a[112:115], v[140:143]
    v_mfma_f32_16x16x32_bf16 v[160:163], a[112:115], a[124:127], v[160:163]
    s_waitcnt lgkmcnt(0)
    s_waitcnt vmcnt(1)
    s_barrier
    v_mfma_f32_16x16x32_bf16 v[108:111], a[20:23], a[0:3], v[108:111]
    ds_read_b64_tr_b16 a[84:85], v32 offset:0
    ds_read_b64_tr_b16 a[86:87], v32 offset:512
    v_mfma_f32_16x16x32_bf16 v[124:127], a[24:27], a[0:3], v[124:127]
    ds_read_b64_tr_b16 a[88:89], v32 offset:1024
    ds_read_b64_tr_b16 a[90:91], v32 offset:1536
    v_mfma_f32_16x16x32_bf16 v[144:147], a[0:3], a[28:31], v[144:147]
    ds_read_b64_tr_b16 a[92:93], v32 offset:2048
    ds_read_b64_tr_b16 a[94:95], v32 offset:2560
    v_mfma_f32_16x16x32_bf16 v[112:115], a[20:23], a[4:7], v[112:115]
    ds_read_b128 a[64:67], v14 offset:57344
    ds_read_b128 a[68:71], v14 offset:59392
    v_mfma_f32_16x16x32_bf16 v[128:131], a[24:27], a[4:7], v[128:131]
    ds_read_b128 a[72:75], v14 offset:61440
    ds_read_b128 a[76:79], v14 offset:63488
    v_mfma_f32_16x16x32_bf16 v[148:151], a[4:7], a[28:31], v[148:151]
    ds_read_b128 a[80:83], v27 offset:30720
    ds_read_b64_tr_b16 a[116:117], v32 offset:12288
    v_mfma_f32_16x16x32_bf16 v[116:119], a[20:23], a[8:11], v[116:119]
    ds_read_b64_tr_b16 a[118:119], v32 offset:12800
    ds_read_b64_tr_b16 a[120:121], v32 offset:13312
    v_mfma_f32_16x16x32_bf16 v[132:135], a[24:27], a[8:11], v[132:135]
    ds_read_b64_tr_b16 a[122:123], v32 offset:13824
    ds_read_b64_tr_b16 a[124:125], v32 offset:14336
    v_mfma_f32_16x16x32_bf16 v[152:155], a[8:11], a[28:31], v[152:155]
    ds_read_b64_tr_b16 a[126:127], v32 offset:14848
    ds_read_b128 a[96:99], v15 offset:57344
    v_mfma_f32_16x16x32_bf16 v[120:123], a[20:23], a[12:15], v[120:123]
    ds_read_b128 a[100:103], v15 offset:59392
    ds_read_b128 a[104:107], v15 offset:61440
    v_mfma_f32_16x16x32_bf16 v[136:139], a[24:27], a[12:15], v[136:139]
    ds_read_b128 a[108:111], v15 offset:63488
    ds_read_b128 a[112:115], v28 offset:30720
    v_mfma_f32_16x16x32_bf16 v[156:159], a[12:15], a[28:31], v[156:159]
    v_mfma_f32_16x16x32_bf16 v[140:143], a[24:27], a[16:19], v[140:143]
    v_mfma_f32_16x16x32_bf16 v[160:163], a[16:19], a[28:31], v[160:163]
    v_mfma_f32_16x16x32_bf16 v[108:111], a[52:55], a[32:35], v[108:111]
    v_mfma_f32_16x16x32_bf16 v[124:127], a[56:59], a[32:35], v[124:127]
    v_mfma_f32_16x16x32_bf16 v[144:147], a[32:35], a[60:63], v[144:147]
    v_mfma_f32_16x16x32_bf16 v[112:115], a[52:55], a[36:39], v[112:115]
    v_mfma_f32_16x16x32_bf16 v[128:131], a[56:59], a[36:39], v[128:131]
    v_mfma_f32_16x16x32_bf16 v[148:151], a[36:39], a[60:63], v[148:151]
    v_mfma_f32_16x16x32_bf16 v[116:119], a[52:55], a[40:43], v[116:119]
    v_mfma_f32_16x16x32_bf16 v[132:135], a[56:59], a[40:43], v[132:135]
    v_mfma_f32_16x16x32_bf16 v[152:155], a[40:43], a[60:63], v[152:155]
    v_mfma_f32_16x16x32_bf16 v[120:123], a[52:55], a[44:47], v[120:123]
    v_mfma_f32_16x16x32_bf16 v[136:139], a[56:59], a[44:47], v[136:139]
    v_mfma_f32_16x16x32_bf16 v[156:159], a[44:47], a[60:63], v[156:159]
    v_mfma_f32_16x16x32_bf16 v[140:143], a[56:59], a[48:51], v[140:143]
    v_mfma_f32_16x16x32_bf16 v[160:163], a[48:51], a[60:63], v[160:163]
    s_waitcnt lgkmcnt(0)
    s_barrier
    v_mfma_f32_16x16x32_bf16 v[108:111], a[84:87], a[64:67], v[108:111]
    s_mov_b32 s51, 34816
    buffer_load_dword v11, v35, s[24:27], s51 offen
    v_mfma_f32_16x16x32_bf16 v[124:127], a[88:91], a[64:67], v[124:127]
    v_mfma_f32_16x16x32_bf16 v[144:147], a[64:67], a[92:95], v[144:147]
    v_mfma_f32_16x16x32_bf16 v[112:115], a[84:87], a[68:71], v[112:115]
    v_mfma_f32_16x16x32_bf16 v[128:131], a[88:91], a[68:71], v[128:131]
    v_mfma_f32_16x16x32_bf16 v[148:151], a[68:71], a[92:95], v[148:151]
    v_mfma_f32_16x16x32_bf16 v[116:119], a[84:87], a[72:75], v[116:119]
    v_mfma_f32_16x16x32_bf16 v[132:135], a[88:91], a[72:75], v[132:135]
    v_mfma_f32_16x16x32_bf16 v[152:155], a[72:75], a[92:95], v[152:155]
    v_mfma_f32_16x16x32_bf16 v[120:123], a[84:87], a[76:79], v[120:123]
    v_mfma_f32_16x16x32_bf16 v[136:139], a[88:91], a[76:79], v[136:139]
    v_mfma_f32_16x16x32_bf16 v[156:159], a[76:79], a[92:95], v[156:159]
    v_mfma_f32_16x16x32_bf16 v[140:143], a[88:91], a[80:83], v[140:143]
    v_mfma_f32_16x16x32_bf16 v[160:163], a[80:83], a[92:95], v[160:163]
    v_mfma_f32_16x16x32_bf16 v[108:111], a[116:119], a[96:99], v[108:111]
    v_mfma_f32_16x16x32_bf16 v[124:127], a[120:123], a[96:99], v[124:127]
    v_mfma_f32_16x16x32_bf16 v[144:147], a[96:99], a[124:127], v[144:147]
    v_mfma_f32_16x16x32_bf16 v[112:115], a[116:119], a[100:103], v[112:115]
    v_mfma_f32_16x16x32_bf16 v[128:131], a[120:123], a[100:103], v[128:131]
    v_mfma_f32_16x16x32_bf16 v[148:151], a[100:103], a[124:127], v[148:151]
    v_mfma_f32_16x16x32_bf16 v[116:119], a[116:119], a[104:107], v[116:119]
    v_mfma_f32_16x16x32_bf16 v[132:135], a[120:123], a[104:107], v[132:135]
    v_mfma_f32_16x16x32_bf16 v[152:155], a[104:107], a[124:127], v[152:155]
    v_mfma_f32_16x16x32_bf16 v[120:123], a[116:119], a[108:111], v[120:123]
    v_mfma_f32_16x16x32_bf16 v[136:139], a[120:123], a[108:111], v[136:139]
    v_mfma_f32_16x16x32_bf16 v[156:159], a[108:111], a[124:127], v[156:159]
    v_mfma_f32_16x16x32_bf16 v[140:143], a[120:123], a[112:115], v[140:143]
    v_mfma_f32_16x16x32_bf16 v[160:163], a[112:115], a[124:127], v[160:163]
    v_mov_b32 v244, 0xf149f2ca
    s_cmp_eq_u32 s44, 0
    s_cselect_b32 s48, 0xf149f2ca, 0
    v_mov_b32 v207, s48
    v_lshl_add_u32 v205, v3, 2, 0
    v_sub_u32 v206, v2, v205
    v_cmp_lt_u32 vcc, 7, v206
    v_cmp_lt_i32 s[60:61], -9, v206
    s_nop 0
    v_cndmask_b32 v188, 0, v244, vcc
    v_cndmask_b32 v192, 0, v244, s[60:61]
    v_cndmask_b32 v200, v207, v244, s[60:61]
    buffer_store_dwordx4 v[72:75], v34, s[20:23], s78 offen offset:0 sc1
    v_cmp_lt_i32 vcc, -1, v206
    v_cmp_lt_u32 s[60:61], 7, v205
    s_nop 0
    v_cndmask_b32 v196, v207, v244, vcc
    v_cndmask_b32 v196, v196, v244, s[60:61]
    v_lshl_add_u32 v205, v3, 2, 1
    v_sub_u32 v206, v2, v205
    v_cmp_lt_u32 vcc, 7, v206
    v_cmp_lt_i32 s[60:61], -9, v206
    s_nop 0
    v_cndmask_b32 v189, 0, v244, vcc
    buffer_store_dwordx4 v[72:75], v34, s[20:23], s78 offen offset:1024 sc1
    v_cndmask_b32 v193, 0, v244, s[60:61]
    v_cndmask_b32 v201, v207, v244, s[60:61]
    v_cmp_lt_i32 vcc, -1, v206
    v_cmp_lt_u32 s[60:61], 7, v205
    s_nop 0
    v_cndmask_b32 v197, v207, v244, vcc
    v_cndmask_b32 v197, v197, v244, s[60:61]
    v_lshl_add_u32 v205, v3, 2, 2
    v_sub_u32 v206, v2, v205
    v_cmp_lt_u32 vcc, 7, v206
    buffer_store_dwordx4 v[72:75], v34, s[20:23], s78 offen offset:2048 sc1
    v_cmp_lt_i32 s[60:61], -9, v206
    v_cndmask_b32 v190, 0, v244, vcc
    s_nop 0
    v_cndmask_b32 v194, 0, v244, s[60:61]
    v_cndmask_b32 v202, v207, v244, s[60:61]
    v_cmp_lt_i32 vcc, -1, v206
    v_cmp_lt_u32 s[60:61], 7, v205
    s_nop 0
    v_cndmask_b32 v198, v207, v244, vcc
    v_cndmask_b32 v198, v198, v244, s[60:61]
    v_lshl_add_u32 v205, v3, 2, 3
    buffer_store_dwordx4 v[72:75], v34, s[20:23], s78 offen offset:3072 sc1
    s_add_u32 s78, s78, 4096
    v_sub_u32 v206, v2, v205
    v_cmp_lt_u32 vcc, 7, v206
    v_cmp_lt_i32 s[60:61], -9, v206
    s_nop 0
    v_cndmask_b32 v191, 0, v244, vcc
    v_cndmask_b32 v195, 0, v244, s[60:61]
    v_cndmask_b32 v203, v207, v244, s[60:61]
    v_cmp_lt_i32 vcc, -1, v206
    v_cmp_lt_u32 s[60:61], 7, v205
    s_nop 0
    v_cndmask_b32 v199, v207, v244, vcc
    buffer_store_dwordx4 v[72:75], v34, s[20:23], s78 offen offset:0 sc1
    v_cndmask_b32 v199, v199, v244, s[60:61]
    v_cvt_pk_bf16_f32 v108, v108, v109
    v_cvt_pk_bf16_f32 v109, v110, v111
    v_cvt_pk_bf16_f32 v112, v112, v113
    v_cvt_pk_bf16_f32 v113, v114, v115
    v_cvt_pk_bf16_f32 v116, v116, v117
    v_cvt_pk_bf16_f32 v117, v118, v119
    v_cvt_pk_bf16_f32 v120, v120, v121
    v_cvt_pk_bf16_f32 v121, v122, v123
    buffer_store_dwordx4 v[72:75], v34, s[20:23], s78 offen offset:1024 sc1
    v_cvt_pk_bf16_f32 v124, v124, v125
    v_cvt_pk_bf16_f32 v125, v126, v127
    v_cvt_pk_bf16_f32 v128, v128, v129
    v_cvt_pk_bf16_f32 v129, v130, v131
    v_cvt_pk_bf16_f32 v132, v132, v133
    v_cvt_pk_bf16_f32 v133, v134, v135
    v_cvt_pk_bf16_f32 v136, v136, v137
    v_cvt_pk_bf16_f32 v137, v138, v139
    v_cvt_pk_bf16_f32 v140, v140, v141
    buffer_store_dwordx4 v[72:75], v34, s[20:23], s78 offen offset:2048 sc1
    v_cvt_pk_bf16_f32 v141, v142, v143
    s_nop 1
    v_mfma_f32_16x16x16_bf16 v[208:211], v[140:141], v[108:109], v[196:199]
    v_mfma_f32_16x16x16_bf16 v[212:215], v[124:125], v[108:109], v[188:191]
    v_mfma_f32_16x16x16_bf16 v[216:219], v[124:125], v[112:113], v[192:195]
    buffer_store_dwordx4 v[72:75], v34, s[20:23], s78 offen offset:3072 sc1
    s_add_u32 s78, s78, 4096
    v_mfma_f32_16x16x16_bf16 v[220:223], v[128:129], v[112:113], v[188:191]
    v_mfma_f32_16x16x16_bf16 v[224:227], v[140:141], v[116:117], v[200:203]
    v_mfma_f32_16x16x16_bf16 v[228:231], v[132:133], v[116:117], v[188:191]
    buffer_store_dwordx4 v[72:75], v34, s[20:23], s78 offen offset:0 sc1
    v_mfma_f32_16x16x16_bf16 v[232:235], v[132:133], v[120:121], v[192:195]
    v_mfma_f32_16x16x16_bf16 v[236:239], v[136:137], v[120:121], v[188:191]
    v_cvt_pk_bf16_f32 v16, v160, v161
    v_cvt_pk_bf16_f32 v17, v162, v163
    v_cvt_pk_bf16_f32 v18, v144, v145
    buffer_store_dwordx4 v[72:75], v34, s[20:23], s78 offen offset:1024 sc1
    v_cvt_pk_bf16_f32 v19, v146, v147
    v_cvt_pk_bf16_f32 v20, v148, v149
    v_cvt_pk_bf16_f32 v21, v150, v151
    v_cvt_pk_bf16_f32 v28, v160, v161
    v_cvt_pk_bf16_f32 v29, v162, v163
    v_cvt_pk_bf16_f32 v30, v152, v153
    v_cvt_pk_bf16_f32 v31, v154, v155
    v_cvt_pk_bf16_f32 v32, v156, v157
    v_cvt_pk_bf16_f32 v33, v158, v159
    buffer_store_dwordx4 v[72:75], v34, s[20:23], s78 offen offset:2048 sc1
    v_mov_b32 v240, 0x3f803f80
    v_mov_b32 v241, 0x3f803f80
    v_mov_b32 v242, 0x3f803f80
    v_mov_b32 v243, 0x3f803f80
    v_max3_f32 v164, v208, v209, v210
    v_max3_f32 v165, v211, v212, v213
    v_max3_f32 v166, v216, v217, v218
    v_max3_f32 v167, v219, v220, v221
    v_max3_f32 v168, v224, v225, v226
    buffer_store_dwordx4 v[72:75], v34, s[20:23], s78 offen offset:3072 sc1
    s_add_u32 s78, s78, 4096
    v_max3_f32 v169, v227, v228, v229
    v_max3_f32 v170, v232, v233, v234
    v_max3_f32 v171, v235, v236, v237
    v_max3_f32 v164, v164, v214, v215
    v_max3_f32 v166, v166, v222, v223
    v_max3_f32 v168, v168, v230, v231
    v_max3_f32 v170, v170, v238, v239
    v_max_f32 v165, v164, v165
    v_max_f32 v167, v166, v167
    buffer_store_dwordx4 v[72:75], v34, s[20:23], s78 offen offset:0 sc1
    v_max_f32 v169, v168, v169
    v_max_f32 v171, v170, v171
    v_mov_b32 v12, v165
    v_mov_b32 v13, v167
    v_mov_b32 v22, v169
    v_mov_b32 v27, v171
    v_permlane32_swap_b32 v165, v12
    v_permlane32_swap_b32 v167, v13
    v_permlane32_swap_b32 v169, v22
    buffer_store_dwordx4 v[72:75], v34, s[20:23], s78 offen offset:1024 sc1
    v_permlane32_swap_b32 v171, v27
    v_max_f32 v165, v165, v12
    v_max_f32 v167, v167, v13
    v_max_f32 v169, v169, v22
    v_max_f32 v171, v171, v27
    v_mov_b32 v12, v165
    v_mov_b32 v13, v167
    v_mov_b32 v22, v169
    v_mov_b32 v27, v171
    buffer_store_dwordx4 v[72:75], v34, s[20:23], s78 offen offset:2048 sc1
    v_permlane16_swap_b32 v165, v12
    v_permlane16_swap_b32 v167, v13
    v_permlane16_swap_b32 v169, v22
    v_permlane16_swap_b32 v171, v27
    v_max_f32 v165, v165, v12
    v_max_f32 v167, v167, v13
    v_max_f32 v169, v169, v22
    v_max_f32 v171, v171, v27
    v_mov_b32 v164, 0x3eb8aa3b
    buffer_store_dwordx4 v[72:75], v34, s[20:23], s78 offen offset:3072 sc1
    s_add_u32 s78, s78, 4096
    v_mul_f32 v165, 0xbeb8aa3b, v165
    v_mov_b32 v166, 0x3eb8aa3b
    v_mul_f32 v167, 0xbeb8aa3b, v167
    v_mov_b32 v168, 0x3eb8aa3b
    v_mul_f32 v169, 0xbeb8aa3b, v169
    v_mov_b32 v170, 0x3eb8aa3b
    v_mul_f32 v171, 0xbeb8aa3b, v171
    v_pk_fma_f32 v[208:209], v[208:209], v[164:165], v[164:165] op_sel:[0,0,1] op_sel_hi:[1,0,1]
    v_pk_fma_f32 v[210:211], v[210:211], v[164:165], v[164:165] op_sel:[0,0,1] op_sel_hi:[1,0,1]
    buffer_store_dwordx4 v[72:75], v34, s[20:23], s78 offen offset:0 sc1
    v_pk_fma_f32 v[212:213], v[212:213], v[164:165], v[164:165] op_sel:[0,0,1] op_sel_hi:[1,0,1]
    v_pk_fma_f32 v[214:215], v[214:215], v[164:165], v[164:165] op_sel:[0,0,1] op_sel_hi:[1,0,1]
    v_pk_fma_f32 v[216:217], v[216:217], v[166:167], v[166:167] op_sel:[0,0,1] op_sel_hi:[1,0,1]
    v_pk_fma_f32 v[218:219], v[218:219], v[166:167], v[166:167] op_sel:[0,0,1] op_sel_hi:[1,0,1]
    v_pk_fma_f32 v[220:221], v[220:221], v[166:167], v[166:167] op_sel:[0,0,1] op_sel_hi:[1,0,1]
    v_pk_fma_f32 v[222:223], v[222:223], v[166:167], v[166:167] op_sel:[0,0,1] op_sel_hi:[1,0,1]
    v_pk_fma_f32 v[224:225], v[224:225], v[168:169], v[168:169] op_sel:[0,0,1] op_sel_hi:[1,0,1]
    v_pk_fma_f32 v[226:227], v[226:227], v[168:169], v[168:169] op_sel:[0,0,1] op_sel_hi:[1,0,1]
    v_pk_fma_f32 v[228:229], v[228:229], v[168:169], v[168:169] op_sel:[0,0,1] op_sel_hi:[1,0,1]
    buffer_store_dwordx4 v[72:75], v34, s[20:23], s78 offen offset:1024 sc1
    v_pk_fma_f32 v[230:231], v[230:231], v[168:169], v[168:169] op_sel:[0,0,1] op_sel_hi:[1,0,1]
    v_pk_fma_f32 v[232:233], v[232:233], v[170:171], v[170:171] op_sel:[0,0,1] op_sel_hi:[1,0,1]
    v_pk_fma_f32 v[234:235], v[234:235], v[170:171], v[170:171] op_sel:[0,0,1] op_sel_hi:[1,0,1]
    v_pk_fma_f32 v[236:237], v[236:237], v[170:171], v[170:171] op_sel:[0,0,1] op_sel_hi:[1,0,1]
    v_pk_fma_f32 v[238:239], v[238:239], v[170:171], v[170:171] op_sel:[0,0,1] op_sel_hi:[1,0,1]
    v_exp_f32 v208, v208
    v_exp_f32 v209, v209
    buffer_store_dwordx4 v[72:75], v34, s[20:23], s78 offen offset:2048 sc1
    v_exp_f32 v210, v210
    v_exp_f32 v211, v211
    v_exp_f32 v212, v212
    v_exp_f32 v213, v213
    v_exp_f32 v214, v214
    buffer_store_dwordx4 v[72:75], v34, s[20:23], s78 offen offset:3072 sc1
    s_add_u32 s78, s78, 4096
    v_exp_f32 v215, v215
    v_exp_f32 v216, v216
    v_exp_f32 v217, v217
    v_exp_f32 v218, v218
    v_exp_f32 v219, v219
    buffer_store_dwordx4 v[72:75], v34, s[20:23], s78 offen offset:0 sc1
    v_exp_f32 v220, v220
    v_exp_f32 v221, v221
    v_exp_f32 v222, v222
    v_exp_f32 v223, v223
    v_exp_f32 v224, v224
    buffer_store_dwordx4 v[72:75], v34, s[20:23], s78 offen offset:1024 sc1
    v_exp_f32 v225, v225
    v_exp_f32 v226, v226
    v_exp_f32 v227, v227
    v_exp_f32 v228, v228
    v_exp_f32 v229, v229
    buffer_store_dwordx4 v[72:75], v34, s[20:23], s78 offen offset:2048 sc1
    v_exp_f32 v230, v230
    v_exp_f32 v231, v231
    v_exp_f32 v232, v232
    v_exp_f32 v233, v233
    v_exp_f32 v234, v234
    buffer_store_dwordx4 v[72:75], v34, s[20:23], s78 offen offset:3072 sc1
    s_add_u32 s78, s78, 4096
    v_exp_f32 v235, v235
    v_exp_f32 v236, v236
    v_exp_f32 v237, v237
    v_exp_f32 v238, v238
    v_exp_f32 v239, v239
    buffer_store_dwordx4 v[72:75], v34, s[20:23], s78 offen offset:0 sc1
    v_cvt_pk_bf16_f32 v208, v208, v209
    v_cvt_pk_bf16_f32 v209, v210, v211
    v_cvt_pk_bf16_f32 v210, v212, v213
    v_cvt_pk_bf16_f32 v211, v214, v215
    v_cvt_pk_bf16_f32 v216, v216, v217
    v_cvt_pk_bf16_f32 v217, v218, v219
    v_cvt_pk_bf16_f32 v218, v220, v221
    v_cvt_pk_bf16_f32 v219, v222, v223
    v_cvt_pk_bf16_f32 v224, v224, v225
    buffer_store_dwordx4 v[72:75], v34, s[20:23], s78 offen offset:1024 sc1
    v_cvt_pk_bf16_f32 v225, v226, v227
    v_cvt_pk_bf16_f32 v226, v228, v229
    v_cvt_pk_bf16_f32 v227, v230, v231
    v_cvt_pk_bf16_f32 v232, v232, v233
    v_cvt_pk_bf16_f32 v233, v234, v235
    v_cvt_pk_bf16_f32 v234, v236, v237
    v_cvt_pk_bf16_f32 v235, v238, v239
    v_mfma_f32_16x16x32_bf16 v[108:111], v[16:19], v[208:211], 0
    buffer_store_dwordx4 v[72:75], v34, s[20:23], s78 offen offset:2048 sc1
    v_mfma_f32_16x16x32_bf16 v[124:127], v[240:243], v[208:211], 0
    v_mfma_f32_16x16x32_bf16 v[112:115], v[18:21], v[216:219], 0
    v_mfma_f32_16x16x32_bf16 v[128:131], v[240:243], v[216:219], 0
    buffer_store_dwordx4 v[72:75], v34, s[20:23], s78 offen offset:3072 sc1
    s_add_u32 s78, s78, 4096
    v_mfma_f32_16x16x32_bf16 v[116:119], v[28:31], v[224:227], 0
    v_mfma_f32_16x16x32_bf16 v[132:135], v[240:243], v[224:227], 0
    v_mfma_f32_16x16x32_bf16 v[120:123], v[30:33], v[232:235], 0
    v_mfma_f32_16x16x32_bf16 v[136:139], v[240:243], v[232:235], 0
    s_lshr_b32 s48, s3, 1
    s_lshl_b32 s48, s48, 10
    s_and_b32 s50, s3, 1
    s_lshl_b32 s50, s50, 3
    s_add_u32 s48, s48, s50
    s_add_u32 s48, s48, 151552
    v_add_u32 v205, s48, v34
    s_add_u32 s48, s62, 151552
    v_add_u32 v206, s48, v34
    v_rcp_f32 v124, v124
    v_rcp_f32 v128, v128
    v_rcp_f32 v132, v132
    v_rcp_f32 v136, v136
    v_pk_mul_f32 v[108:109], v[108:109], v[124:125] op_sel_hi:[1,0]
    v_pk_mul_f32 v[110:111], v[110:111], v[124:125] op_sel_hi:[1,0]
    v_pk_mul_f32 v[112:113], v[112:113], v[128:129] op_sel_hi:[1,0]
    v_pk_mul_f32 v[114:115], v[114:115], v[128:129] op_sel_hi:[1,0]
    v_pk_mul_f32 v[116:117], v[116:117], v[132:133] op_sel_hi:[1,0]
    v_pk_mul_f32 v[118:119], v[118:119], v[132:133] op_sel_hi:[1,0]
    v_pk_mul_f32 v[120:121], v[120:121], v[136:137] op_sel_hi:[1,0]
    v_pk_mul_f32 v[122:123], v[122:123], v[136:137] op_sel_hi:[1,0]
    v_cvt_pk_bf16_f32 v108, v108, v109
    v_cvt_pk_bf16_f32 v109, v110, v111
    v_cvt_pk_bf16_f32 v112, v112, v113
    v_cvt_pk_bf16_f32 v113, v114, v115
    v_cvt_pk_bf16_f32 v116, v116, v117
    v_cvt_pk_bf16_f32 v117, v118, v119
    v_cvt_pk_bf16_f32 v120, v120, v121
    v_cvt_pk_bf16_f32 v121, v122, v123
    ds_write_b64 v205, v[108:109] offset:0
    ds_write_b64 v205, v[112:113] offset:2048
    ds_write_b64 v205, v[116:117] offset:4096
    ds_write_b64 v205, v[120:121] offset:6144
    v_mul_f32 v176, 0xbfb8aa3b, v104
    v_exp_f32 v176, v176
    s_nop 0
    v_add_f32 v176, 1.0, v176
    v_rcp_f32 v176, v176
    s_lshl_b32 s48, s3, 6
    s_add_u32 s48, s48, 162816
    v_lshl_add_u32 v207, v2, 2, s48
    ds_write_b32 v207, v176
    v_xor_b32 v207, 64, v207
    s_waitcnt lgkmcnt(0)
    s_barrier
    ds_read_b32 v178, v207
    ds_read_b128 v[208:211], v206 offset:0
    ds_read_b128 v[212:215], v206 offset:1024
    s_lshl_b32 s48, s45, 11
    s_add_u32 s48, s48, s67
    s_waitcnt lgkmcnt(0)
    buffer_store_dwordx4 v[208:211], v34, s[20:23], s48 offen offset:0 sc1
    buffer_store_dwordx4 v[212:215], v34, s[20:23], s48 offen offset:1024 sc1
    s_lshl_b32 s48, s44, 9
    s_lshl_b32 s50, s3, 7
    s_add_u32 s48, s48, s50
    s_lshl_b32 s50, s45, 4
    s_add_u32 s48, s48, s50
    s_add_u32 s48, s48, 655360
    v_lshlrev_b32 v10, 3, v1
    s_waitcnt vmcnt(0)
    s_mov_b64 exec, 1
    buffer_store_dwordx2 v[172:173], v10, s[20:23], s48 offen sc1
    s_mov_b64 exec, -1
    s_and_b32 s48, s2, 6
    s_lshl_b32 s48, s48, 3
    s_add_u32 s48, s48, s73
    s_lshl_b32 s51, s48, 14
    buffer_load_dword v11, v39, s[32:35], s51 offen
    s_lshl_b32 s51, s48, 13
    s_mov_b64 exec, 0xffffffff
    buffer_load_dword v11, v39, s[28:31], s51 offen
    s_mov_b64 exec, -1
    s_and_b32 s49, s53, 3
    s_and_b32 s48, s2, 1
    s_lshl_b32 s48, s48, 2
    s_add_u32 s46, s48, s49
    s_cmp_eq_u32 s49, 3
    s_cselect_b32 s46, 3, s46
    v_min_u32 v185, 31, v1
    v_lshlrev_b32 v185, 3, v185
    s_lshl_b32 s72, s46, 10
    s_lshl_b32 s50, s3, 8
    s_add_u32 s72, s72, s50
    s_add_u32 s72, s72, 393216
    buffer_load_dwordx2 v[174:175], v185, s[20:23], s72 offen sc1
    s_lshl_b32 s49, s46, 3
    s_lshl_b32 s50, s3, 1
    s_add_u32 s49, s49, s50
    s_lshl_b32 s49, s49, 16
    s_add_u32 s49, s49, 1048576
    v_and_b32 v35, 31, v1
    v_lshlrev_b32 v35, 7, v35
    v_lshrrev_b32 v8, 5, v1
    v_lshl_add_u32 v35, v8, 16, v35
    v_add_u32 v35, s49, v35
    s_waitcnt vmcnt(0)
    s_mov_b32 s58, 0x40000
L_poll3:
    v_cmp_ne_u64 vcc, s[56:57], v[174:175]
    s_nop 4
    s_cbranch_vccz L_polld3
    s_sub_u32 s58, s58, 1
    s_cbranch_scc1 L_polld3
    s_sleep 8
    v_min_u32 v185, 31, v1
    v_lshlrev_b32 v185, 3, v185
    s_lshl_b32 s72, s46, 10
    s_lshl_b32 s50, s3, 8
    s_add_u32 s72, s72, s50
    s_add_u32 s72, s72, 393216
    buffer_load_dwordx2 v[174:175], v185, s[20:23], s72 offen sc1
    s_waitcnt vmcnt(0)
    s_branch L_poll3
L_polld3:
    s_mov_b32 s51, 32768
    buffer_load_dword v11, v35, s[20:23], s51 offen sc1
    s_mov_b32 s51, 36864
    buffer_load_dword v11, v35, s[20:23], s51 offen sc1
    s_mov_b32 s51, 40960
    buffer_load_dword v11, v35, s[20:23], s51 offen sc1
    s_mov_b32 s51, 45056
    buffer_load_dword v11, v35, s[20:23], s51 offen sc1
    s_mov_b32 s51, 49152
    buffer_load_dword v11, v35, s[20:23], s51 offen sc1
    s_mov_b32 s51, 53248
    buffer_load_dword v11, v35, s[20:23], s51 offen sc1
    s_mov_b32 s51, 57344
    buffer_load_dword v11, v35, s[20:23], s51 offen sc1
    s_mov_b32 s51, 61440
    buffer_load_dword v11, v35, s[20:23], s51 offen sc1
    s_add_u32 m0, s65, 65536
    s_mov_b32 s52, 0
    buffer_load_dwordx4 v36, s[28:31], s52 offen lds
    s_add_u32 m0, s65, 69632
    s_mov_b32 s52, 32768
    buffer_load_dwordx4 v36, s[28:31], s52 offen lds
    s_add_u32 m0, s65, 73728
    s_mov_b32 s52, 65536
    buffer_load_dwordx4 v36, s[28:31], s52 offen lds
    s_add_u32 m0, s65, 77824
    s_mov_b32 s52, 98304
    buffer_load_dwordx4 v36, s[28:31], s52 offen lds
    s_add_u32 m0, s65, 81920
    s_mov_b32 s52, 131072
    buffer_load_dwordx4 v36, s[28:31], s52 offen lds
    s_add_u32 m0, s65, 86016
    s_mov_b32 s52, 163840
    buffer_load_dwordx4 v36, s[28:31], s52 offen lds
    s_add_u32 m0, s65, 90112
    s_mov_b32 s52, 196608
    buffer_load_dwordx4 v36, s[28:31], s52 offen lds
    s_add_u32 m0, s65, 94208
    s_mov_b32 s52, 229376
    buffer_load_dwordx4 v36, s[28:31], s52 offen lds
    s_add_u32 m0, s65, 98304
    s_mov_b32 s52, 262144
    buffer_load_dwordx4 v36, s[28:31], s52 offen lds
    s_add_u32 m0, s65, 102400
    s_mov_b32 s52, 294912
    buffer_load_dwordx4 v36, s[28:31], s52 offen lds
    s_add_u32 m0, s65, 106496
    s_mov_b32 s52, 327680
    buffer_load_dwordx4 v36, s[28:31], s52 offen lds
    s_add_u32 m0, s65, 110592
    s_mov_b32 s52, 360448
    buffer_load_dwordx4 v36, s[28:31], s52 offen lds
    s_add_u32 m0, s65, 114688
    s_mov_b32 s52, 393216
    buffer_load_dwordx4 v36, s[28:31], s52 offen lds
    s_add_u32 m0, s65, 118784
    s_mov_b32 s52, 425984
    buffer_load_dwordx4 v36, s[28:31], s52 offen lds
    s_add_u32 m0, s65, 122880
    s_mov_b32 s52, 458752
    buffer_load_dwordx4 v36, s[28:31], s52 offen lds
    s_add_u32 m0, s65, 126976
    s_mov_b32 s52, 491520
    buffer_load_dwordx4 v36, s[28:31], s52 offen lds
    s_add_u32 m0, s65, 131072
    s_mov_b32 s52, 524288
    buffer_load_dwordx4 v36, s[32:35], s52 offen lds
    s_add_u32 m0, s65, 135168
    s_mov_b32 s52, 557056
    buffer_load_dwordx4 v36, s[32:35], s52 offen lds
    s_add_u32 m0, s65, 139264
    s_mov_b32 s52, 589824
    buffer_load_dwordx4 v36, s[32:35], s52 offen lds
    s_add_u32 m0, s65, 143360
    s_mov_b32 s52, 622592
    buffer_load_dwordx4 v36, s[32:35], s52 offen lds
    s_add_u32 m0, s65, 147456
    s_mov_b32 s52, 655360
    buffer_load_dwordx4 v36, s[32:35], s52 offen lds
    s_add_u32 m0, s65, 151552
    s_mov_b32 s52, 688128
    buffer_load_dwordx4 v36, s[32:35], s52 offen lds
    s_add_u32 m0, s65, 155648
    s_mov_b32 s52, 720896
    buffer_load_dwordx4 v36, s[32:35], s52 offen lds
    s_add_u32 m0, s65, 159744
    s_mov_b32 s52, 753664
    buffer_load_dwordx4 v36, s[32:35], s52 offen lds
    v_min_u32 v185, 31, v1
    v_lshlrev_b32 v185, 4, v185
    s_lshl_b32 s72, s44, 9
    s_add_u32 s72, s72, 655360
    buffer_load_dwordx2 v[174:175], v185, s[20:23], s72 offen sc1
    s_waitcnt vmcnt(0)
    s_mov_b32 s58, 0x40000
L_poll4:
    v_cmp_ne_u64 vcc, s[56:57], v[174:175]
    s_nop 4
    s_cbranch_vccz L_polld4
L_h10:
    s_cbranch_execz L_hret
    s_sub_u32 s58, s58, 1
    s_cbranch_scc1 L_polld4
    s_sleep 16
    v_min_u32 v185, 31, v1
    v_lshlrev_b32 v185, 4, v185
    s_lshl_b32 s72, s44, 9
    s_add_u32 s72, s72, 655360
    buffer_load_dwordx2 v[174:175], v185, s[20:23], s72 offen sc1
    s_waitcnt vmcnt(0)
    s_branch L_poll4
L_polld4:
    v_lshlrev_b32 v35, 7, v1
    s_xor_b32 s48, s44, 4
    s_lshl_b32 s48, s48, 2
    s_add_u32 s48, s48, s3
    v_min_u32 v185, 7, v1
    v_lshlrev_b32 v185, 4, v185
    s_lshl_b32 s72, s48, 7
    s_add_u32 s72, s72, 655360
    buffer_load_dwordx2 v[174:175], v185, s[20:23], s72 offen sc1
    s_add_u32 s78, s67, 0
    buffer_load_dwordx4 a[192:195], v204, s[20:23], s78 offen offset:0 sc1
    s_add_u32 s79, s77, 0
    buffer_load_dwordx4 a[196:199], v204, s[20:23], s79 offen offset:0 sc1
    buffer_load_dwordx4 a[200:203], v204, s[20:23], s78 offen offset:2048 sc1
    buffer_load_dwordx4 a[204:207], v204, s[20:23], s79 offen offset:2048 sc1
    s_add_u32 s78, s67, 4096
    buffer_load_dwordx4 a[208:211], v204, s[20:23], s78 offen offset:0 sc1
    s_add_u32 s79, s77, 4096
    buffer_load_dwordx4 a[212:215], v204, s[20:23], s79 offen offset:0 sc1
    buffer_load_dwordx4 a[216:219], v204, s[20:23], s78 offen offset:2048 sc1
    buffer_load_dwordx4 a[220:223], v204, s[20:23], s79 offen offset:2048 sc1
    s_add_u32 s78, s67, 8192
    buffer_load_dwordx4 a[224:227], v204, s[20:23], s78 offen offset:0 sc1
    s_add_u32 s79, s77, 8192
    buffer_load_dwordx4 a[228:231], v204, s[20:23], s79 offen offset:0 sc1
    buffer_load_dwordx4 a[232:235], v204, s[20:23], s78 offen offset:2048 sc1
    buffer_load_dwordx4 a[236:239], v204, s[20:23], s79 offen offset:2048 sc1
    s_add_u32 s78, s67, 12288
    buffer_load_dwordx4 a[240:243], v204, s[20:23], s78 offen offset:0 sc1
    s_add_u32 s79, s77, 12288
    buffer_load_dwordx4 a[244:247], v204, s[20:23], s79 offen offset:0 sc1
    buffer_load_dwordx4 a[248:251], v204, s[20:23], s78 offen offset:2048 sc1
    buffer_load_dwordx4 a[252:255], v204, s[20:23], s79 offen offset:2048 sc1
    s_waitcnt vmcnt(16)
    s_mov_b32 s58, 0x40000
L_poll5:
    v_cmp_ne_u64 vcc, s[56:57], v[174:175]
    s_nop 4
    s_cbranch_vccz L_polld5
    s_sub_u32 s58, s58, 1
    s_cbranch_scc1 L_polld5
    s_sleep 4
    s_xor_b32 s48, s44, 4
    s_lshl_b32 s48, s48, 2
    s_add_u32 s48, s48, s3
    v_min_u32 v185, 7, v1
    v_lshlrev_b32 v185, 4, v185
    s_lshl_b32 s72, s48, 7
    s_add_u32 s72, s72, 655360
    buffer_load_dwordx2 v[174:175], v185, s[20:23], s72 offen sc1
    s_waitcnt vmcnt(0)
    s_branch L_poll5
L_polld5:
    s_lshl_b32 s51, s48, 14
    s_add_u32 s51, s51, 9437184
    buffer_load_dword v11, v35, s[20:23], s51 offen sc1
    s_add_u32 s51, s51, 8192
    buffer_load_dword v11, v35, s[20:23], s51 offen sc1
    v_xor_b32 v246, 0, v37
    v_add_u32 v246, 65536, v246
    v_xor_b32 v247, 32, v37
    v_add_u32 v247, 65536, v247
    v_xor_b32 v248, 64, v37
    v_add_u32 v248, 65536, v248
    v_xor_b32 v249, 96, v37
    v_add_u32 v249, 65536, v249
    s_barrier
    ds_read_b64_tr_b16 a[128:129], v246 offset:0
    ds_read_b64_tr_b16 a[130:131], v246 offset:2048
    ds_read_b64_tr_b16 a[132:133], v247 offset:0
    ds_read_b64_tr_b16 a[134:135], v247 offset:2048
    ds_read_b64_tr_b16 a[136:137], v248 offset:0
    ds_read_b64_tr_b16 a[138:139], v248 offset:2048
    ds_read_b64_tr_b16 a[140:141], v249 offset:0
    ds_read_b64_tr_b16 a[142:143], v249 offset:2048
    ds_read_b64_tr_b16 a[144:145], v246 offset:8192
    ds_read_b64_tr_b16 a[146:147], v246 offset:10240
    ds_read_b64_tr_b16 a[148:149], v247 offset:8192
    ds_read_b64_tr_b16 a[150:151], v247 offset:10240
    ds_read_b64_tr_b16 a[152:153], v248 offset:8192
    ds_read_b64_tr_b16 a[154:155], v248 offset:10240
    ds_read_b64_tr_b16 a[156:157], v249 offset:8192
    ds_read_b64_tr_b16 a[158:159], v249 offset:10240
    s_waitcnt lgkmcnt(0)
    s_barrier
    s_branch L_join
L_redo:
    s_nop 7
    ds_read_b64_tr_b16 a[160:161], v19 offset:0
    ds_read_b64_tr_b16 a[162:163], v19 offset:2048
    ds_read_b64_tr_b16 a[164:165], v20 offset:0
    ds_read_b64_tr_b16 a[166:167], v20 offset:2048
    ds_read_b64_tr_b16 a[168:169], v21 offset:0
    ds_read_b64_tr_b16 a[170:171], v21 offset:2048
    ds_read_b64_tr_b16 a[172:173], v22 offset:0
    ds_read_b64_tr_b16 a[174:175], v22 offset:2048
    ds_read_b64_tr_b16 a[128:129], v19 offset:8192
    ds_read_b64_tr_b16 a[130:131], v19 offset:10240
    ds_read_b64_tr_b16 a[132:133], v20 offset:8192
    ds_read_b64_tr_b16 a[134:135], v20 offset:10240
    ds_read_b64_tr_b16 a[136:137], v21 offset:8192
    ds_read_b64_tr_b16 a[138:139], v21 offset:10240
    ds_read_b64_tr_b16 a[140:141], v22 offset:8192
    ds_read_b64_tr_b16 a[142:143], v22 offset:10240
    s_add_u32 s78, s70, 16384
    buffer_load_dwordx4 v[24:27], v204, s[20:23], s78 offen offset:0 sc1
    s_add_u32 s79, s80, 16384
    buffer_load_dwordx4 v[28:31], v204, s[20:23], s79 offen offset:0 sc1
    buffer_load_dwordx4 v[40:43], v204, s[20:23], s78 offen offset:2048 sc1
    buffer_load_dwordx4 v[44:47], v204, s[20:23], s79 offen offset:2048 sc1
    s_add_u32 s78, s70, 20480
    buffer_load_dwordx4 v[48:51], v204, s[20:23], s78 offen offset:0 sc1
    s_add_u32 s79, s80, 20480
    buffer_load_dwordx4 v[52:55], v204, s[20:23], s79 offen offset:0 sc1
    buffer_load_dwordx4 v[56:59], v204, s[20:23], s78 offen offset:2048 sc1
    buffer_load_dwordx4 v[60:63], v204, s[20:23], s79 offen offset:2048 sc1
    s_add_u32 s78, s70, 0
    buffer_load_dwordx4 v[64:67], v204, s[20:23], s78 offen offset:0 sc1
    s_add_u32 s79, s80, 0
    buffer_load_dwordx4 v[68:71], v204, s[20:23], s79 offen offset:0 sc1
    s_waitcnt lgkmcnt(8)
    s_waitcnt vmcnt(8)
    v_mfma_f32_16x16x32_bf16 v[216:219], a[160:163], v[24:27], 0
    buffer_load_dwordx4 v[72:75], v204, s[20:23], s78 offen offset:2048 sc1
    ds_read_b64_tr_b16 a[144:145], v19 offset:16384
    v_max3_u32 v10, v24, v25, v26
    v_mfma_f32_16x16x32_bf16 v[232:235], a[160:163], v[28:31], 0
    ds_read_b64_tr_b16 a[146:147], v19 offset:18432
    v_mfma_f32_16x16x32_bf16 v[220:223], a[164:167], v[24:27], 0
    ds_read_b64_tr_b16 a[148:149], v20 offset:16384
    v_max3_u32 v10, v26, v27, v10
    v_mfma_f32_16x16x32_bf16 v[236:239], a[164:167], v[28:31], 0
    ds_read_b64_tr_b16 a[150:151], v20 offset:18432
    v_mfma_f32_16x16x32_bf16 v[224:227], a[168:171], v[24:27], 0
    buffer_load_dwordx4 v[76:79], v204, s[20:23], s79 offen offset:2048 sc1
    ds_read_b64_tr_b16 a[152:153], v21 offset:16384
    v_max3_u32 v10, v28, v29, v10
    v_mfma_f32_16x16x32_bf16 v[240:243], a[168:171], v[28:31], 0
    ds_read_b64_tr_b16 a[154:155], v21 offset:18432
    v_mfma_f32_16x16x32_bf16 v[228:231], a[172:175], v[24:27], 0
    ds_read_b64_tr_b16 a[156:157], v22 offset:16384
    v_max3_u32 v10, v30, v31, v10
    v_mfma_f32_16x16x32_bf16 v[252:255], a[172:175], v[28:31], 0
    ds_read_b64_tr_b16 a[158:159], v22 offset:18432
    s_waitcnt lgkmcnt(8)
    s_waitcnt vmcnt(8)
    v_mfma_f32_16x16x32_bf16 v[216:219], a[128:131], v[40:43], v[216:219]
    s_add_u32 s78, s70, 4096
    buffer_load_dwordx4 v[80:83], v204, s[20:23], s78 offen offset:0 sc1
    ds_read_b64_tr_b16 a[160:161], v19 offset:24576
    v_max3_u32 v10, v40, v41, v10
    v_mfma_f32_16x16x32_bf16 v[232:235], a[128:131], v[44:47], v[232:235]
    ds_read_b64_tr_b16 a[162:163], v19 offset:26624
    v_mfma_f32_16x16x32_bf16 v[220:223], a[132:135], v[40:43], v[220:223]
    ds_read_b64_tr_b16 a[164:165], v20 offset:24576
    v_max3_u32 v10, v42, v43, v10
    v_mfma_f32_16x16x32_bf16 v[236:239], a[132:135], v[44:47], v[236:239]
    ds_read_b64_tr_b16 a[166:167], v20 offset:26624
    v_mfma_f32_16x16x32_bf16 v[224:227], a[136:139], v[40:43], v[224:227]
    s_add_u32 s79, s80, 4096
    buffer_load_dwordx4 v[84:87], v204, s[20:23], s79 offen offset:0 sc1
    ds_read_b64_tr_b16 a[168:169], v21 offset:24576
    v_max3_u32 v10, v44, v45, v10
    v_mfma_f32_16x16x32_bf16 v[240:243], a[136:139], v[44:47], v[240:243]
    ds_read_b64_tr_b16 a[170:171], v21 offset:26624
    v_mfma_f32_16x16x32_bf16 v[228:231], a[140:143], v[40:43], v[228:231]
    ds_read_b64_tr_b16 a[172:173], v22 offset:24576
    v_max3_u32 v10, v46, v47, v10
    v_mfma_f32_16x16x32_bf16 v[252:255], a[140:143], v[44:47], v[252:255]
    ds_read_b64_tr_b16 a[174:175], v22 offset:26624
    s_waitcnt lgkmcnt(8)
    s_waitcnt vmcnt(8)
    v_mfma_f32_16x16x32_bf16 v[216:219], a[144:147], v[48:51], v[216:219]
    buffer_load_dwordx4 v[88:91], v204, s[20:23], s78 offen offset:2048 sc1
    ds_read_b64_tr_b16 a[128:129], v15 offset:0
    v_max3_u32 v10, v48, v49, v10
    v_mfma_f32_16x16x32_bf16 v[232:235], a[144:147], v[52:55], v[232:235]
    ds_read_b64_tr_b16 a[130:131], v15 offset:2048
    v_mfma_f32_16x16x32_bf16 v[220:223], a[148:151], v[48:51], v[220:223]
    ds_read_b64_tr_b16 a[132:133], v16 offset:0
    v_max3_u32 v10, v50, v51, v10
    v_mfma_f32_16x16x32_bf16 v[236:239], a[148:151], v[52:55], v[236:239]
    ds_read_b64_tr_b16 a[134:135], v16 offset:2048
    v_mfma_f32_16x16x32_bf16 v[224:227], a[152:155], v[48:51], v[224:227]
    buffer_load_dwordx4 v[92:95], v204, s[20:23], s79 offen offset:2048 sc1
    ds_read_b64_tr_b16 a[136:137], v17 offset:0
    v_max3_u32 v10, v52, v53, v10
    v_mfma_f32_16x16x32_bf16 v[240:243], a[152:155], v[52:55], v[240:243]
    ds_read_b64_tr_b16 a[138:139], v17 offset:2048
    v_mfma_f32_16x16x32_bf16 v[228:231], a[156:159], v[48:51], v[228:231]
    ds_read_b64_tr_b16 a[140:141], v18 offset:0
    v_max3_u32 v10, v54, v55, v10
    v_mfma_f32_16x16x32_bf16 v[252:255], a[156:159], v[52:55], v[252:255]
    ds_read_b64_tr_b16 a[142:143], v18 offset:2048
    s_waitcnt lgkmcnt(8)
    s_waitcnt vmcnt(8)
    v_mfma_f32_16x16x32_bf16 v[216:219], a[160:163], v[56:59], v[216:219]
    s_add_u32 s78, s70, 8192
    buffer_load_dwordx4 v[96:99], v204, s[20:23], s78 offen offset:0 sc1
    ds_read_b64_tr_b16 a[144:145], v15 offset:8192
    v_max3_u32 v10, v56, v57, v10
    v_mfma_f32_16x16x32_bf16 v[232:235], a[160:163], v[60:63], v[232:235]
    ds_read_b64_tr_b16 a[146:147], v15 offset:10240
    v_mfma_f32_16x16x32_bf16 v[220:223], a[164:167], v[56:59], v[220:223]
    ds_read_b64_tr_b16 a[148:149], v16 offset:8192
    v_max3_u32 v10, v58, v59, v10
    v_mfma_f32_16x16x32_bf16 v[236:239], a[164:167], v[60:63], v[236:239]
    ds_read_b64_tr_b16 a[150:151], v16 offset:10240
    v_mfma_f32_16x16x32_bf16 v[224:227], a[168:171], v[56:59], v[224:227]
    s_add_u32 s79, s80, 8192
    buffer_load_dwordx4 v[100:103], v204, s[20:23], s79 offen offset:0 sc1
    ds_read_b64_tr_b16 a[152:153], v17 offset:8192
    v_max3_u32 v10, v60, v61, v10
    v_mfma_f32_16x16x32_bf16 v[240:243], a[168:171], v[60:63], v[240:243]
    ds_read_b64_tr_b16 a[154:155], v17 offset:10240
    v_mfma_f32_16x16x32_bf16 v[228:231], a[172:175], v[56:59], v[228:231]
    ds_read_b64_tr_b16 a[156:157], v18 offset:8192
    v_max3_u32 v10, v62, v63, v10
    v_mfma_f32_16x16x32_bf16 v[252:255], a[172:175], v[60:63], v[252:255]
    ds_read_b64_tr_b16 a[158:159], v18 offset:10240
    s_waitcnt lgkmcnt(8)
    s_waitcnt vmcnt(8)
    v_mfma_f32_16x16x32_bf16 v[216:219], a[128:131], v[64:67], v[216:219]
    buffer_load_dwordx4 v[104:107], v204, s[20:23], s78 offen offset:2048 sc1
    ds_read_b64_tr_b16 a[160:161], v15 offset:16384
    v_max3_u32 v10, v64, v65, v10
    v_mfma_f32_16x16x32_bf16 v[232:235], a[128:131], v[68:71], v[232:235]
    ds_read_b64_tr_b16 a[162:163], v15 offset:18432
    v_mfma_f32_16x16x32_bf16 v[220:223], a[132:135], v[64:67], v[220:223]
    ds_read_b64_tr_b16 a[164:165], v16 offset:16384
    v_max3_u32 v10, v66, v67, v10
    v_mfma_f32_16x16x32_bf16 v[236:239], a[132:135], v[68:71], v[236:239]
    ds_read_b64_tr_b16 a[166:167], v16 offset:18432
    v_mfma_f32_16x16x32_bf16 v[224:227], a[136:139], v[64:67], v[224:227]
    buffer_load_dwordx4 v[108:111], v204, s[20:23], s79 offen offset:2048 sc1
    ds_read_b64_tr_b16 a[168:169], v17 offset:16384
    v_max3_u32 v10, v68, v69, v10
    v_mfma_f32_16x16x32_bf16 v[240:243], a[136:139], v[68:71], v[240:243]
    ds_read_b64_tr_b16 a[170:171], v17 offset:18432
    v_mfma_f32_16x16x32_bf16 v[228:231], a[140:143], v[64:67], v[228:231]
    ds_read_b64_tr_b16 a[172:173], v18 offset:16384
    v_max3_u32 v10, v70, v71, v10
    v_mfma_f32_16x16x32_bf16 v[252:255], a[140:143], v[68:71], v[252:255]
    ds_read_b64_tr_b16 a[174:175], v18 offset:18432
    s_waitcnt lgkmcnt(8)
    s_waitcnt vmcnt(8)
    v_mfma_f32_16x16x32_bf16 v[216:219], a[144:147], v[72:75], v[216:219]
    s_add_u32 s78, s70, 12288
    buffer_load_dwordx4 v[112:115], v204, s[20:23], s78 offen offset:0 sc1
    ds_read_b64_tr_b16 a[128:129], v15 offset:24576
    v_max3_u32 v10, v72, v73, v10
    v_mfma_f32_16x16x32_bf16 v[232:235], a[144:147], v[76:79], v[232:235]
    ds_read_b64_tr_b16 a[130:131], v15 offset:26624
    v_mfma_f32_16x16x32_bf16 v[220:223], a[148:151], v[72:75], v[220:223]
    ds_read_b64_tr_b16 a[132:133], v16 offset:24576
    v_max3_u32 v10, v74, v75, v10
    v_mfma_f32_16x16x32_bf16 v[236:239], a[148:151], v[76:79], v[236:239]
    ds_read_b64_tr_b16 a[134:135], v16 offset:26624
    v_mfma_f32_16x16x32_bf16 v[224:227], a[152:155], v[72:75], v[224:227]
    s_add_u32 s79, s80, 12288
    buffer_load_dwordx4 v[116:119], v204, s[20:23], s79 offen offset:0 sc1
    ds_read_b64_tr_b16 a[136:137], v17 offset:24576
    v_max3_u32 v10, v76, v77, v10
    v_mfma_f32_16x16x32_bf16 v[240:243], a[152:155], v[76:79], v[240:243]
    ds_read_b64_tr_b16 a[138:139], v17 offset:26624
    v_mfma_f32_16x16x32_bf16 v[228:231], a[156:159], v[72:75], v[228:231]
    ds_read_b64_tr_b16 a[140:141], v18 offset:24576
    v_max3_u32 v10, v78, v79, v10
    v_mfma_f32_16x16x32_bf16 v[252:255], a[156:159], v[76:79], v[252:255]
    ds_read_b64_tr_b16 a[142:143], v18 offset:26624
    s_waitcnt lgkmcnt(8)
    s_waitcnt vmcnt(8)
    v_mfma_f32_16x16x32_bf16 v[216:219], a[160:163], v[80:83], v[216:219]
    buffer_load_dwordx4 v[120:123], v204, s[20:23], s78 offen offset:2048 sc1
    ds_read_b64_tr_b16 a[144:145], v15 offset:32768
    v_max3_u32 v10, v80, v81, v10
    v_mfma_f32_16x16x32_bf16 v[232:235], a[160:163], v[84:87], v[232:235]
    ds_read_b64_tr_b16 a[146:147], v15 offset:34816
    v_mfma_f32_16x16x32_bf16 v[220:223], a[164:167], v[80:83], v[220:223]
    ds_read_b64_tr_b16 a[148:149], v16 offset:32768
    v_max3_u32 v10, v82, v83, v10
    v_mfma_f32_16x16x32_bf16 v[236:239], a[164:167], v[84:87], v[236:239]
    ds_read_b64_tr_b16 a[150:151], v16 offset:34816
    v_mfma_f32_16x16x32_bf16 v[224:227], a[168:171], v[80:83], v[224:227]
    buffer_load_dwordx4 v[124:127], v204, s[20:23], s79 offen offset:2048 sc1
    ds_read_b64_tr_b16 a[152:153], v17 offset:32768
    v_max3_u32 v10, v84, v85, v10
    v_mfma_f32_16x16x32_bf16 v[240:243], a[168:171], v[84:87], v[240:243]
    ds_read_b64_tr_b16 a[154:155], v17 offset:34816
    v_mfma_f32_16x16x32_bf16 v[228:231], a[172:175], v[80:83], v[228:231]
    ds_read_b64_tr_b16 a[156:157], v18 offset:32768
    v_max3_u32 v10, v86, v87, v10
    v_mfma_f32_16x16x32_bf16 v[252:255], a[172:175], v[84:87], v[252:255]
    ds_read_b64_tr_b16 a[158:159], v18 offset:34816
    s_waitcnt lgkmcnt(8)
    s_waitcnt vmcnt(8)
    v_mfma_f32_16x16x32_bf16 v[216:219], a[128:131], v[88:91], v[216:219]
    s_add_u32 s78, s70, 24576
    buffer_load_dwordx4 v[128:131], v204, s[20:23], s78 offen offset:0 sc1
    ds_read_b64_tr_b16 a[160:161], v15 offset:40960
    v_max3_u32 v10, v88, v89, v10
    v_mfma_f32_16x16x32_bf16 v[232:235], a[128:131], v[92:95], v[232:235]
    ds_read_b64_tr_b16 a[162:163], v15 offset:43008
    v_mfma_f32_16x16x32_bf16 v[220:223], a[132:135], v[88:91], v[220:223]
    ds_read_b64_tr_b16 a[164:165], v16 offset:40960
    v_max3_u32 v10, v90, v91, v10
    v_mfma_f32_16x16x32_bf16 v[236:239], a[132:135], v[92:95], v[236:239]
    ds_read_b64_tr_b16 a[166:167], v16 offset:43008
    v_mfma_f32_16x16x32_bf16 v[224:227], a[136:139], v[88:91], v[224:227]
    s_add_u32 s79, s80, 24576
    buffer_load_dwordx4 v[132:135], v204, s[20:23], s79 offen offset:0 sc1
    ds_read_b64_tr_b16 a[168:169], v17 offset:40960
    v_max3_u32 v10, v92, v93, v10
    v_mfma_f32_16x16x32_bf16 v[240:243], a[136:139], v[92:95], v[240:243]
    ds_read_b64_tr_b16 a[170:171], v17 offset:43008
    v_mfma_f32_16x16x32_bf16 v[228:231], a[140:143], v[88:91], v[228:231]
    ds_read_b64_tr_b16 a[172:173], v18 offset:40960
    v_max3_u32 v10, v94, v95, v10
    v_mfma_f32_16x16x32_bf16 v[252:255], a[140:143], v[92:95], v[252:255]
    ds_read_b64_tr_b16 a[174:175], v18 offset:43008
    s_waitcnt lgkmcnt(8)
    s_waitcnt vmcnt(8)
    v_mfma_f32_16x16x32_bf16 v[216:219], a[144:147], v[96:99], v[216:219]
    buffer_load_dwordx4 v[136:139], v204, s[20:23], s78 offen offset:2048 sc1
    ds_read_b64_tr_b16 a[128:129], v15 offset:49152
    v_max3_u32 v10, v96, v97, v10
    v_mfma_f32_16x16x32_bf16 v[232:235], a[144:147], v[100:103], v[232:235]
    ds_read_b64_tr_b16 a[130:131], v15 offset:51200
    v_mfma_f32_16x16x32_bf16 v[220:223], a[148:151], v[96:99], v[220:223]
    ds_read_b64_tr_b16 a[132:133], v16 offset:49152
    v_max3_u32 v10, v98, v99, v10
    v_mfma_f32_16x16x32_bf16 v[236:239], a[148:151], v[100:103], v[236:239]
    ds_read_b64_tr_b16 a[134:135], v16 offset:51200
    v_mfma_f32_16x16x32_bf16 v[224:227], a[152:155], v[96:99], v[224:227]
    buffer_load_dwordx4 v[140:143], v204, s[20:23], s79 offen offset:2048 sc1
    ds_read_b64_tr_b16 a[136:137], v17 offset:49152
    v_max3_u32 v10, v100, v101, v10
    v_mfma_f32_16x16x32_bf16 v[240:243], a[152:155], v[100:103], v[240:243]
    ds_read_b64_tr_b16 a[138:139], v17 offset:51200
    v_mfma_f32_16x16x32_bf16 v[228:231], a[156:159], v[96:99], v[228:231]
    ds_read_b64_tr_b16 a[140:141], v18 offset:49152
    v_max3_u32 v10, v102, v103, v10
    v_mfma_f32_16x16x32_bf16 v[252:255], a[156:159], v[100:103], v[252:255]
    ds_read_b64_tr_b16 a[142:143], v18 offset:51200
    s_waitcnt lgkmcnt(8)
    s_waitcnt vmcnt(8)
    v_mfma_f32_16x16x32_bf16 v[216:219], a[160:163], v[104:107], v[216:219]
    ds_read_b64_tr_b16 a[144:145], v15 offset:57344
    v_max3_u32 v10, v104, v105, v10
    v_mfma_f32_16x16x32_bf16 v[232:235], a[160:163], v[108:111], v[232:235]
    ds_read_b64_tr_b16 a[146:147], v15 offset:59392
    v_mfma_f32_16x16x32_bf16 v[220:223], a[164:167], v[104:107], v[220:223]
    ds_read_b64_tr_b16 a[148:149], v16 offset:57344
    v_max3_u32 v10, v106, v107, v10
    v_mfma_f32_16x16x32_bf16 v[236:239], a[164:167], v[108:111], v[236:239]
    ds_read_b64_tr_b16 a[150:151], v16 offset:59392
    v_mfma_f32_16x16x32_bf16 v[224:227], a[168:171], v[104:107], v[224:227]
    ds_read_b64_tr_b16 a[152:153], v17 offset:57344
    v_max3_u32 v10, v108, v109, v10
    v_mfma_f32_16x16x32_bf16 v[240:243], a[168:171], v[108:111], v[240:243]
    ds_read_b64_tr_b16 a[154:155], v17 offset:59392
    v_mfma_f32_16x16x32_bf16 v[228:231], a[172:175], v[104:107], v[228:231]
    ds_read_b64_tr_b16 a[156:157], v18 offset:57344
    v_max3_u32 v10, v110, v111, v10
    v_mfma_f32_16x16x32_bf16 v[252:255], a[172:175], v[108:111], v[252:255]
    ds_read_b64_tr_b16 a[158:159], v18 offset:59392
    s_waitcnt lgkmcnt(8)
    s_waitcnt vmcnt(6)
    v_mfma_f32_16x16x32_bf16 v[216:219], a[128:131], v[112:115], v[216:219]
    ds_read_b64_tr_b16 a[160:161], v246 offset:0
    v_max3_u32 v10, v112, v113, v10
    v_mfma_f32_16x16x32_bf16 v[232:235], a[128:131], v[116:119], v[232:235]
    ds_read_b64_tr_b16 a[162:163], v246 offset:2048
    v_mfma_f32_16x16x32_bf16 v[220:223], a[132:135], v[112:115], v[220:223]
    ds_read_b64_tr_b16 a[164:165], v247 offset:0
    v_max3_u32 v10, v114, v115, v10
    v_mfma_f32_16x16x32_bf16 v[236:239], a[132:135], v[116:119], v[236:239]
    ds_read_b64_tr_b16 a[166:167], v247 offset:2048
    v_mfma_f32_16x16x32_bf16 v[224:227], a[136:139], v[112:115], v[224:227]
    ds_read_b64_tr_b16 a[168:169], v248 offset:0
    v_max3_u32 v10, v116, v117, v10
    v_mfma_f32_16x16x32_bf16 v[240:243], a[136:139], v[116:119], v[240:243]
    ds_read_b64_tr_b16 a[170:171], v248 offset:2048
    v_mfma_f32_16x16x32_bf16 v[228:231], a[140:143], v[112:115], v[228:231]
    ds_read_b64_tr_b16 a[172:173], v249 offset:0
    v_max3_u32 v10, v118, v119, v10
    v_mfma_f32_16x16x32_bf16 v[252:255], a[140:143], v[116:119], v[252:255]
    ds_read_b64_tr_b16 a[174:175], v249 offset:2048
    s_waitcnt lgkmcnt(8)
    s_waitcnt vmcnt(4)
    v_mfma_f32_16x16x32_bf16 v[216:219], a[144:147], v[120:123], v[216:219]
    ds_read_b64_tr_b16 a[128:129], v246 offset:8192
    v_max3_u32 v10, v120, v121, v10
    v_mfma_f32_16x16x32_bf16 v[232:235], a[144:147], v[124:127], v[232:235]
    ds_read_b64_tr_b16 a[130:131], v246 offset:10240
    v_mfma_f32_16x16x32_bf16 v[220:223], a[148:151], v[120:123], v[220:223]
    ds_read_b64_tr_b16 a[132:133], v247 offset:8192
    v_max3_u32 v10, v122, v123, v10
    v_mfma_f32_16x16x32_bf16 v[236:239], a[148:151], v[124:127], v[236:239]
    ds_read_b64_tr_b16 a[134:135], v247 offset:10240
    v_mfma_f32_16x16x32_bf16 v[224:227], a[152:155], v[120:123], v[224:227]
    ds_read_b64_tr_b16 a[136:137], v248 offset:8192
    v_max3_u32 v10, v124, v125, v10
    v_mfma_f32_16x16x32_bf16 v[240:243], a[152:155], v[124:127], v[240:243]
    ds_read_b64_tr_b16 a[138:139], v248 offset:10240
    v_mfma_f32_16x16x32_bf16 v[228:231], a[156:159], v[120:123], v[228:231]
    ds_read_b64_tr_b16 a[140:141], v249 offset:8192
    v_max3_u32 v10, v126, v127, v10
    v_mfma_f32_16x16x32_bf16 v[252:255], a[156:159], v[124:127], v[252:255]
    ds_read_b64_tr_b16 a[142:143], v249 offset:10240
    s_waitcnt lgkmcnt(8)
    s_waitcnt vmcnt(2)
    v_mfma_f32_16x16x32_bf16 v[216:219], a[160:163], v[128:131], v[216:219]
    v_max3_u32 v10, v128, v129, v10
    v_mfma_f32_16x16x32_bf16 v[232:235], a[160:163], v[132:135], v[232:235]
    v_mfma_f32_16x16x32_bf16 v[220:223], a[164:167], v[128:131], v[220:223]
    v_max3_u32 v10, v130, v131, v10
    v_mfma_f32_16x16x32_bf16 v[236:239], a[164:167], v[132:135], v[236:239]
    v_mfma_f32_16x16x32_bf16 v[224:227], a[168:171], v[128:131], v[224:227]
    v_max3_u32 v10, v132, v133, v10
    v_mfma_f32_16x16x32_bf16 v[240:243], a[168:171], v[132:135], v[240:243]
    v_mfma_f32_16x16x32_bf16 v[228:231], a[172:175], v[128:131], v[228:231]
    v_max3_u32 v10, v134, v135, v10
    v_mfma_f32_16x16x32_bf16 v[252:255], a[172:175], v[132:135], v[252:255]
    s_waitcnt lgkmcnt(0)
    s_waitcnt vmcnt(0)
    v_mfma_f32_16x16x32_bf16 v[232:235], a[128:131], v[140:143], v[232:235]
    v_max3_u32 v10, v136, v137, v10
    v_mfma_f32_16x16x32_bf16 v[236:239], a[132:135], v[140:143], v[236:239]
    v_mfma_f32_16x16x32_bf16 v[240:243], a[136:139], v[140:143], v[240:243]
    v_max3_u32 v10, v138, v139, v10
    v_mfma_f32_16x16x32_bf16 v[252:255], a[140:143], v[140:143], v[252:255]
    v_mfma_f32_16x16x32_bf16 v[216:219], a[128:131], v[136:139], v[216:219]
    v_max3_u32 v10, v140, v141, v10
    v_mfma_f32_16x16x32_bf16 v[220:223], a[132:135], v[136:139], v[220:223]
    v_mfma_f32_16x16x32_bf16 v[224:227], a[136:139], v[136:139], v[224:227]
    v_max3_u32 v10, v142, v143, v10
    v_mfma_f32_16x16x32_bf16 v[228:231], a[140:143], v[136:139], v[228:231]
    v_cmp_eq_u32 vcc, -1, v10
    s_waitcnt lgkmcnt(0)
    s_sub_u32 s58, s58, 1
    s_cbranch_scc1 L_fok
    s_nop 3
    s_cbranch_vccnz L_redo
    s_branch L_fok
L_codeend:
    s_endpgm
.section .rodata,"a"
.p2align 6
.amdhsa_kernel gated_mix__sliding_local_dilated__mixer_gmlp__prompt_kernel
  .amdhsa_next_free_vgpr 512
  .amdhsa_next_free_sgpr 100
  .amdhsa_accum_offset 256
  .amdhsa_group_segment_fixed_size 0
  .amdhsa_kernarg_size 96
  .amdhsa_user_sgpr_count 2
  .amdhsa_user_sgpr_kernarg_segment_ptr 1
  .amdhsa_system_sgpr_workgroup_id_x 1
.end_amdhsa_kernel
```
